```python
import torch

def _softmax(x, axis=-1):
    return torch.softmax(x, dim=axis)
def _gelu(x):
    return torch.nn.functional.gelu(x, approximate="tanh")
def _silu(x):
    return torch.nn.functional.silu(x)
def _sigmoid(x):
    return torch.sigmoid(x)
def _layernorm(x, axis=-1, eps=1e-5):
    m = x.mean(dim=axis, keepdim=True)
    v = x.var(dim=axis, keepdim=True, unbiased=False)
    return (x - m) / torch.sqrt(v + eps)
def _scatter_add(tgt, idx, src, axis=0):
    return tgt.clone().index_add_(axis, idx, src)
def _segment_sum(src, seg, n):
    out = torch.zeros((n,) + src.shape[1:], dtype=src.dtype)
    return out.index_add_(0, seg, src)
def _pad(x, pw):
    flat = tuple(v for pair in reversed(pw) for v in pair)
    return torch.nn.functional.pad(x, flat)

kernel_name = 'interleave_layers__mha_block__glu_gated_glu__prompt'

def setup_inputs():

    _w = (lambda a: (lambda t: t.to(torch.bfloat16) if t.is_floating_point() else t)(torch.as_tensor(a)))
    def _A_setup():
        B, S, D, H = 1, 2048, 448, 16
        return {
            "x": _w((lambda *s: torch.randn(*s, dtype=torch.bfloat16) * 0.05)(B, S, D)),
            "wqkv": _w((lambda *s: torch.randn(*s, dtype=torch.bfloat16) * 0.05)(D, 3 * D)),
            "wo": _w((lambda *s: torch.randn(*s, dtype=torch.bfloat16) * 0.05)(D, D)),
        }
    _A_in = _A_setup()

    def _B_setup():
        B, S, D, F = 1, 2048, 448, 1792
        return {
            "x": _w((lambda *s: torch.randn(*s, dtype=torch.bfloat16) * 0.05)(B, S, D)),
            "w_gate": _w((lambda *s: torch.randn(*s, dtype=torch.bfloat16) * 0.05)(D, F)),
            "w_up": _w((lambda *s: torch.randn(*s, dtype=torch.bfloat16) * 0.05)(D, F)),
            "w_down": _w((lambda *s: torch.randn(*s, dtype=torch.bfloat16) * 0.05)(F, D)),
        }
    _B_in = _B_setup()

    return {
        "A_x": _A_in["x"],
        "A_wqkv": _A_in["wqkv"],
        "A_wo": _A_in["wo"],
        "B_x": _B_in["x"],
        "B_w_gate": _B_in["w_gate"],
        "B_w_up": _B_in["w_up"],
        "B_w_down": _B_in["w_down"],
    }

def reference(A_x, A_wqkv, A_wo, B_x, B_w_gate, B_w_up, B_w_down):
    def _A_ref(x, wqkv, wo):
        B, S, D = x.shape
        H = 16
        Dh = D // H
        qkv = (lambda x, *d: x.permute(*d))((x @ wqkv).reshape(B, S, 3, H, Dh), 2, 0, 3, 1, 4)
        q, k, v = qkv[0], qkv[1], qkv[2]
        scores = torch.einsum("bhqd,bhkd->bhqk", q, k) * (Dh ** -0.5)
        p = _softmax(scores, axis=-1)
        o = torch.einsum("bhqk,bhkd->bhqd", p, v)
        return (lambda x, *d: x.permute(*d))(o, 0, 2, 1, 3).reshape(B, S, D) @ wo

    def _B_ref(x, w_gate, w_up, w_down):
        g = torch.einsum("bsd,df->bsf", x, w_gate)
        u = torch.einsum("bsd,df->bsf", x, w_up)
        h = _sigmoid(g) * u
        return torch.einsum("bsf,fd->bsd", h, w_down)

    x = A_x
    x = x + _A_ref(_layernorm(x, axis=-1), A_wqkv, A_wo)
    x = x + _B_ref(_layernorm(x, axis=-1), B_w_gate, B_w_up, B_w_down)
    x = x + _A_ref(_layernorm(x, axis=-1), A_wqkv, A_wo)
    x = x + _B_ref(_layernorm(x, axis=-1), B_w_gate, B_w_up, B_w_down)
    return x
```

```asm
; @launch kernel=k_qkv1_kernel grid=(256,1,1) block=(256,1,1) lds=49152
; @launch kernel=k_attn_kernel grid=(256,1,1) block=(512,1,1) lds=98304
; @launch kernel=k_oproj1_kernel grid=(224,1,1) block=(256,1,1) lds=16384
; @launch kernel=k_glu_kernel grid=(224,1,1) block=(256,1,1) lds=65536
; @launch kernel=k_down1_kernel grid=(224,1,1) block=(256,1,1) lds=65536
; @launch kernel=k_qkv2_kernel grid=(256,1,1) block=(256,1,1) lds=49152
; @launch kernel=k_attn_kernel grid=(256,1,1) block=(512,1,1) lds=98304
; @launch kernel=k_oproj2_kernel grid=(224,1,1) block=(256,1,1) lds=16384
; @launch kernel=k_glu_kernel grid=(224,1,1) block=(256,1,1) lds=65536
; @launch kernel=k_down2_kernel grid=(224,1,1) block=(256,1,1) lds=65536
.amdgcn_target "amdgcn-amd-amdhsa--gfx950"
.text
.globl k_qkv1_kernel
.p2align 8
.type k_qkv1_kernel,@function
k_qkv1_kernel:
    s_cmp_ge_u32 s2, 256
    s_cbranch_scc1 k_qkv1_kernel_end
    s_load_dwordx2 s[28:29], s[0:1], 0
    s_load_dwordx2 s[30:31], s[0:1], 8
    s_load_dwordx2 s[34:35], s[0:1], 72
    v_and_b32 v200, 63, v0
    v_lshrrev_b32 v184, 6, v0
    s_and_b32 s37, s2, 7
    s_lshl_b32 s37, s37, 1
    v_readfirstlane_b32 s36, v184
    s_lshr_b32 s38, s2, 3
    s_and_b32 s42, s38, 1
    s_add_u32 s37, s37, s42
    s_lshr_b32 s38, s38, 1
    s_waitcnt lgkmcnt(0)
    s_mov_b32 s8, s28
    s_mov_b32 s9, s29
    s_mov_b32 s10, 0x1c0000
    s_mov_b32 s11, 0x20000
    s_mov_b32 s12, s30
    s_mov_b32 s13, s31
    s_mov_b32 s14, 0x126000
    s_mov_b32 s15, 0x20000
    s_mov_b32 s20, s34
    s_mov_b32 s21, s35
    s_mov_b32 s22, 0x600000
    s_mov_b32 s23, 0x20000
    s_lshl_b32 s48, s37, 2
    s_add_u32 s48, s48, s36
    s_lshl_b32 s42, s48, 5
    v_and_b32 v208, 31, v200
    v_add_u32 v208, s42, v208
    v_mul_u32_u24 v206, 896, v208
    v_lshrrev_b32 v184, 5, v200
    v_lshlrev_b32 v184, 4, v184
    v_add_u32 v206, v206, v184
    buffer_load_dwordx4 v[0:3], v206, s[8:11], 0 offen offset:0
    buffer_load_dwordx4 v[4:7], v206, s[8:11], 0 offen offset:32
    buffer_load_dwordx4 v[8:11], v206, s[8:11], 0 offen offset:64
    buffer_load_dwordx4 v[12:15], v206, s[8:11], 0 offen offset:96
    buffer_load_dwordx4 v[16:19], v206, s[8:11], 0 offen offset:128
    buffer_load_dwordx4 v[20:23], v206, s[8:11], 0 offen offset:160
    buffer_load_dwordx4 v[24:27], v206, s[8:11], 0 offen offset:192
    buffer_load_dwordx4 v[28:31], v206, s[8:11], 0 offen offset:224
    buffer_load_dwordx4 v[32:35], v206, s[8:11], 0 offen offset:256
    buffer_load_dwordx4 v[36:39], v206, s[8:11], 0 offen offset:288
    buffer_load_dwordx4 v[40:43], v206, s[8:11], 0 offen offset:320
    buffer_load_dwordx4 v[44:47], v206, s[8:11], 0 offen offset:352
    buffer_load_dwordx4 v[48:51], v206, s[8:11], 0 offen offset:384
    buffer_load_dwordx4 v[52:55], v206, s[8:11], 0 offen offset:416
    buffer_load_dwordx4 v[56:59], v206, s[8:11], 0 offen offset:448
    buffer_load_dwordx4 v[60:63], v206, s[8:11], 0 offen offset:480
    buffer_load_dwordx4 v[64:67], v206, s[8:11], 0 offen offset:512
    buffer_load_dwordx4 v[68:71], v206, s[8:11], 0 offen offset:544
    buffer_load_dwordx4 v[72:75], v206, s[8:11], 0 offen offset:576
    buffer_load_dwordx4 v[76:79], v206, s[8:11], 0 offen offset:608
    buffer_load_dwordx4 v[80:83], v206, s[8:11], 0 offen offset:640
    buffer_load_dwordx4 v[84:87], v206, s[8:11], 0 offen offset:672
    buffer_load_dwordx4 v[88:91], v206, s[8:11], 0 offen offset:704
    buffer_load_dwordx4 v[92:95], v206, s[8:11], 0 offen offset:736
    buffer_load_dwordx4 v[96:99], v206, s[8:11], 0 offen offset:768
    buffer_load_dwordx4 v[100:103], v206, s[8:11], 0 offen offset:800
    buffer_load_dwordx4 v[104:107], v206, s[8:11], 0 offen offset:832
    buffer_load_dwordx4 v[108:111], v206, s[8:11], 0 offen offset:864
    s_lshl_b32 s42, s36, 6
    v_add_u32 v203, s42, v200
    v_mul_u32_u24 v184, 683, v203
    v_lshrrev_b32 v184, 13, v184
    v_mul_u32_u24 v185, 12, v184
    v_sub_u32 v185, v203, v185
    v_mul_u32_u24 v203, 2688, v184
    v_lshrrev_b32 v186, 2, v185
    v_mul_u32_u24 v186, 56, v186
    v_and_b32 v185, 3, v185
    v_lshl_add_u32 v186, v185, 4, v186
    v_add_u32 v203, v203, v186
    v_add_u32 v204, s42, v200
    v_add_u32 v204, 256, v204
    v_mul_u32_u24 v184, 683, v204
    v_lshrrev_b32 v184, 13, v184
    v_mul_u32_u24 v185, 12, v184
    v_sub_u32 v185, v204, v185
    v_mul_u32_u24 v204, 2688, v184
    v_lshrrev_b32 v186, 2, v185
    v_mul_u32_u24 v186, 56, v186
    v_and_b32 v185, 3, v185
    v_lshl_add_u32 v186, v185, 4, v186
    v_add_u32 v204, v204, v186
    v_add_u32 v205, s42, v200
    v_add_u32 v205, 512, v205
    v_mul_u32_u24 v184, 683, v205
    v_lshrrev_b32 v184, 13, v184
    v_mul_u32_u24 v185, 12, v184
    v_sub_u32 v185, v205, v185
    v_mul_u32_u24 v205, 2688, v184
    v_lshrrev_b32 v186, 2, v185
    v_mul_u32_u24 v186, 56, v186
    v_and_b32 v185, 3, v185
    v_lshl_add_u32 v186, v185, 4, v186
    v_add_u32 v205, v205, v186
    s_mul_i32 s43, s38, 96
    s_mul_i32 s40, s38, 168
    s_lshl_b32 s39, s36, 10
    v_lshrrev_b32 v184, 5, v200
    v_lshlrev_b32 v184, 3, v184
    v_bfe_u32 v185, v200, 2, 2
    v_add_u32 v184, v184, v185
    v_mul_u32_u24 v201, 192, v184
    v_bfe_u32 v186, v200, 4, 1
    v_lshlrev_b32 v186, 5, v186
    v_and_b32 v187, 3, v200
    v_lshl_add_u32 v186, v187, 3, v186
    v_add_u32 v201, v201, v186
    s_add_u32 s42, s40, 0x0
    s_add_u32 m0, s39, 0
    buffer_load_dwordx4 v203, s[12:15], s42 offen lds
    s_add_u32 s42, s40, 0x0
    s_add_u32 m0, s39, 4096
    buffer_load_dwordx4 v204, s[12:15], s42 offen lds
    s_add_u32 s42, s40, 0x0
    s_add_u32 m0, s39, 8192
    buffer_load_dwordx4 v205, s[12:15], s42 offen lds
    s_add_u32 s42, s40, 0x2a000
    s_add_u32 m0, s39, 12288
    buffer_load_dwordx4 v203, s[12:15], s42 offen lds
    s_add_u32 s42, s40, 0x2a000
    s_add_u32 m0, s39, 16384
    buffer_load_dwordx4 v204, s[12:15], s42 offen lds
    s_add_u32 s42, s40, 0x2a000
    s_add_u32 m0, s39, 20480
    buffer_load_dwordx4 v205, s[12:15], s42 offen lds
    s_waitcnt vmcnt(6)
    v_mov_b32 v184, 0x3f803f80
    v_mov_b32 v185, 0
    v_mov_b32 v186, 0
    v_dot2_f32_bf16 v185, v0, v184, v185
    v_dot2_f32_bf16 v186, v1, v184, v186
    v_dot2_f32_bf16 v185, v2, v184, v185
    v_dot2_f32_bf16 v186, v3, v184, v186
    v_dot2_f32_bf16 v185, v4, v184, v185
    v_dot2_f32_bf16 v186, v5, v184, v186
    v_dot2_f32_bf16 v185, v6, v184, v185
    v_dot2_f32_bf16 v186, v7, v184, v186
    v_dot2_f32_bf16 v185, v8, v184, v185
    v_dot2_f32_bf16 v186, v9, v184, v186
    v_dot2_f32_bf16 v185, v10, v184, v185
    v_dot2_f32_bf16 v186, v11, v184, v186
    v_dot2_f32_bf16 v185, v12, v184, v185
    v_dot2_f32_bf16 v186, v13, v184, v186
    v_dot2_f32_bf16 v185, v14, v184, v185
    v_dot2_f32_bf16 v186, v15, v184, v186
    v_dot2_f32_bf16 v185, v16, v184, v185
    v_dot2_f32_bf16 v186, v17, v184, v186
    v_dot2_f32_bf16 v185, v18, v184, v185
    v_dot2_f32_bf16 v186, v19, v184, v186
    v_dot2_f32_bf16 v185, v20, v184, v185
    v_dot2_f32_bf16 v186, v21, v184, v186
    v_dot2_f32_bf16 v185, v22, v184, v185
    v_dot2_f32_bf16 v186, v23, v184, v186
    v_dot2_f32_bf16 v185, v24, v184, v185
    v_dot2_f32_bf16 v186, v25, v184, v186
    v_dot2_f32_bf16 v185, v26, v184, v185
    v_dot2_f32_bf16 v186, v27, v184, v186
    v_dot2_f32_bf16 v185, v28, v184, v185
    v_dot2_f32_bf16 v186, v29, v184, v186
    v_dot2_f32_bf16 v185, v30, v184, v185
    v_dot2_f32_bf16 v186, v31, v184, v186
    v_dot2_f32_bf16 v185, v32, v184, v185
    v_dot2_f32_bf16 v186, v33, v184, v186
    v_dot2_f32_bf16 v185, v34, v184, v185
    v_dot2_f32_bf16 v186, v35, v184, v186
    v_dot2_f32_bf16 v185, v36, v184, v185
    v_dot2_f32_bf16 v186, v37, v184, v186
    v_dot2_f32_bf16 v185, v38, v184, v185
    v_dot2_f32_bf16 v186, v39, v184, v186
    v_dot2_f32_bf16 v185, v40, v184, v185
    v_dot2_f32_bf16 v186, v41, v184, v186
    v_dot2_f32_bf16 v185, v42, v184, v185
    v_dot2_f32_bf16 v186, v43, v184, v186
    v_dot2_f32_bf16 v185, v44, v184, v185
    v_dot2_f32_bf16 v186, v45, v184, v186
    v_dot2_f32_bf16 v185, v46, v184, v185
    v_dot2_f32_bf16 v186, v47, v184, v186
    v_dot2_f32_bf16 v185, v48, v184, v185
    v_dot2_f32_bf16 v186, v49, v184, v186
    v_dot2_f32_bf16 v185, v50, v184, v185
    v_dot2_f32_bf16 v186, v51, v184, v186
    v_dot2_f32_bf16 v185, v52, v184, v185
    v_dot2_f32_bf16 v186, v53, v184, v186
    v_dot2_f32_bf16 v185, v54, v184, v185
    v_dot2_f32_bf16 v186, v55, v184, v186
    v_dot2_f32_bf16 v185, v56, v184, v185
    v_dot2_f32_bf16 v186, v57, v184, v186
    v_dot2_f32_bf16 v185, v58, v184, v185
    v_dot2_f32_bf16 v186, v59, v184, v186
    v_dot2_f32_bf16 v185, v60, v184, v185
    v_dot2_f32_bf16 v186, v61, v184, v186
    v_dot2_f32_bf16 v185, v62, v184, v185
    v_dot2_f32_bf16 v186, v63, v184, v186
    v_dot2_f32_bf16 v185, v64, v184, v185
    v_dot2_f32_bf16 v186, v65, v184, v186
    v_dot2_f32_bf16 v185, v66, v184, v185
    v_dot2_f32_bf16 v186, v67, v184, v186
    v_dot2_f32_bf16 v185, v68, v184, v185
    v_dot2_f32_bf16 v186, v69, v184, v186
    v_dot2_f32_bf16 v185, v70, v184, v185
    v_dot2_f32_bf16 v186, v71, v184, v186
    v_dot2_f32_bf16 v185, v72, v184, v185
    v_dot2_f32_bf16 v186, v73, v184, v186
    v_dot2_f32_bf16 v185, v74, v184, v185
    v_dot2_f32_bf16 v186, v75, v184, v186
    v_dot2_f32_bf16 v185, v76, v184, v185
    v_dot2_f32_bf16 v186, v77, v184, v186
    v_dot2_f32_bf16 v185, v78, v184, v185
    v_dot2_f32_bf16 v186, v79, v184, v186
    v_dot2_f32_bf16 v185, v80, v184, v185
    v_dot2_f32_bf16 v186, v81, v184, v186
    v_dot2_f32_bf16 v185, v82, v184, v185
    v_dot2_f32_bf16 v186, v83, v184, v186
    v_dot2_f32_bf16 v185, v84, v184, v185
    v_dot2_f32_bf16 v186, v85, v184, v186
    v_dot2_f32_bf16 v185, v86, v184, v185
    v_dot2_f32_bf16 v186, v87, v184, v186
    v_dot2_f32_bf16 v185, v88, v184, v185
    v_dot2_f32_bf16 v186, v89, v184, v186
    v_dot2_f32_bf16 v185, v90, v184, v185
    v_dot2_f32_bf16 v186, v91, v184, v186
    v_dot2_f32_bf16 v185, v92, v184, v185
    v_dot2_f32_bf16 v186, v93, v184, v186
    v_dot2_f32_bf16 v185, v94, v184, v185
    v_dot2_f32_bf16 v186, v95, v184, v186
    v_dot2_f32_bf16 v185, v96, v184, v185
    v_dot2_f32_bf16 v186, v97, v184, v186
    v_dot2_f32_bf16 v185, v98, v184, v185
    v_dot2_f32_bf16 v186, v99, v184, v186
    v_dot2_f32_bf16 v185, v100, v184, v185
    v_dot2_f32_bf16 v186, v101, v184, v186
    v_dot2_f32_bf16 v185, v102, v184, v185
    v_dot2_f32_bf16 v186, v103, v184, v186
    v_dot2_f32_bf16 v185, v104, v184, v185
    v_dot2_f32_bf16 v186, v105, v184, v186
    v_dot2_f32_bf16 v185, v106, v184, v185
    v_dot2_f32_bf16 v186, v107, v184, v186
    v_dot2_f32_bf16 v185, v108, v184, v185
    v_dot2_f32_bf16 v186, v109, v184, v186
    v_dot2_f32_bf16 v185, v110, v184, v185
    v_dot2_f32_bf16 v186, v111, v184, v186
    s_nop 3
    v_add_f32 v185, v185, v186
    v_mov_b32 v187, v185
    s_nop 1
    v_permlane32_swap_b32 v187, v185
    s_nop 1
    v_add_f32 v185, v185, v187
    v_mul_f32 v188, 0x3b124925, v185
    v_cvt_pk_bf16_f32 v189, v188, v188
    v_lshlrev_b32 v189, 16, v189
    v_sub_f32 v190, 0, v189
    v_mov_b32 v191, v190
    v_mov_b32 v192, 0
    v_mov_b32 v193, 0
    v_lshlrev_b32 v194, 16, v0
    v_and_b32 v195, 0xffff0000, v0
    v_pk_add_f32 v[194:195], v[194:195], v[190:191]
    v_pk_fma_f32 v[192:193], v[194:195], v[194:195], v[192:193]
    v_cvt_pk_bf16_f32 v0, v194, v195
    v_lshlrev_b32 v194, 16, v1
    v_and_b32 v195, 0xffff0000, v1
    v_pk_add_f32 v[194:195], v[194:195], v[190:191]
    v_pk_fma_f32 v[192:193], v[194:195], v[194:195], v[192:193]
    v_cvt_pk_bf16_f32 v1, v194, v195
    v_lshlrev_b32 v194, 16, v2
    v_and_b32 v195, 0xffff0000, v2
    v_pk_add_f32 v[194:195], v[194:195], v[190:191]
    v_pk_fma_f32 v[192:193], v[194:195], v[194:195], v[192:193]
    v_cvt_pk_bf16_f32 v2, v194, v195
    v_lshlrev_b32 v194, 16, v3
    v_and_b32 v195, 0xffff0000, v3
    v_pk_add_f32 v[194:195], v[194:195], v[190:191]
    v_pk_fma_f32 v[192:193], v[194:195], v[194:195], v[192:193]
    v_cvt_pk_bf16_f32 v3, v194, v195
    v_lshlrev_b32 v194, 16, v4
    v_and_b32 v195, 0xffff0000, v4
    v_pk_add_f32 v[194:195], v[194:195], v[190:191]
    v_pk_fma_f32 v[192:193], v[194:195], v[194:195], v[192:193]
    v_cvt_pk_bf16_f32 v4, v194, v195
    v_lshlrev_b32 v194, 16, v5
    v_and_b32 v195, 0xffff0000, v5
    v_pk_add_f32 v[194:195], v[194:195], v[190:191]
    v_pk_fma_f32 v[192:193], v[194:195], v[194:195], v[192:193]
    v_cvt_pk_bf16_f32 v5, v194, v195
    v_lshlrev_b32 v194, 16, v6
    v_and_b32 v195, 0xffff0000, v6
    v_pk_add_f32 v[194:195], v[194:195], v[190:191]
    v_pk_fma_f32 v[192:193], v[194:195], v[194:195], v[192:193]
    v_cvt_pk_bf16_f32 v6, v194, v195
    v_lshlrev_b32 v194, 16, v7
    v_and_b32 v195, 0xffff0000, v7
    v_pk_add_f32 v[194:195], v[194:195], v[190:191]
    v_pk_fma_f32 v[192:193], v[194:195], v[194:195], v[192:193]
    v_cvt_pk_bf16_f32 v7, v194, v195
    v_lshlrev_b32 v194, 16, v8
    v_and_b32 v195, 0xffff0000, v8
    v_pk_add_f32 v[194:195], v[194:195], v[190:191]
    v_pk_fma_f32 v[192:193], v[194:195], v[194:195], v[192:193]
    v_cvt_pk_bf16_f32 v8, v194, v195
    v_lshlrev_b32 v194, 16, v9
    v_and_b32 v195, 0xffff0000, v9
    v_pk_add_f32 v[194:195], v[194:195], v[190:191]
    v_pk_fma_f32 v[192:193], v[194:195], v[194:195], v[192:193]
    v_cvt_pk_bf16_f32 v9, v194, v195
    v_lshlrev_b32 v194, 16, v10
    v_and_b32 v195, 0xffff0000, v10
    v_pk_add_f32 v[194:195], v[194:195], v[190:191]
    v_pk_fma_f32 v[192:193], v[194:195], v[194:195], v[192:193]
    v_cvt_pk_bf16_f32 v10, v194, v195
    v_lshlrev_b32 v194, 16, v11
    v_and_b32 v195, 0xffff0000, v11
    v_pk_add_f32 v[194:195], v[194:195], v[190:191]
    v_pk_fma_f32 v[192:193], v[194:195], v[194:195], v[192:193]
    v_cvt_pk_bf16_f32 v11, v194, v195
    v_lshlrev_b32 v194, 16, v12
    v_and_b32 v195, 0xffff0000, v12
    v_pk_add_f32 v[194:195], v[194:195], v[190:191]
    v_pk_fma_f32 v[192:193], v[194:195], v[194:195], v[192:193]
    v_cvt_pk_bf16_f32 v12, v194, v195
    v_lshlrev_b32 v194, 16, v13
    v_and_b32 v195, 0xffff0000, v13
    v_pk_add_f32 v[194:195], v[194:195], v[190:191]
    v_pk_fma_f32 v[192:193], v[194:195], v[194:195], v[192:193]
    v_cvt_pk_bf16_f32 v13, v194, v195
    v_lshlrev_b32 v194, 16, v14
    v_and_b32 v195, 0xffff0000, v14
    v_pk_add_f32 v[194:195], v[194:195], v[190:191]
    v_pk_fma_f32 v[192:193], v[194:195], v[194:195], v[192:193]
    v_cvt_pk_bf16_f32 v14, v194, v195
    v_lshlrev_b32 v194, 16, v15
    v_and_b32 v195, 0xffff0000, v15
    v_pk_add_f32 v[194:195], v[194:195], v[190:191]
    v_pk_fma_f32 v[192:193], v[194:195], v[194:195], v[192:193]
    v_cvt_pk_bf16_f32 v15, v194, v195
    v_lshlrev_b32 v194, 16, v16
    v_and_b32 v195, 0xffff0000, v16
    v_pk_add_f32 v[194:195], v[194:195], v[190:191]
    v_pk_fma_f32 v[192:193], v[194:195], v[194:195], v[192:193]
    v_cvt_pk_bf16_f32 v16, v194, v195
    v_lshlrev_b32 v194, 16, v17
    v_and_b32 v195, 0xffff0000, v17
    v_pk_add_f32 v[194:195], v[194:195], v[190:191]
    v_pk_fma_f32 v[192:193], v[194:195], v[194:195], v[192:193]
    v_cvt_pk_bf16_f32 v17, v194, v195
    v_lshlrev_b32 v194, 16, v18
    v_and_b32 v195, 0xffff0000, v18
    v_pk_add_f32 v[194:195], v[194:195], v[190:191]
    v_pk_fma_f32 v[192:193], v[194:195], v[194:195], v[192:193]
    v_cvt_pk_bf16_f32 v18, v194, v195
    v_lshlrev_b32 v194, 16, v19
    v_and_b32 v195, 0xffff0000, v19
    v_pk_add_f32 v[194:195], v[194:195], v[190:191]
    v_pk_fma_f32 v[192:193], v[194:195], v[194:195], v[192:193]
    v_cvt_pk_bf16_f32 v19, v194, v195
    v_lshlrev_b32 v194, 16, v20
    v_and_b32 v195, 0xffff0000, v20
    v_pk_add_f32 v[194:195], v[194:195], v[190:191]
    v_pk_fma_f32 v[192:193], v[194:195], v[194:195], v[192:193]
    v_cvt_pk_bf16_f32 v20, v194, v195
    v_lshlrev_b32 v194, 16, v21
    v_and_b32 v195, 0xffff0000, v21
    v_pk_add_f32 v[194:195], v[194:195], v[190:191]
    v_pk_fma_f32 v[192:193], v[194:195], v[194:195], v[192:193]
    v_cvt_pk_bf16_f32 v21, v194, v195
    v_lshlrev_b32 v194, 16, v22
    v_and_b32 v195, 0xffff0000, v22
    v_pk_add_f32 v[194:195], v[194:195], v[190:191]
    v_pk_fma_f32 v[192:193], v[194:195], v[194:195], v[192:193]
    v_cvt_pk_bf16_f32 v22, v194, v195
    v_lshlrev_b32 v194, 16, v23
    v_and_b32 v195, 0xffff0000, v23
    v_pk_add_f32 v[194:195], v[194:195], v[190:191]
    v_pk_fma_f32 v[192:193], v[194:195], v[194:195], v[192:193]
    v_cvt_pk_bf16_f32 v23, v194, v195
    v_lshlrev_b32 v194, 16, v24
    v_and_b32 v195, 0xffff0000, v24
    v_pk_add_f32 v[194:195], v[194:195], v[190:191]
    v_pk_fma_f32 v[192:193], v[194:195], v[194:195], v[192:193]
    v_cvt_pk_bf16_f32 v24, v194, v195
    v_lshlrev_b32 v194, 16, v25
    v_and_b32 v195, 0xffff0000, v25
    v_pk_add_f32 v[194:195], v[194:195], v[190:191]
    v_pk_fma_f32 v[192:193], v[194:195], v[194:195], v[192:193]
    v_cvt_pk_bf16_f32 v25, v194, v195
    v_lshlrev_b32 v194, 16, v26
    v_and_b32 v195, 0xffff0000, v26
    v_pk_add_f32 v[194:195], v[194:195], v[190:191]
    v_pk_fma_f32 v[192:193], v[194:195], v[194:195], v[192:193]
    v_cvt_pk_bf16_f32 v26, v194, v195
    v_lshlrev_b32 v194, 16, v27
    v_and_b32 v195, 0xffff0000, v27
    v_pk_add_f32 v[194:195], v[194:195], v[190:191]
    v_pk_fma_f32 v[192:193], v[194:195], v[194:195], v[192:193]
    v_cvt_pk_bf16_f32 v27, v194, v195
    v_lshlrev_b32 v194, 16, v28
    v_and_b32 v195, 0xffff0000, v28
    v_pk_add_f32 v[194:195], v[194:195], v[190:191]
    v_pk_fma_f32 v[192:193], v[194:195], v[194:195], v[192:193]
    v_cvt_pk_bf16_f32 v28, v194, v195
    v_lshlrev_b32 v194, 16, v29
    v_and_b32 v195, 0xffff0000, v29
    v_pk_add_f32 v[194:195], v[194:195], v[190:191]
    v_pk_fma_f32 v[192:193], v[194:195], v[194:195], v[192:193]
    v_cvt_pk_bf16_f32 v29, v194, v195
    v_lshlrev_b32 v194, 16, v30
    v_and_b32 v195, 0xffff0000, v30
    v_pk_add_f32 v[194:195], v[194:195], v[190:191]
    v_pk_fma_f32 v[192:193], v[194:195], v[194:195], v[192:193]
    v_cvt_pk_bf16_f32 v30, v194, v195
    v_lshlrev_b32 v194, 16, v31
    v_and_b32 v195, 0xffff0000, v31
    v_pk_add_f32 v[194:195], v[194:195], v[190:191]
    v_pk_fma_f32 v[192:193], v[194:195], v[194:195], v[192:193]
    v_cvt_pk_bf16_f32 v31, v194, v195
    v_lshlrev_b32 v194, 16, v32
    v_and_b32 v195, 0xffff0000, v32
    v_pk_add_f32 v[194:195], v[194:195], v[190:191]
    v_pk_fma_f32 v[192:193], v[194:195], v[194:195], v[192:193]
    v_cvt_pk_bf16_f32 v32, v194, v195
    v_lshlrev_b32 v194, 16, v33
    v_and_b32 v195, 0xffff0000, v33
    v_pk_add_f32 v[194:195], v[194:195], v[190:191]
    v_pk_fma_f32 v[192:193], v[194:195], v[194:195], v[192:193]
    v_cvt_pk_bf16_f32 v33, v194, v195
    v_lshlrev_b32 v194, 16, v34
    v_and_b32 v195, 0xffff0000, v34
    v_pk_add_f32 v[194:195], v[194:195], v[190:191]
    v_pk_fma_f32 v[192:193], v[194:195], v[194:195], v[192:193]
    v_cvt_pk_bf16_f32 v34, v194, v195
    v_lshlrev_b32 v194, 16, v35
    v_and_b32 v195, 0xffff0000, v35
    v_pk_add_f32 v[194:195], v[194:195], v[190:191]
    v_pk_fma_f32 v[192:193], v[194:195], v[194:195], v[192:193]
    v_cvt_pk_bf16_f32 v35, v194, v195
    v_lshlrev_b32 v194, 16, v36
    v_and_b32 v195, 0xffff0000, v36
    v_pk_add_f32 v[194:195], v[194:195], v[190:191]
    v_pk_fma_f32 v[192:193], v[194:195], v[194:195], v[192:193]
    v_cvt_pk_bf16_f32 v36, v194, v195
    v_lshlrev_b32 v194, 16, v37
    v_and_b32 v195, 0xffff0000, v37
    v_pk_add_f32 v[194:195], v[194:195], v[190:191]
    v_pk_fma_f32 v[192:193], v[194:195], v[194:195], v[192:193]
    v_cvt_pk_bf16_f32 v37, v194, v195
    v_lshlrev_b32 v194, 16, v38
    v_and_b32 v195, 0xffff0000, v38
    v_pk_add_f32 v[194:195], v[194:195], v[190:191]
    v_pk_fma_f32 v[192:193], v[194:195], v[194:195], v[192:193]
    v_cvt_pk_bf16_f32 v38, v194, v195
    v_lshlrev_b32 v194, 16, v39
    v_and_b32 v195, 0xffff0000, v39
    v_pk_add_f32 v[194:195], v[194:195], v[190:191]
    v_pk_fma_f32 v[192:193], v[194:195], v[194:195], v[192:193]
    v_cvt_pk_bf16_f32 v39, v194, v195
    v_lshlrev_b32 v194, 16, v40
    v_and_b32 v195, 0xffff0000, v40
    v_pk_add_f32 v[194:195], v[194:195], v[190:191]
    v_pk_fma_f32 v[192:193], v[194:195], v[194:195], v[192:193]
    v_cvt_pk_bf16_f32 v40, v194, v195
    v_lshlrev_b32 v194, 16, v41
    v_and_b32 v195, 0xffff0000, v41
    v_pk_add_f32 v[194:195], v[194:195], v[190:191]
    v_pk_fma_f32 v[192:193], v[194:195], v[194:195], v[192:193]
    v_cvt_pk_bf16_f32 v41, v194, v195
    v_lshlrev_b32 v194, 16, v42
    v_and_b32 v195, 0xffff0000, v42
    v_pk_add_f32 v[194:195], v[194:195], v[190:191]
    v_pk_fma_f32 v[192:193], v[194:195], v[194:195], v[192:193]
    v_cvt_pk_bf16_f32 v42, v194, v195
    v_lshlrev_b32 v194, 16, v43
    v_and_b32 v195, 0xffff0000, v43
    v_pk_add_f32 v[194:195], v[194:195], v[190:191]
    v_pk_fma_f32 v[192:193], v[194:195], v[194:195], v[192:193]
    v_cvt_pk_bf16_f32 v43, v194, v195
    v_lshlrev_b32 v194, 16, v44
    v_and_b32 v195, 0xffff0000, v44
    v_pk_add_f32 v[194:195], v[194:195], v[190:191]
    v_pk_fma_f32 v[192:193], v[194:195], v[194:195], v[192:193]
    v_cvt_pk_bf16_f32 v44, v194, v195
    v_lshlrev_b32 v194, 16, v45
    v_and_b32 v195, 0xffff0000, v45
    v_pk_add_f32 v[194:195], v[194:195], v[190:191]
    v_pk_fma_f32 v[192:193], v[194:195], v[194:195], v[192:193]
    v_cvt_pk_bf16_f32 v45, v194, v195
    v_lshlrev_b32 v194, 16, v46
    v_and_b32 v195, 0xffff0000, v46
    v_pk_add_f32 v[194:195], v[194:195], v[190:191]
    v_pk_fma_f32 v[192:193], v[194:195], v[194:195], v[192:193]
    v_cvt_pk_bf16_f32 v46, v194, v195
    v_lshlrev_b32 v194, 16, v47
    v_and_b32 v195, 0xffff0000, v47
    v_pk_add_f32 v[194:195], v[194:195], v[190:191]
    v_pk_fma_f32 v[192:193], v[194:195], v[194:195], v[192:193]
    v_cvt_pk_bf16_f32 v47, v194, v195
    v_lshlrev_b32 v194, 16, v48
    v_and_b32 v195, 0xffff0000, v48
    v_pk_add_f32 v[194:195], v[194:195], v[190:191]
    v_pk_fma_f32 v[192:193], v[194:195], v[194:195], v[192:193]
    v_cvt_pk_bf16_f32 v48, v194, v195
    v_lshlrev_b32 v194, 16, v49
    v_and_b32 v195, 0xffff0000, v49
    v_pk_add_f32 v[194:195], v[194:195], v[190:191]
    v_pk_fma_f32 v[192:193], v[194:195], v[194:195], v[192:193]
    v_cvt_pk_bf16_f32 v49, v194, v195
    v_lshlrev_b32 v194, 16, v50
    v_and_b32 v195, 0xffff0000, v50
    v_pk_add_f32 v[194:195], v[194:195], v[190:191]
    v_pk_fma_f32 v[192:193], v[194:195], v[194:195], v[192:193]
    v_cvt_pk_bf16_f32 v50, v194, v195
    v_lshlrev_b32 v194, 16, v51
    v_and_b32 v195, 0xffff0000, v51
    v_pk_add_f32 v[194:195], v[194:195], v[190:191]
    v_pk_fma_f32 v[192:193], v[194:195], v[194:195], v[192:193]
    v_cvt_pk_bf16_f32 v51, v194, v195
    v_lshlrev_b32 v194, 16, v52
    v_and_b32 v195, 0xffff0000, v52
    v_pk_add_f32 v[194:195], v[194:195], v[190:191]
    v_pk_fma_f32 v[192:193], v[194:195], v[194:195], v[192:193]
    v_cvt_pk_bf16_f32 v52, v194, v195
    v_lshlrev_b32 v194, 16, v53
    v_and_b32 v195, 0xffff0000, v53
    v_pk_add_f32 v[194:195], v[194:195], v[190:191]
    v_pk_fma_f32 v[192:193], v[194:195], v[194:195], v[192:193]
    v_cvt_pk_bf16_f32 v53, v194, v195
    v_lshlrev_b32 v194, 16, v54
    v_and_b32 v195, 0xffff0000, v54
    v_pk_add_f32 v[194:195], v[194:195], v[190:191]
    v_pk_fma_f32 v[192:193], v[194:195], v[194:195], v[192:193]
    v_cvt_pk_bf16_f32 v54, v194, v195
    v_lshlrev_b32 v194, 16, v55
    v_and_b32 v195, 0xffff0000, v55
    v_pk_add_f32 v[194:195], v[194:195], v[190:191]
    v_pk_fma_f32 v[192:193], v[194:195], v[194:195], v[192:193]
    v_cvt_pk_bf16_f32 v55, v194, v195
    v_lshlrev_b32 v194, 16, v56
    v_and_b32 v195, 0xffff0000, v56
    v_pk_add_f32 v[194:195], v[194:195], v[190:191]
    v_pk_fma_f32 v[192:193], v[194:195], v[194:195], v[192:193]
    v_cvt_pk_bf16_f32 v56, v194, v195
    v_lshlrev_b32 v194, 16, v57
    v_and_b32 v195, 0xffff0000, v57
    v_pk_add_f32 v[194:195], v[194:195], v[190:191]
    v_pk_fma_f32 v[192:193], v[194:195], v[194:195], v[192:193]
    v_cvt_pk_bf16_f32 v57, v194, v195
    v_lshlrev_b32 v194, 16, v58
    v_and_b32 v195, 0xffff0000, v58
    v_pk_add_f32 v[194:195], v[194:195], v[190:191]
    v_pk_fma_f32 v[192:193], v[194:195], v[194:195], v[192:193]
    v_cvt_pk_bf16_f32 v58, v194, v195
    v_lshlrev_b32 v194, 16, v59
    v_and_b32 v195, 0xffff0000, v59
    v_pk_add_f32 v[194:195], v[194:195], v[190:191]
    v_pk_fma_f32 v[192:193], v[194:195], v[194:195], v[192:193]
    v_cvt_pk_bf16_f32 v59, v194, v195
    v_lshlrev_b32 v194, 16, v60
    v_and_b32 v195, 0xffff0000, v60
    v_pk_add_f32 v[194:195], v[194:195], v[190:191]
    v_pk_fma_f32 v[192:193], v[194:195], v[194:195], v[192:193]
    v_cvt_pk_bf16_f32 v60, v194, v195
    v_lshlrev_b32 v194, 16, v61
    v_and_b32 v195, 0xffff0000, v61
    v_pk_add_f32 v[194:195], v[194:195], v[190:191]
    v_pk_fma_f32 v[192:193], v[194:195], v[194:195], v[192:193]
    v_cvt_pk_bf16_f32 v61, v194, v195
    v_lshlrev_b32 v194, 16, v62
    v_and_b32 v195, 0xffff0000, v62
    v_pk_add_f32 v[194:195], v[194:195], v[190:191]
    v_pk_fma_f32 v[192:193], v[194:195], v[194:195], v[192:193]
    v_cvt_pk_bf16_f32 v62, v194, v195
    v_lshlrev_b32 v194, 16, v63
    v_and_b32 v195, 0xffff0000, v63
    v_pk_add_f32 v[194:195], v[194:195], v[190:191]
    v_pk_fma_f32 v[192:193], v[194:195], v[194:195], v[192:193]
    v_cvt_pk_bf16_f32 v63, v194, v195
    v_lshlrev_b32 v194, 16, v64
    v_and_b32 v195, 0xffff0000, v64
    v_pk_add_f32 v[194:195], v[194:195], v[190:191]
    v_pk_fma_f32 v[192:193], v[194:195], v[194:195], v[192:193]
    v_cvt_pk_bf16_f32 v64, v194, v195
    v_lshlrev_b32 v194, 16, v65
    v_and_b32 v195, 0xffff0000, v65
    v_pk_add_f32 v[194:195], v[194:195], v[190:191]
    v_pk_fma_f32 v[192:193], v[194:195], v[194:195], v[192:193]
    v_cvt_pk_bf16_f32 v65, v194, v195
    v_lshlrev_b32 v194, 16, v66
    v_and_b32 v195, 0xffff0000, v66
    v_pk_add_f32 v[194:195], v[194:195], v[190:191]
    v_pk_fma_f32 v[192:193], v[194:195], v[194:195], v[192:193]
    v_cvt_pk_bf16_f32 v66, v194, v195
    v_lshlrev_b32 v194, 16, v67
    v_and_b32 v195, 0xffff0000, v67
    v_pk_add_f32 v[194:195], v[194:195], v[190:191]
    v_pk_fma_f32 v[192:193], v[194:195], v[194:195], v[192:193]
    v_cvt_pk_bf16_f32 v67, v194, v195
    v_lshlrev_b32 v194, 16, v68
    v_and_b32 v195, 0xffff0000, v68
    v_pk_add_f32 v[194:195], v[194:195], v[190:191]
    v_pk_fma_f32 v[192:193], v[194:195], v[194:195], v[192:193]
    v_cvt_pk_bf16_f32 v68, v194, v195
    v_lshlrev_b32 v194, 16, v69
    v_and_b32 v195, 0xffff0000, v69
    v_pk_add_f32 v[194:195], v[194:195], v[190:191]
    v_pk_fma_f32 v[192:193], v[194:195], v[194:195], v[192:193]
    v_cvt_pk_bf16_f32 v69, v194, v195
    v_lshlrev_b32 v194, 16, v70
    v_and_b32 v195, 0xffff0000, v70
    v_pk_add_f32 v[194:195], v[194:195], v[190:191]
    v_pk_fma_f32 v[192:193], v[194:195], v[194:195], v[192:193]
    v_cvt_pk_bf16_f32 v70, v194, v195
    v_lshlrev_b32 v194, 16, v71
    v_and_b32 v195, 0xffff0000, v71
    v_pk_add_f32 v[194:195], v[194:195], v[190:191]
    v_pk_fma_f32 v[192:193], v[194:195], v[194:195], v[192:193]
    v_cvt_pk_bf16_f32 v71, v194, v195
    v_lshlrev_b32 v194, 16, v72
    v_and_b32 v195, 0xffff0000, v72
    v_pk_add_f32 v[194:195], v[194:195], v[190:191]
    v_pk_fma_f32 v[192:193], v[194:195], v[194:195], v[192:193]
    v_cvt_pk_bf16_f32 v72, v194, v195
    v_lshlrev_b32 v194, 16, v73
    v_and_b32 v195, 0xffff0000, v73
    v_pk_add_f32 v[194:195], v[194:195], v[190:191]
    v_pk_fma_f32 v[192:193], v[194:195], v[194:195], v[192:193]
    v_cvt_pk_bf16_f32 v73, v194, v195
    v_lshlrev_b32 v194, 16, v74
    v_and_b32 v195, 0xffff0000, v74
    v_pk_add_f32 v[194:195], v[194:195], v[190:191]
    v_pk_fma_f32 v[192:193], v[194:195], v[194:195], v[192:193]
    v_cvt_pk_bf16_f32 v74, v194, v195
    v_lshlrev_b32 v194, 16, v75
    v_and_b32 v195, 0xffff0000, v75
    v_pk_add_f32 v[194:195], v[194:195], v[190:191]
    v_pk_fma_f32 v[192:193], v[194:195], v[194:195], v[192:193]
    v_cvt_pk_bf16_f32 v75, v194, v195
    v_lshlrev_b32 v194, 16, v76
    v_and_b32 v195, 0xffff0000, v76
    v_pk_add_f32 v[194:195], v[194:195], v[190:191]
    v_pk_fma_f32 v[192:193], v[194:195], v[194:195], v[192:193]
    v_cvt_pk_bf16_f32 v76, v194, v195
    v_lshlrev_b32 v194, 16, v77
    v_and_b32 v195, 0xffff0000, v77
    v_pk_add_f32 v[194:195], v[194:195], v[190:191]
    v_pk_fma_f32 v[192:193], v[194:195], v[194:195], v[192:193]
    v_cvt_pk_bf16_f32 v77, v194, v195
    v_lshlrev_b32 v194, 16, v78
    v_and_b32 v195, 0xffff0000, v78
    v_pk_add_f32 v[194:195], v[194:195], v[190:191]
    v_pk_fma_f32 v[192:193], v[194:195], v[194:195], v[192:193]
    v_cvt_pk_bf16_f32 v78, v194, v195
    v_lshlrev_b32 v194, 16, v79
    v_and_b32 v195, 0xffff0000, v79
    v_pk_add_f32 v[194:195], v[194:195], v[190:191]
    v_pk_fma_f32 v[192:193], v[194:195], v[194:195], v[192:193]
    v_cvt_pk_bf16_f32 v79, v194, v195
    v_lshlrev_b32 v194, 16, v80
    v_and_b32 v195, 0xffff0000, v80
    v_pk_add_f32 v[194:195], v[194:195], v[190:191]
    v_pk_fma_f32 v[192:193], v[194:195], v[194:195], v[192:193]
    v_cvt_pk_bf16_f32 v80, v194, v195
    v_lshlrev_b32 v194, 16, v81
    v_and_b32 v195, 0xffff0000, v81
    v_pk_add_f32 v[194:195], v[194:195], v[190:191]
    v_pk_fma_f32 v[192:193], v[194:195], v[194:195], v[192:193]
    v_cvt_pk_bf16_f32 v81, v194, v195
    v_lshlrev_b32 v194, 16, v82
    v_and_b32 v195, 0xffff0000, v82
    v_pk_add_f32 v[194:195], v[194:195], v[190:191]
    v_pk_fma_f32 v[192:193], v[194:195], v[194:195], v[192:193]
    v_cvt_pk_bf16_f32 v82, v194, v195
    v_lshlrev_b32 v194, 16, v83
    v_and_b32 v195, 0xffff0000, v83
    v_pk_add_f32 v[194:195], v[194:195], v[190:191]
    v_pk_fma_f32 v[192:193], v[194:195], v[194:195], v[192:193]
    v_cvt_pk_bf16_f32 v83, v194, v195
    v_lshlrev_b32 v194, 16, v84
    v_and_b32 v195, 0xffff0000, v84
    v_pk_add_f32 v[194:195], v[194:195], v[190:191]
    v_pk_fma_f32 v[192:193], v[194:195], v[194:195], v[192:193]
    v_cvt_pk_bf16_f32 v84, v194, v195
    v_lshlrev_b32 v194, 16, v85
    v_and_b32 v195, 0xffff0000, v85
    v_pk_add_f32 v[194:195], v[194:195], v[190:191]
    v_pk_fma_f32 v[192:193], v[194:195], v[194:195], v[192:193]
    v_cvt_pk_bf16_f32 v85, v194, v195
    v_lshlrev_b32 v194, 16, v86
    v_and_b32 v195, 0xffff0000, v86
    v_pk_add_f32 v[194:195], v[194:195], v[190:191]
    v_pk_fma_f32 v[192:193], v[194:195], v[194:195], v[192:193]
    v_cvt_pk_bf16_f32 v86, v194, v195
    v_lshlrev_b32 v194, 16, v87
    v_and_b32 v195, 0xffff0000, v87
    v_pk_add_f32 v[194:195], v[194:195], v[190:191]
    v_pk_fma_f32 v[192:193], v[194:195], v[194:195], v[192:193]
    v_cvt_pk_bf16_f32 v87, v194, v195
    v_lshlrev_b32 v194, 16, v88
    v_and_b32 v195, 0xffff0000, v88
    v_pk_add_f32 v[194:195], v[194:195], v[190:191]
    v_pk_fma_f32 v[192:193], v[194:195], v[194:195], v[192:193]
    v_cvt_pk_bf16_f32 v88, v194, v195
    v_lshlrev_b32 v194, 16, v89
    v_and_b32 v195, 0xffff0000, v89
    v_pk_add_f32 v[194:195], v[194:195], v[190:191]
    v_pk_fma_f32 v[192:193], v[194:195], v[194:195], v[192:193]
    v_cvt_pk_bf16_f32 v89, v194, v195
    v_lshlrev_b32 v194, 16, v90
    v_and_b32 v195, 0xffff0000, v90
    v_pk_add_f32 v[194:195], v[194:195], v[190:191]
    v_pk_fma_f32 v[192:193], v[194:195], v[194:195], v[192:193]
    v_cvt_pk_bf16_f32 v90, v194, v195
    v_lshlrev_b32 v194, 16, v91
    v_and_b32 v195, 0xffff0000, v91
    v_pk_add_f32 v[194:195], v[194:195], v[190:191]
    v_pk_fma_f32 v[192:193], v[194:195], v[194:195], v[192:193]
    v_cvt_pk_bf16_f32 v91, v194, v195
    v_lshlrev_b32 v194, 16, v92
    v_and_b32 v195, 0xffff0000, v92
    v_pk_add_f32 v[194:195], v[194:195], v[190:191]
    v_pk_fma_f32 v[192:193], v[194:195], v[194:195], v[192:193]
    v_cvt_pk_bf16_f32 v92, v194, v195
    v_lshlrev_b32 v194, 16, v93
    v_and_b32 v195, 0xffff0000, v93
    v_pk_add_f32 v[194:195], v[194:195], v[190:191]
    v_pk_fma_f32 v[192:193], v[194:195], v[194:195], v[192:193]
    v_cvt_pk_bf16_f32 v93, v194, v195
    v_lshlrev_b32 v194, 16, v94
    v_and_b32 v195, 0xffff0000, v94
    v_pk_add_f32 v[194:195], v[194:195], v[190:191]
    v_pk_fma_f32 v[192:193], v[194:195], v[194:195], v[192:193]
    v_cvt_pk_bf16_f32 v94, v194, v195
    v_lshlrev_b32 v194, 16, v95
    v_and_b32 v195, 0xffff0000, v95
    v_pk_add_f32 v[194:195], v[194:195], v[190:191]
    v_pk_fma_f32 v[192:193], v[194:195], v[194:195], v[192:193]
    v_cvt_pk_bf16_f32 v95, v194, v195
    v_lshlrev_b32 v194, 16, v96
    v_and_b32 v195, 0xffff0000, v96
    v_pk_add_f32 v[194:195], v[194:195], v[190:191]
    v_pk_fma_f32 v[192:193], v[194:195], v[194:195], v[192:193]
    v_cvt_pk_bf16_f32 v96, v194, v195
    v_lshlrev_b32 v194, 16, v97
    v_and_b32 v195, 0xffff0000, v97
    v_pk_add_f32 v[194:195], v[194:195], v[190:191]
    v_pk_fma_f32 v[192:193], v[194:195], v[194:195], v[192:193]
    v_cvt_pk_bf16_f32 v97, v194, v195
    v_lshlrev_b32 v194, 16, v98
    v_and_b32 v195, 0xffff0000, v98
    v_pk_add_f32 v[194:195], v[194:195], v[190:191]
    v_pk_fma_f32 v[192:193], v[194:195], v[194:195], v[192:193]
    v_cvt_pk_bf16_f32 v98, v194, v195
    v_lshlrev_b32 v194, 16, v99
    v_and_b32 v195, 0xffff0000, v99
    v_pk_add_f32 v[194:195], v[194:195], v[190:191]
    v_pk_fma_f32 v[192:193], v[194:195], v[194:195], v[192:193]
    v_cvt_pk_bf16_f32 v99, v194, v195
    v_lshlrev_b32 v194, 16, v100
    v_and_b32 v195, 0xffff0000, v100
    v_pk_add_f32 v[194:195], v[194:195], v[190:191]
    v_pk_fma_f32 v[192:193], v[194:195], v[194:195], v[192:193]
    v_cvt_pk_bf16_f32 v100, v194, v195
    v_lshlrev_b32 v194, 16, v101
    v_and_b32 v195, 0xffff0000, v101
    v_pk_add_f32 v[194:195], v[194:195], v[190:191]
    v_pk_fma_f32 v[192:193], v[194:195], v[194:195], v[192:193]
    v_cvt_pk_bf16_f32 v101, v194, v195
    v_lshlrev_b32 v194, 16, v102
    v_and_b32 v195, 0xffff0000, v102
    v_pk_add_f32 v[194:195], v[194:195], v[190:191]
    v_pk_fma_f32 v[192:193], v[194:195], v[194:195], v[192:193]
    v_cvt_pk_bf16_f32 v102, v194, v195
    v_lshlrev_b32 v194, 16, v103
    v_and_b32 v195, 0xffff0000, v103
    v_pk_add_f32 v[194:195], v[194:195], v[190:191]
    v_pk_fma_f32 v[192:193], v[194:195], v[194:195], v[192:193]
    v_cvt_pk_bf16_f32 v103, v194, v195
    v_lshlrev_b32 v194, 16, v104
    v_and_b32 v195, 0xffff0000, v104
    v_pk_add_f32 v[194:195], v[194:195], v[190:191]
    v_pk_fma_f32 v[192:193], v[194:195], v[194:195], v[192:193]
    v_cvt_pk_bf16_f32 v104, v194, v195
    v_lshlrev_b32 v194, 16, v105
    v_and_b32 v195, 0xffff0000, v105
    v_pk_add_f32 v[194:195], v[194:195], v[190:191]
    v_pk_fma_f32 v[192:193], v[194:195], v[194:195], v[192:193]
    v_cvt_pk_bf16_f32 v105, v194, v195
    v_lshlrev_b32 v194, 16, v106
    v_and_b32 v195, 0xffff0000, v106
    v_pk_add_f32 v[194:195], v[194:195], v[190:191]
    v_pk_fma_f32 v[192:193], v[194:195], v[194:195], v[192:193]
    v_cvt_pk_bf16_f32 v106, v194, v195
    v_lshlrev_b32 v194, 16, v107
    v_and_b32 v195, 0xffff0000, v107
    v_pk_add_f32 v[194:195], v[194:195], v[190:191]
    v_pk_fma_f32 v[192:193], v[194:195], v[194:195], v[192:193]
    v_cvt_pk_bf16_f32 v107, v194, v195
    v_lshlrev_b32 v194, 16, v108
    v_and_b32 v195, 0xffff0000, v108
    v_pk_add_f32 v[194:195], v[194:195], v[190:191]
    v_pk_fma_f32 v[192:193], v[194:195], v[194:195], v[192:193]
    v_cvt_pk_bf16_f32 v108, v194, v195
    v_lshlrev_b32 v194, 16, v109
    v_and_b32 v195, 0xffff0000, v109
    v_pk_add_f32 v[194:195], v[194:195], v[190:191]
    v_pk_fma_f32 v[192:193], v[194:195], v[194:195], v[192:193]
    v_cvt_pk_bf16_f32 v109, v194, v195
    v_lshlrev_b32 v194, 16, v110
    v_and_b32 v195, 0xffff0000, v110
    v_pk_add_f32 v[194:195], v[194:195], v[190:191]
    v_pk_fma_f32 v[192:193], v[194:195], v[194:195], v[192:193]
    v_cvt_pk_bf16_f32 v110, v194, v195
    v_lshlrev_b32 v194, 16, v111
    v_and_b32 v195, 0xffff0000, v111
    v_pk_add_f32 v[194:195], v[194:195], v[190:191]
    v_pk_fma_f32 v[192:193], v[194:195], v[194:195], v[192:193]
    v_cvt_pk_bf16_f32 v111, v194, v195
    v_add_f32 v192, v192, v193
    v_mov_b32 v187, v192
    s_nop 1
    v_permlane32_swap_b32 v187, v192
    s_nop 1
    v_add_f32 v192, v192, v187
    v_sub_f32 v187, v188, v189
    v_mul_f32 v187, v187, v187
    v_mul_f32 v192, 0x3b124925, v192
    v_sub_f32 v192, v192, v187
    v_cvt_pk_bf16_f32 v192, v192, v192
    v_lshlrev_b32 v192, 16, v192
    v_add_f32 v192, 0x3727c5ac, v192
    v_cvt_pk_bf16_f32 v192, v192, v192
    v_lshlrev_b32 v192, 16, v192
    v_sqrt_f32 v192, v192
    s_nop 0
    v_cvt_pk_bf16_f32 v192, v192, v192
    v_lshlrev_b32 v192, 16, v192
    v_rcp_f32 v207, v192
    s_nop 0
    s_waitcnt vmcnt(3)
    s_barrier
    s_add_u32 s42, s40, 0x54000
    s_add_u32 m0, s39, 24576
    buffer_load_dwordx4 v203, s[12:15], s42 offen lds
    s_add_u32 s42, s40, 0x54000
    s_add_u32 m0, s39, 28672
    buffer_load_dwordx4 v204, s[12:15], s42 offen lds
    s_add_u32 s42, s40, 0x54000
    s_add_u32 m0, s39, 32768
    buffer_load_dwordx4 v205, s[12:15], s42 offen lds
    ds_read_b64_tr_b16 v[160:161], v201 offset:0
    ds_read_b64_tr_b16 v[162:163], v201 offset:768
    ds_read_b64_tr_b16 v[164:165], v201 offset:64
    ds_read_b64_tr_b16 v[166:167], v201 offset:832
    ds_read_b64_tr_b16 v[168:169], v201 offset:128
    ds_read_b64_tr_b16 v[170:171], v201 offset:896
    ds_read_b64_tr_b16 v[172:173], v201 offset:3072
    ds_read_b64_tr_b16 v[174:175], v201 offset:3840
    ds_read_b64_tr_b16 v[176:177], v201 offset:3136
    ds_read_b64_tr_b16 v[178:179], v201 offset:3904
    ds_read_b64_tr_b16 v[180:181], v201 offset:3200
    ds_read_b64_tr_b16 v[182:183], v201 offset:3968
    s_waitcnt lgkmcnt(6)
    v_mfma_f32_32x32x16_bf16 v[112:127], v[160:163], v[0:3], 0
    v_mfma_f32_32x32x16_bf16 v[128:143], v[164:167], v[0:3], 0
    v_mfma_f32_32x32x16_bf16 v[144:159], v[168:171], v[0:3], 0
    ds_read_b64_tr_b16 v[160:161], v201 offset:6144
    ds_read_b64_tr_b16 v[162:163], v201 offset:6912
    ds_read_b64_tr_b16 v[164:165], v201 offset:6208
    ds_read_b64_tr_b16 v[166:167], v201 offset:6976
    ds_read_b64_tr_b16 v[168:169], v201 offset:6272
    ds_read_b64_tr_b16 v[170:171], v201 offset:7040
    s_waitcnt lgkmcnt(6)
    v_mfma_f32_32x32x16_bf16 v[112:127], v[172:175], v[4:7], v[112:127]
    v_mfma_f32_32x32x16_bf16 v[128:143], v[176:179], v[4:7], v[128:143]
    v_mfma_f32_32x32x16_bf16 v[144:159], v[180:183], v[4:7], v[144:159]
    ds_read_b64_tr_b16 v[172:173], v201 offset:9216
    ds_read_b64_tr_b16 v[174:175], v201 offset:9984
    ds_read_b64_tr_b16 v[176:177], v201 offset:9280
    ds_read_b64_tr_b16 v[178:179], v201 offset:10048
    ds_read_b64_tr_b16 v[180:181], v201 offset:9344
    ds_read_b64_tr_b16 v[182:183], v201 offset:10112
    s_waitcnt lgkmcnt(6)
    v_mfma_f32_32x32x16_bf16 v[112:127], v[160:163], v[8:11], v[112:127]
    v_mfma_f32_32x32x16_bf16 v[128:143], v[164:167], v[8:11], v[128:143]
    v_mfma_f32_32x32x16_bf16 v[144:159], v[168:171], v[8:11], v[144:159]
    s_waitcnt vmcnt(3)
    s_barrier
    s_add_u32 s42, s40, 0x7e000
    s_add_u32 m0, s39, 36864
    buffer_load_dwordx4 v203, s[12:15], s42 offen lds
    s_add_u32 s42, s40, 0x7e000
    s_add_u32 m0, s39, 40960
    buffer_load_dwordx4 v204, s[12:15], s42 offen lds
    s_add_u32 s42, s40, 0x7e000
    s_add_u32 m0, s39, 45056
    buffer_load_dwordx4 v205, s[12:15], s42 offen lds
    ds_read_b64_tr_b16 v[160:161], v201 offset:12288
    ds_read_b64_tr_b16 v[162:163], v201 offset:13056
    ds_read_b64_tr_b16 v[164:165], v201 offset:12352
    ds_read_b64_tr_b16 v[166:167], v201 offset:13120
    ds_read_b64_tr_b16 v[168:169], v201 offset:12416
    ds_read_b64_tr_b16 v[170:171], v201 offset:13184
    s_waitcnt lgkmcnt(6)
    v_mfma_f32_32x32x16_bf16 v[112:127], v[172:175], v[12:15], v[112:127]
    v_mfma_f32_32x32x16_bf16 v[128:143], v[176:179], v[12:15], v[128:143]
    v_mfma_f32_32x32x16_bf16 v[144:159], v[180:183], v[12:15], v[144:159]
    ds_read_b64_tr_b16 v[172:173], v201 offset:15360
    ds_read_b64_tr_b16 v[174:175], v201 offset:16128
    ds_read_b64_tr_b16 v[176:177], v201 offset:15424
    ds_read_b64_tr_b16 v[178:179], v201 offset:16192
    ds_read_b64_tr_b16 v[180:181], v201 offset:15488
    ds_read_b64_tr_b16 v[182:183], v201 offset:16256
    s_waitcnt lgkmcnt(6)
    v_mfma_f32_32x32x16_bf16 v[112:127], v[160:163], v[16:19], v[112:127]
    v_mfma_f32_32x32x16_bf16 v[128:143], v[164:167], v[16:19], v[128:143]
    v_mfma_f32_32x32x16_bf16 v[144:159], v[168:171], v[16:19], v[144:159]
    ds_read_b64_tr_b16 v[160:161], v201 offset:18432
    ds_read_b64_tr_b16 v[162:163], v201 offset:19200
    ds_read_b64_tr_b16 v[164:165], v201 offset:18496
    ds_read_b64_tr_b16 v[166:167], v201 offset:19264
    ds_read_b64_tr_b16 v[168:169], v201 offset:18560
    ds_read_b64_tr_b16 v[170:171], v201 offset:19328
    s_waitcnt lgkmcnt(6)
    v_mfma_f32_32x32x16_bf16 v[112:127], v[172:175], v[20:23], v[112:127]
    v_mfma_f32_32x32x16_bf16 v[128:143], v[176:179], v[20:23], v[128:143]
    v_mfma_f32_32x32x16_bf16 v[144:159], v[180:183], v[20:23], v[144:159]
    ds_read_b64_tr_b16 v[172:173], v201 offset:21504
    ds_read_b64_tr_b16 v[174:175], v201 offset:22272
    ds_read_b64_tr_b16 v[176:177], v201 offset:21568
    ds_read_b64_tr_b16 v[178:179], v201 offset:22336
    ds_read_b64_tr_b16 v[180:181], v201 offset:21632
    ds_read_b64_tr_b16 v[182:183], v201 offset:22400
    s_waitcnt lgkmcnt(6)
    v_mfma_f32_32x32x16_bf16 v[112:127], v[160:163], v[24:27], v[112:127]
    v_mfma_f32_32x32x16_bf16 v[128:143], v[164:167], v[24:27], v[128:143]
    v_mfma_f32_32x32x16_bf16 v[144:159], v[168:171], v[24:27], v[144:159]
    s_waitcnt vmcnt(3)
    s_barrier
    s_add_u32 s42, s40, 0xa8000
    s_add_u32 m0, s39, 0
    buffer_load_dwordx4 v203, s[12:15], s42 offen lds
    s_add_u32 s42, s40, 0xa8000
    s_add_u32 m0, s39, 4096
    buffer_load_dwordx4 v204, s[12:15], s42 offen lds
    s_add_u32 s42, s40, 0xa8000
    s_add_u32 m0, s39, 8192
    buffer_load_dwordx4 v205, s[12:15], s42 offen lds
    ds_read_b64_tr_b16 v[160:161], v201 offset:24576
    ds_read_b64_tr_b16 v[162:163], v201 offset:25344
    ds_read_b64_tr_b16 v[164:165], v201 offset:24640
    ds_read_b64_tr_b16 v[166:167], v201 offset:25408
    ds_read_b64_tr_b16 v[168:169], v201 offset:24704
    ds_read_b64_tr_b16 v[170:171], v201 offset:25472
    s_waitcnt lgkmcnt(6)
    v_mfma_f32_32x32x16_bf16 v[112:127], v[172:175], v[28:31], v[112:127]
    v_mfma_f32_32x32x16_bf16 v[128:143], v[176:179], v[28:31], v[128:143]
    v_mfma_f32_32x32x16_bf16 v[144:159], v[180:183], v[28:31], v[144:159]
    ds_read_b64_tr_b16 v[172:173], v201 offset:27648
    ds_read_b64_tr_b16 v[174:175], v201 offset:28416
    ds_read_b64_tr_b16 v[176:177], v201 offset:27712
    ds_read_b64_tr_b16 v[178:179], v201 offset:28480
    ds_read_b64_tr_b16 v[180:181], v201 offset:27776
    ds_read_b64_tr_b16 v[182:183], v201 offset:28544
    s_waitcnt lgkmcnt(6)
    v_mfma_f32_32x32x16_bf16 v[112:127], v[160:163], v[32:35], v[112:127]
    v_mfma_f32_32x32x16_bf16 v[128:143], v[164:167], v[32:35], v[128:143]
    v_mfma_f32_32x32x16_bf16 v[144:159], v[168:171], v[32:35], v[144:159]
    ds_read_b64_tr_b16 v[160:161], v201 offset:30720
    ds_read_b64_tr_b16 v[162:163], v201 offset:31488
    ds_read_b64_tr_b16 v[164:165], v201 offset:30784
    ds_read_b64_tr_b16 v[166:167], v201 offset:31552
    ds_read_b64_tr_b16 v[168:169], v201 offset:30848
    ds_read_b64_tr_b16 v[170:171], v201 offset:31616
    s_waitcnt lgkmcnt(6)
    v_mfma_f32_32x32x16_bf16 v[112:127], v[172:175], v[36:39], v[112:127]
    v_mfma_f32_32x32x16_bf16 v[128:143], v[176:179], v[36:39], v[128:143]
    v_mfma_f32_32x32x16_bf16 v[144:159], v[180:183], v[36:39], v[144:159]
    ds_read_b64_tr_b16 v[172:173], v201 offset:33792
    ds_read_b64_tr_b16 v[174:175], v201 offset:34560
    ds_read_b64_tr_b16 v[176:177], v201 offset:33856
    ds_read_b64_tr_b16 v[178:179], v201 offset:34624
    ds_read_b64_tr_b16 v[180:181], v201 offset:33920
    ds_read_b64_tr_b16 v[182:183], v201 offset:34688
    s_waitcnt lgkmcnt(6)
    v_mfma_f32_32x32x16_bf16 v[112:127], v[160:163], v[40:43], v[112:127]
    v_mfma_f32_32x32x16_bf16 v[128:143], v[164:167], v[40:43], v[128:143]
    v_mfma_f32_32x32x16_bf16 v[144:159], v[168:171], v[40:43], v[144:159]
    s_waitcnt vmcnt(3)
    s_barrier
    s_add_u32 s42, s40, 0xd2000
    s_add_u32 m0, s39, 12288
    buffer_load_dwordx4 v203, s[12:15], s42 offen lds
    s_add_u32 s42, s40, 0xd2000
    s_add_u32 m0, s39, 16384
    buffer_load_dwordx4 v204, s[12:15], s42 offen lds
    s_add_u32 s42, s40, 0xd2000
    s_add_u32 m0, s39, 20480
    buffer_load_dwordx4 v205, s[12:15], s42 offen lds
    ds_read_b64_tr_b16 v[160:161], v201 offset:36864
    ds_read_b64_tr_b16 v[162:163], v201 offset:37632
    ds_read_b64_tr_b16 v[164:165], v201 offset:36928
    ds_read_b64_tr_b16 v[166:167], v201 offset:37696
    ds_read_b64_tr_b16 v[168:169], v201 offset:36992
    ds_read_b64_tr_b16 v[170:171], v201 offset:37760
    s_waitcnt lgkmcnt(6)
    v_mfma_f32_32x32x16_bf16 v[112:127], v[172:175], v[44:47], v[112:127]
    v_mfma_f32_32x32x16_bf16 v[128:143], v[176:179], v[44:47], v[128:143]
    v_mfma_f32_32x32x16_bf16 v[144:159], v[180:183], v[44:47], v[144:159]
    ds_read_b64_tr_b16 v[172:173], v201 offset:39936
    ds_read_b64_tr_b16 v[174:175], v201 offset:40704
    ds_read_b64_tr_b16 v[176:177], v201 offset:40000
    ds_read_b64_tr_b16 v[178:179], v201 offset:40768
    ds_read_b64_tr_b16 v[180:181], v201 offset:40064
    ds_read_b64_tr_b16 v[182:183], v201 offset:40832
    s_waitcnt lgkmcnt(6)
    v_mfma_f32_32x32x16_bf16 v[112:127], v[160:163], v[48:51], v[112:127]
    v_mfma_f32_32x32x16_bf16 v[128:143], v[164:167], v[48:51], v[128:143]
    v_mfma_f32_32x32x16_bf16 v[144:159], v[168:171], v[48:51], v[144:159]
    ds_read_b64_tr_b16 v[160:161], v201 offset:43008
    ds_read_b64_tr_b16 v[162:163], v201 offset:43776
    ds_read_b64_tr_b16 v[164:165], v201 offset:43072
    ds_read_b64_tr_b16 v[166:167], v201 offset:43840
    ds_read_b64_tr_b16 v[168:169], v201 offset:43136
    ds_read_b64_tr_b16 v[170:171], v201 offset:43904
    s_waitcnt lgkmcnt(6)
    v_mfma_f32_32x32x16_bf16 v[112:127], v[172:175], v[52:55], v[112:127]
    v_mfma_f32_32x32x16_bf16 v[128:143], v[176:179], v[52:55], v[128:143]
    v_mfma_f32_32x32x16_bf16 v[144:159], v[180:183], v[52:55], v[144:159]
    ds_read_b64_tr_b16 v[172:173], v201 offset:46080
    ds_read_b64_tr_b16 v[174:175], v201 offset:46848
    ds_read_b64_tr_b16 v[176:177], v201 offset:46144
    ds_read_b64_tr_b16 v[178:179], v201 offset:46912
    ds_read_b64_tr_b16 v[180:181], v201 offset:46208
    ds_read_b64_tr_b16 v[182:183], v201 offset:46976
    s_waitcnt lgkmcnt(6)
    v_mfma_f32_32x32x16_bf16 v[112:127], v[160:163], v[56:59], v[112:127]
    v_mfma_f32_32x32x16_bf16 v[128:143], v[164:167], v[56:59], v[128:143]
    v_mfma_f32_32x32x16_bf16 v[144:159], v[168:171], v[56:59], v[144:159]
    s_waitcnt vmcnt(3)
    s_barrier
    s_add_u32 s42, s40, 0xfc000
    s_add_u32 m0, s39, 24576
    buffer_load_dwordx4 v203, s[12:15], s42 offen lds
    s_add_u32 s42, s40, 0xfc000
    s_add_u32 m0, s39, 28672
    buffer_load_dwordx4 v204, s[12:15], s42 offen lds
    s_add_u32 s42, s40, 0xfc000
    s_add_u32 m0, s39, 32768
    buffer_load_dwordx4 v205, s[12:15], s42 offen lds
    ds_read_b64_tr_b16 v[160:161], v201 offset:0
    ds_read_b64_tr_b16 v[162:163], v201 offset:768
    ds_read_b64_tr_b16 v[164:165], v201 offset:64
    ds_read_b64_tr_b16 v[166:167], v201 offset:832
    ds_read_b64_tr_b16 v[168:169], v201 offset:128
    ds_read_b64_tr_b16 v[170:171], v201 offset:896
    s_waitcnt lgkmcnt(6)
    v_mfma_f32_32x32x16_bf16 v[112:127], v[172:175], v[60:63], v[112:127]
    v_mfma_f32_32x32x16_bf16 v[128:143], v[176:179], v[60:63], v[128:143]
    v_mfma_f32_32x32x16_bf16 v[144:159], v[180:183], v[60:63], v[144:159]
    ds_read_b64_tr_b16 v[172:173], v201 offset:3072
    ds_read_b64_tr_b16 v[174:175], v201 offset:3840
    ds_read_b64_tr_b16 v[176:177], v201 offset:3136
    ds_read_b64_tr_b16 v[178:179], v201 offset:3904
    ds_read_b64_tr_b16 v[180:181], v201 offset:3200
    ds_read_b64_tr_b16 v[182:183], v201 offset:3968
    s_waitcnt lgkmcnt(6)
    v_mfma_f32_32x32x16_bf16 v[112:127], v[160:163], v[64:67], v[112:127]
    v_mfma_f32_32x32x16_bf16 v[128:143], v[164:167], v[64:67], v[128:143]
    v_mfma_f32_32x32x16_bf16 v[144:159], v[168:171], v[64:67], v[144:159]
    ds_read_b64_tr_b16 v[160:161], v201 offset:6144
    ds_read_b64_tr_b16 v[162:163], v201 offset:6912
    ds_read_b64_tr_b16 v[164:165], v201 offset:6208
    ds_read_b64_tr_b16 v[166:167], v201 offset:6976
    ds_read_b64_tr_b16 v[168:169], v201 offset:6272
    ds_read_b64_tr_b16 v[170:171], v201 offset:7040
    s_waitcnt lgkmcnt(6)
    v_mfma_f32_32x32x16_bf16 v[112:127], v[172:175], v[68:71], v[112:127]
    v_mfma_f32_32x32x16_bf16 v[128:143], v[176:179], v[68:71], v[128:143]
    v_mfma_f32_32x32x16_bf16 v[144:159], v[180:183], v[68:71], v[144:159]
    ds_read_b64_tr_b16 v[172:173], v201 offset:9216
    ds_read_b64_tr_b16 v[174:175], v201 offset:9984
    ds_read_b64_tr_b16 v[176:177], v201 offset:9280
    ds_read_b64_tr_b16 v[178:179], v201 offset:10048
    ds_read_b64_tr_b16 v[180:181], v201 offset:9344
    ds_read_b64_tr_b16 v[182:183], v201 offset:10112
    s_waitcnt lgkmcnt(6)
    v_mfma_f32_32x32x16_bf16 v[112:127], v[160:163], v[72:75], v[112:127]
    v_mfma_f32_32x32x16_bf16 v[128:143], v[164:167], v[72:75], v[128:143]
    v_mfma_f32_32x32x16_bf16 v[144:159], v[168:171], v[72:75], v[144:159]
    s_waitcnt vmcnt(3)
    s_barrier
    ds_read_b64_tr_b16 v[160:161], v201 offset:12288
    ds_read_b64_tr_b16 v[162:163], v201 offset:13056
    ds_read_b64_tr_b16 v[164:165], v201 offset:12352
    ds_read_b64_tr_b16 v[166:167], v201 offset:13120
    ds_read_b64_tr_b16 v[168:169], v201 offset:12416
    ds_read_b64_tr_b16 v[170:171], v201 offset:13184
    s_waitcnt lgkmcnt(6)
    v_mfma_f32_32x32x16_bf16 v[112:127], v[172:175], v[76:79], v[112:127]
    v_mfma_f32_32x32x16_bf16 v[128:143], v[176:179], v[76:79], v[128:143]
    v_mfma_f32_32x32x16_bf16 v[144:159], v[180:183], v[76:79], v[144:159]
    ds_read_b64_tr_b16 v[172:173], v201 offset:15360
    ds_read_b64_tr_b16 v[174:175], v201 offset:16128
    ds_read_b64_tr_b16 v[176:177], v201 offset:15424
    ds_read_b64_tr_b16 v[178:179], v201 offset:16192
    ds_read_b64_tr_b16 v[180:181], v201 offset:15488
    ds_read_b64_tr_b16 v[182:183], v201 offset:16256
    s_waitcnt lgkmcnt(6)
    v_mfma_f32_32x32x16_bf16 v[112:127], v[160:163], v[80:83], v[112:127]
    v_mfma_f32_32x32x16_bf16 v[128:143], v[164:167], v[80:83], v[128:143]
    v_mfma_f32_32x32x16_bf16 v[144:159], v[168:171], v[80:83], v[144:159]
    ds_read_b64_tr_b16 v[160:161], v201 offset:18432
    ds_read_b64_tr_b16 v[162:163], v201 offset:19200
    ds_read_b64_tr_b16 v[164:165], v201 offset:18496
    ds_read_b64_tr_b16 v[166:167], v201 offset:19264
    ds_read_b64_tr_b16 v[168:169], v201 offset:18560
    ds_read_b64_tr_b16 v[170:171], v201 offset:19328
    s_waitcnt lgkmcnt(6)
    v_mfma_f32_32x32x16_bf16 v[112:127], v[172:175], v[84:87], v[112:127]
    v_mfma_f32_32x32x16_bf16 v[128:143], v[176:179], v[84:87], v[128:143]
    v_mfma_f32_32x32x16_bf16 v[144:159], v[180:183], v[84:87], v[144:159]
    ds_read_b64_tr_b16 v[172:173], v201 offset:21504
    ds_read_b64_tr_b16 v[174:175], v201 offset:22272
    ds_read_b64_tr_b16 v[176:177], v201 offset:21568
    ds_read_b64_tr_b16 v[178:179], v201 offset:22336
    ds_read_b64_tr_b16 v[180:181], v201 offset:21632
    ds_read_b64_tr_b16 v[182:183], v201 offset:22400
    s_waitcnt lgkmcnt(6)
    v_mfma_f32_32x32x16_bf16 v[112:127], v[160:163], v[88:91], v[112:127]
    v_mfma_f32_32x32x16_bf16 v[128:143], v[164:167], v[88:91], v[128:143]
    v_mfma_f32_32x32x16_bf16 v[144:159], v[168:171], v[88:91], v[144:159]
    s_waitcnt vmcnt(0)
    s_barrier
    ds_read_b64_tr_b16 v[160:161], v201 offset:24576
    ds_read_b64_tr_b16 v[162:163], v201 offset:25344
    ds_read_b64_tr_b16 v[164:165], v201 offset:24640
    ds_read_b64_tr_b16 v[166:167], v201 offset:25408
    ds_read_b64_tr_b16 v[168:169], v201 offset:24704
    ds_read_b64_tr_b16 v[170:171], v201 offset:25472
    s_waitcnt lgkmcnt(6)
    v_mfma_f32_32x32x16_bf16 v[112:127], v[172:175], v[92:95], v[112:127]
    v_mfma_f32_32x32x16_bf16 v[128:143], v[176:179], v[92:95], v[128:143]
    v_mfma_f32_32x32x16_bf16 v[144:159], v[180:183], v[92:95], v[144:159]
    ds_read_b64_tr_b16 v[172:173], v201 offset:27648
    ds_read_b64_tr_b16 v[174:175], v201 offset:28416
    ds_read_b64_tr_b16 v[176:177], v201 offset:27712
    ds_read_b64_tr_b16 v[178:179], v201 offset:28480
    ds_read_b64_tr_b16 v[180:181], v201 offset:27776
    ds_read_b64_tr_b16 v[182:183], v201 offset:28544
    s_waitcnt lgkmcnt(6)
    v_mfma_f32_32x32x16_bf16 v[112:127], v[160:163], v[96:99], v[112:127]
    v_mfma_f32_32x32x16_bf16 v[128:143], v[164:167], v[96:99], v[128:143]
    v_mfma_f32_32x32x16_bf16 v[144:159], v[168:171], v[96:99], v[144:159]
    ds_read_b64_tr_b16 v[160:161], v201 offset:30720
    ds_read_b64_tr_b16 v[162:163], v201 offset:31488
    ds_read_b64_tr_b16 v[164:165], v201 offset:30784
    ds_read_b64_tr_b16 v[166:167], v201 offset:31552
    ds_read_b64_tr_b16 v[168:169], v201 offset:30848
    ds_read_b64_tr_b16 v[170:171], v201 offset:31616
    s_waitcnt lgkmcnt(6)
    v_mfma_f32_32x32x16_bf16 v[112:127], v[172:175], v[100:103], v[112:127]
    v_mfma_f32_32x32x16_bf16 v[128:143], v[176:179], v[100:103], v[128:143]
    v_mfma_f32_32x32x16_bf16 v[144:159], v[180:183], v[100:103], v[144:159]
    ds_read_b64_tr_b16 v[172:173], v201 offset:33792
    ds_read_b64_tr_b16 v[174:175], v201 offset:34560
    ds_read_b64_tr_b16 v[176:177], v201 offset:33856
    ds_read_b64_tr_b16 v[178:179], v201 offset:34624
    ds_read_b64_tr_b16 v[180:181], v201 offset:33920
    ds_read_b64_tr_b16 v[182:183], v201 offset:34688
    s_waitcnt lgkmcnt(6)
    v_mfma_f32_32x32x16_bf16 v[112:127], v[160:163], v[104:107], v[112:127]
    v_mfma_f32_32x32x16_bf16 v[128:143], v[164:167], v[104:107], v[128:143]
    v_mfma_f32_32x32x16_bf16 v[144:159], v[168:171], v[104:107], v[144:159]
    s_waitcnt lgkmcnt(0)
    v_mfma_f32_32x32x16_bf16 v[112:127], v[172:175], v[108:111], v[112:127]
    v_mfma_f32_32x32x16_bf16 v[128:143], v[176:179], v[108:111], v[128:143]
    v_mfma_f32_32x32x16_bf16 v[144:159], v[180:183], v[108:111], v[144:159]
    s_nop 15
    s_nop 3
    v_lshlrev_b32 v192, 6, v208
    v_lshrrev_b32 v212, 5, v200
    v_lshl_add_u32 v192, v212, 4, v192
    v_cmp_le_u32 vcc, 32, v200
    v_mul_f32 v112, v112, v207
    v_mul_f32 v113, v113, v207
    v_mul_f32 v114, v114, v207
    v_mul_f32 v115, v115, v207
    v_mul_f32 v116, v116, v207
    v_mul_f32 v117, v117, v207
    v_mul_f32 v118, v118, v207
    v_mul_f32 v119, v119, v207
    v_mul_f32 v120, v120, v207
    v_mul_f32 v121, v121, v207
    v_mul_f32 v122, v122, v207
    v_mul_f32 v123, v123, v207
    v_mul_f32 v124, v124, v207
    v_mul_f32 v125, v125, v207
    v_mul_f32 v126, v126, v207
    v_mul_f32 v127, v127, v207
    v_cvt_pk_bf16_f32 v184, v112, v113
    v_cvt_pk_bf16_f32 v185, v114, v115
    v_cvt_pk_bf16_f32 v186, v116, v117
    v_cvt_pk_bf16_f32 v187, v118, v119
    v_cvt_pk_bf16_f32 v188, v120, v121
    v_cvt_pk_bf16_f32 v189, v122, v123
    v_cvt_pk_bf16_f32 v190, v124, v125
    v_cvt_pk_bf16_f32 v191, v126, v127
    s_nop 1
    v_permlane32_swap_b32 v184, v186
    v_permlane32_swap_b32 v185, v187
    v_permlane32_swap_b32 v188, v190
    v_permlane32_swap_b32 v189, v191
    s_nop 1
    s_mul_i32 s41, s38, 3
    s_add_u32 s41, s41, 0
    s_cmp_ge_u32 s41, 32
    s_cselect_b32 s49, 0x3f80, 0
    s_lshl_b32 s41, s41, 17
    v_mov_b32 v212, s49
    v_mov_b32 v213, 0
    v_cndmask_b32 v190, v190, v212, vcc
    v_cndmask_b32 v191, v191, v213, vcc
    buffer_store_dwordx4 v[184:187], v192, s[20:23], s41 offen
    buffer_store_dwordx4 v[188:191], v192, s[20:23], s41 offen offset:32
    s_nop 1
    v_mul_f32 v128, v128, v207
    v_mul_f32 v129, v129, v207
    v_mul_f32 v130, v130, v207
    v_mul_f32 v131, v131, v207
    v_mul_f32 v132, v132, v207
    v_mul_f32 v133, v133, v207
    v_mul_f32 v134, v134, v207
    v_mul_f32 v135, v135, v207
    v_mul_f32 v136, v136, v207
    v_mul_f32 v137, v137, v207
    v_mul_f32 v138, v138, v207
    v_mul_f32 v139, v139, v207
    v_mul_f32 v140, v140, v207
    v_mul_f32 v141, v141, v207
    v_mul_f32 v142, v142, v207
    v_mul_f32 v143, v143, v207
    v_cvt_pk_bf16_f32 v184, v128, v129
    v_cvt_pk_bf16_f32 v185, v130, v131
    v_cvt_pk_bf16_f32 v186, v132, v133
    v_cvt_pk_bf16_f32 v187, v134, v135
    v_cvt_pk_bf16_f32 v188, v136, v137
    v_cvt_pk_bf16_f32 v189, v138, v139
    v_cvt_pk_bf16_f32 v190, v140, v141
    v_cvt_pk_bf16_f32 v191, v142, v143
    s_nop 1
    v_permlane32_swap_b32 v184, v186
    v_permlane32_swap_b32 v185, v187
    v_permlane32_swap_b32 v188, v190
    v_permlane32_swap_b32 v189, v191
    s_nop 1
    s_mul_i32 s41, s38, 3
    s_add_u32 s41, s41, 1
    s_cmp_ge_u32 s41, 32
    s_cselect_b32 s49, 0x3f80, 0
    s_lshl_b32 s41, s41, 17
    v_mov_b32 v212, s49
    v_mov_b32 v213, 0
    v_cndmask_b32 v190, v190, v212, vcc
    v_cndmask_b32 v191, v191, v213, vcc
    buffer_store_dwordx4 v[184:187], v192, s[20:23], s41 offen
    buffer_store_dwordx4 v[188:191], v192, s[20:23], s41 offen offset:32
    s_nop 1
    v_mul_f32 v144, v144, v207
    v_mul_f32 v145, v145, v207
    v_mul_f32 v146, v146, v207
    v_mul_f32 v147, v147, v207
    v_mul_f32 v148, v148, v207
    v_mul_f32 v149, v149, v207
    v_mul_f32 v150, v150, v207
    v_mul_f32 v151, v151, v207
    v_mul_f32 v152, v152, v207
    v_mul_f32 v153, v153, v207
    v_mul_f32 v154, v154, v207
    v_mul_f32 v155, v155, v207
    v_mul_f32 v156, v156, v207
    v_mul_f32 v157, v157, v207
    v_mul_f32 v158, v158, v207
    v_mul_f32 v159, v159, v207
    v_cvt_pk_bf16_f32 v184, v144, v145
    v_cvt_pk_bf16_f32 v185, v146, v147
    v_cvt_pk_bf16_f32 v186, v148, v149
    v_cvt_pk_bf16_f32 v187, v150, v151
    v_cvt_pk_bf16_f32 v188, v152, v153
    v_cvt_pk_bf16_f32 v189, v154, v155
    v_cvt_pk_bf16_f32 v190, v156, v157
    v_cvt_pk_bf16_f32 v191, v158, v159
    s_nop 1
    v_permlane32_swap_b32 v184, v186
    v_permlane32_swap_b32 v185, v187
    v_permlane32_swap_b32 v188, v190
    v_permlane32_swap_b32 v189, v191
    s_nop 1
    s_mul_i32 s41, s38, 3
    s_add_u32 s41, s41, 2
    s_cmp_ge_u32 s41, 32
    s_cselect_b32 s49, 0x3f80, 0
    s_lshl_b32 s41, s41, 17
    v_mov_b32 v212, s49
    v_mov_b32 v213, 0
    v_cndmask_b32 v190, v190, v212, vcc
    v_cndmask_b32 v191, v191, v213, vcc
    buffer_store_dwordx4 v[184:187], v192, s[20:23], s41 offen
    buffer_store_dwordx4 v[188:191], v192, s[20:23], s41 offen offset:32
    s_nop 1
    s_waitcnt vmcnt(0)
k_qkv1_kernel_end:
    s_endpgm

.globl k_attn_kernel
.p2align 8
.type k_attn_kernel,@function
k_attn_kernel:
    s_cmp_ge_u32 s2, 256
    s_cbranch_scc1 k_attn_kernel_end
    s_load_dwordx2 s[20:21], s[0:1], 72
    v_and_b32 v189, 63, v0
    v_lshrrev_b32 v174, 6, v0
    s_nop 0
    v_readfirstlane_b32 s22, v174
    s_and_b32 s23, s2, 7
    s_lshl_b32 s23, s23, 1
    s_bfe_u32 s25, s2, 0x10003
    s_add_u32 s23, s23, s25
    s_lshr_b32 s24, s2, 4
    s_mov_b32 s30, 0x3e8b97f6
    s_mov_b32 s31, 0x3e8b97f6
    s_waitcnt lgkmcnt(0)
    s_add_u32 s8, s20, 0x200000
    s_addc_u32 s9, s21, 0
    s_mov_b32 s10, 0x400000
    s_mov_b32 s11, 0x20000
    s_mov_b32 s12, s20
    s_mov_b32 s13, s21
    s_mov_b32 s14, 0x200000
    s_mov_b32 s15, 0x20000
    s_add_u32 s16, s20, 0x600000
    s_addc_u32 s17, s21, 0
    s_mov_b32 s18, 0x1c0000
    s_mov_b32 s19, 0x20000
    v_and_b32 v174, 3, v189
    v_bfe_u32 v175, v189, 3, 2
    s_bfe_u32 s25, s22, 0x10001
    s_cmp_eq_u32 s25, 0
    s_cselect_b32 s28, 3, 0
    v_and_b32 v175, s28, v175
    v_xor_b32 v174, v174, v175
    v_lshrrev_b32 v175, 2, v189
    v_lshlrev_b32 v175, 6, v175
    v_lshl_add_u32 v188, v174, 4, v175
    s_lshl_b32 s26, s25, 21
    s_lshl_b32 s25, s23, 17
    s_add_u32 s26, s26, s25
    s_lshr_b32 s25, s22, 2
    s_lshl_b32 s25, s25, 16
    s_add_u32 s26, s26, s25
    s_and_b32 s25, s22, 1
    s_lshl_b32 s25, s25, 12
    s_add_u32 s26, s26, s25
    s_lshl_b32 s27, s22, 12
    s_add_u32 s25, s26, 0x0
    s_add_u32 m0, s27, 0x0
    buffer_load_dwordx4 v188, s[8:11], s25 offen lds
    s_add_u32 s25, s26, 0x400
    s_add_u32 m0, s27, 0x400
    buffer_load_dwordx4 v188, s[8:11], s25 offen lds
    s_add_u32 s25, s26, 0x800
    s_add_u32 m0, s27, 0x800
    buffer_load_dwordx4 v188, s[8:11], s25 offen lds
    s_add_u32 s25, s26, 0xc00
    s_add_u32 m0, s27, 0xc00
    buffer_load_dwordx4 v188, s[8:11], s25 offen lds
    s_add_u32 s25, s26, 0x2000
    s_add_u32 m0, s27, 0x8000
    buffer_load_dwordx4 v188, s[8:11], s25 offen lds
    s_add_u32 s25, s26, 0x2400
    s_add_u32 m0, s27, 0x8400
    buffer_load_dwordx4 v188, s[8:11], s25 offen lds
    s_add_u32 s25, s26, 0x2800
    s_add_u32 m0, s27, 0x8800
    buffer_load_dwordx4 v188, s[8:11], s25 offen lds
    s_add_u32 s25, s26, 0x2c00
    s_add_u32 m0, s27, 0x8c00
    buffer_load_dwordx4 v188, s[8:11], s25 offen lds
    s_add_u32 s25, s26, 0x4000
    s_add_u32 m0, s27, 0x10000
    buffer_load_dwordx4 v188, s[8:11], s25 offen lds
    s_add_u32 s25, s26, 0x4400
    s_add_u32 m0, s27, 0x10400
    buffer_load_dwordx4 v188, s[8:11], s25 offen lds
    s_add_u32 s25, s26, 0x4800
    s_add_u32 m0, s27, 0x10800
    buffer_load_dwordx4 v188, s[8:11], s25 offen lds
    s_add_u32 s25, s26, 0x4c00
    s_add_u32 m0, s27, 0x10c00
    buffer_load_dwordx4 v188, s[8:11], s25 offen lds
    s_and_b32 s25, s22, 3
    s_lshl_b32 s25, s25, 5
    s_lshl_b32 s28, s24, 7
    s_add_u32 s25, s25, s28
    v_and_b32 v190, 31, v189
    v_add_u32 v190, s25, v190
    v_lshlrev_b32 v174, 6, v190
    v_lshrrev_b32 v175, 5, v189
    v_lshl_add_u32 v174, v175, 4, v174
    s_lshl_b32 s28, s23, 17
    buffer_load_dwordx4 v[0:3], v174, s[12:15], s28 offen
    buffer_load_dwordx4 v[4:7], v174, s[12:15], s28 offen offset:32
    s_lshr_b32 s25, s22, 2
    s_lshl_b32 s25, s25, 14
    v_and_b32 v174, 31, v189
    v_bfe_u32 v175, v189, 1, 2
    v_lshrrev_b32 v176, 5, v189
    v_xor_b32 v175, v175, v176
    v_lshlrev_b32 v174, 6, v174
    v_lshl_add_u32 v174, v175, 4, v174
    v_add_u32 v182, s25, v174
    v_xor_b32 v184, 32, v182
    v_add_u32 v183, 0x10000, v182
    v_add_u32 v185, 0x10000, v184
    v_bfe_u32 v174, v189, 2, 2
    v_lshl_add_u32 v174, v176, 2, v174
    v_lshlrev_b32 v174, 6, v174
    v_bfe_u32 v175, v189, 4, 1
    v_lshl_add_u32 v174, v175, 5, v174
    v_and_b32 v175, 3, v189
    v_lshl_add_u32 v174, v175, 3, v174
    s_add_u32 s25, s25, 8192
    v_add_u32 v186, s25, v174
    v_add_u32 v187, 0x10000, v186
    v_mov_b32 v168, 0xff800000
    v_mov_b32 v8, 0
    v_mov_b32 v9, 0
    v_mov_b32 v10, 0
    v_mov_b32 v11, 0
    v_mov_b32 v12, 0
    v_mov_b32 v13, 0
    v_mov_b32 v14, 0
    v_mov_b32 v15, 0
    v_mov_b32 v16, 0
    v_mov_b32 v17, 0
    v_mov_b32 v18, 0
    v_mov_b32 v19, 0
    v_mov_b32 v20, 0
    v_mov_b32 v21, 0
    v_mov_b32 v22, 0
    v_mov_b32 v23, 0
    s_waitcnt vmcnt(10)
    s_barrier
    ds_read_b128 v[104:107], v182 offset:0
    ds_read_b128 v[108:111], v184 offset:0
    ds_read_b128 v[112:115], v182 offset:2048
    ds_read_b128 v[116:119], v184 offset:2048
    ds_read_b64_tr_b16 v[136:137], v186 offset:0
    ds_read_b64_tr_b16 v[138:139], v186 offset:512
    ds_read_b64_tr_b16 v[140:141], v186 offset:1024
    ds_read_b64_tr_b16 v[142:143], v186 offset:1536
    ds_read_b64_tr_b16 v[144:145], v186 offset:2048
    ds_read_b64_tr_b16 v[146:147], v186 offset:2560
    ds_read_b64_tr_b16 v[148:149], v186 offset:3072
    ds_read_b64_tr_b16 v[150:151], v186 offset:3584
    s_waitcnt vmcnt(0)
    s_waitcnt lgkmcnt(8)
    v_mfma_f32_32x32x16_bf16 v[24:39], v[104:107], v[0:3], 0
    v_mfma_f32_32x32x16_bf16 v[24:39], v[108:111], v[4:7], v[24:39]
    v_mfma_f32_32x32x16_bf16 v[40:55], v[112:115], v[0:3], 0
    v_mfma_f32_32x32x16_bf16 v[40:55], v[116:119], v[4:7], v[40:55]
    ds_read_b128 v[120:123], v182 offset:4096
    ds_read_b128 v[124:127], v184 offset:4096
    ds_read_b128 v[128:131], v182 offset:6144
    ds_read_b128 v[132:135], v184 offset:6144
    s_barrier
    s_waitcnt lgkmcnt(0)
    s_nop 7
    s_nop 7
    v_mfma_f32_32x32x16_bf16 v[56:71], v[120:123], v[0:3], 0
    v_max3_f32 v174, v24, v25, v26
    v_max3_f32 v175, v27, v28, v29
    v_max3_f32 v174, v174, v30, v31
    v_max3_f32 v175, v175, v32, v33
    v_max3_f32 v174, v174, v34, v35
    v_max3_f32 v175, v175, v36, v37
    v_max3_f32 v174, v174, v38, v39
    v_max3_f32 v175, v175, v40, v41
    v_mfma_f32_32x32x16_bf16 v[56:71], v[124:127], v[4:7], v[56:71]
    v_max3_f32 v174, v174, v42, v43
    v_max3_f32 v175, v175, v44, v45
    v_max3_f32 v174, v174, v46, v47
    v_max3_f32 v175, v175, v48, v49
    v_max3_f32 v174, v174, v50, v51
    v_max3_f32 v175, v175, v52, v53
    v_max3_f32 v174, v174, v54, v55
    v_max_f32 v174, v174, v175
    v_mfma_f32_32x32x16_bf16 v[72:87], v[128:131], v[0:3], 0
    v_mov_b32 v175, v174
    s_nop 1
    v_permlane32_swap_b32 v174, v175
    s_nop 1
    v_max3_f32 v174, v174, v175, v168
    v_mfma_f32_32x32x16_bf16 v[72:87], v[132:135], v[4:7], v[72:87]
    ds_read_b128 v[104:107], v182 offset:32768
    ds_read_b128 v[108:111], v184 offset:32768
    ds_read_b128 v[112:115], v182 offset:34816
    ds_read_b128 v[116:119], v184 offset:34816
    v_sub_f32 v176, v168, v174
    v_mul_f32 v176, s30, v176
    v_exp_f32 v172, v176
    v_mov_b32 v168, v174
    v_mul_f32 v170, s30, v174
    v_sub_f32 v170, 0, v170
    v_mov_b32 v171, v170
    v_mov_b32 v173, v172
    ds_read_b64_tr_b16 v[152:153], v186 offset:4096
    ds_read_b64_tr_b16 v[154:155], v186 offset:4608
    ds_read_b64_tr_b16 v[156:157], v186 offset:5120
    ds_read_b64_tr_b16 v[158:159], v186 offset:5632
    ds_read_b64_tr_b16 v[160:161], v186 offset:6144
    ds_read_b64_tr_b16 v[162:163], v186 offset:6656
    ds_read_b64_tr_b16 v[164:165], v186 offset:7168
    ds_read_b64_tr_b16 v[166:167], v186 offset:7680
    v_pk_fma_f32 v[24:25], v[24:25], s[30:31], v[170:171]
    v_pk_fma_f32 v[26:27], v[26:27], s[30:31], v[170:171]
    v_pk_fma_f32 v[28:29], v[28:29], s[30:31], v[170:171]
    v_pk_fma_f32 v[30:31], v[30:31], s[30:31], v[170:171]
    v_pk_fma_f32 v[32:33], v[32:33], s[30:31], v[170:171]
    v_pk_fma_f32 v[34:35], v[34:35], s[30:31], v[170:171]
    v_pk_fma_f32 v[36:37], v[36:37], s[30:31], v[170:171]
    v_pk_fma_f32 v[38:39], v[38:39], s[30:31], v[170:171]
    v_pk_mul_f32 v[8:9], v[8:9], v[172:173]
    v_pk_mul_f32 v[10:11], v[10:11], v[172:173]
    v_pk_mul_f32 v[12:13], v[12:13], v[172:173]
    v_pk_mul_f32 v[14:15], v[14:15], v[172:173]
    v_pk_mul_f32 v[16:17], v[16:17], v[172:173]
    v_pk_mul_f32 v[18:19], v[18:19], v[172:173]
    v_pk_mul_f32 v[20:21], v[20:21], v[172:173]
    v_pk_mul_f32 v[22:23], v[22:23], v[172:173]
    v_exp_f32 v24, v24
    v_exp_f32 v25, v25
    v_exp_f32 v26, v26
    v_exp_f32 v27, v27
    v_exp_f32 v28, v28
    v_exp_f32 v29, v29
    v_exp_f32 v30, v30
    v_exp_f32 v31, v31
    v_exp_f32 v32, v32
    v_exp_f32 v33, v33
    v_exp_f32 v34, v34
    v_exp_f32 v35, v35
    v_exp_f32 v36, v36
    v_exp_f32 v37, v37
    v_exp_f32 v38, v38
    v_exp_f32 v39, v39
    s_nop 0
    v_cvt_pk_bf16_f32 v88, v24, v25
    v_cvt_pk_bf16_f32 v89, v26, v27
    v_cvt_pk_bf16_f32 v90, v28, v29
    v_cvt_pk_bf16_f32 v91, v30, v31
    v_cvt_pk_bf16_f32 v92, v32, v33
    v_cvt_pk_bf16_f32 v93, v34, v35
    v_cvt_pk_bf16_f32 v94, v36, v37
    v_cvt_pk_bf16_f32 v95, v38, v39
    s_nop 1
    v_mfma_f32_32x32x16_bf16 v[8:23], v[136:139], v[88:91], v[8:23]
    v_mfma_f32_32x32x16_bf16 v[8:23], v[140:143], v[92:95], v[8:23]
    v_pk_fma_f32 v[40:41], v[40:41], s[30:31], v[170:171]
    v_pk_fma_f32 v[42:43], v[42:43], s[30:31], v[170:171]
    v_pk_fma_f32 v[44:45], v[44:45], s[30:31], v[170:171]
    v_pk_fma_f32 v[46:47], v[46:47], s[30:31], v[170:171]
    v_pk_fma_f32 v[48:49], v[48:49], s[30:31], v[170:171]
    v_pk_fma_f32 v[50:51], v[50:51], s[30:31], v[170:171]
    v_pk_fma_f32 v[52:53], v[52:53], s[30:31], v[170:171]
    v_pk_fma_f32 v[54:55], v[54:55], s[30:31], v[170:171]
    v_exp_f32 v40, v40
    v_exp_f32 v41, v41
    v_exp_f32 v42, v42
    v_exp_f32 v43, v43
    v_exp_f32 v44, v44
    v_exp_f32 v45, v45
    v_exp_f32 v46, v46
    v_exp_f32 v47, v47
    v_exp_f32 v48, v48
    v_exp_f32 v49, v49
    v_exp_f32 v50, v50
    v_exp_f32 v51, v51
    v_exp_f32 v52, v52
    v_exp_f32 v53, v53
    v_exp_f32 v54, v54
    v_exp_f32 v55, v55
    s_nop 0
    v_cvt_pk_bf16_f32 v96, v40, v41
    v_cvt_pk_bf16_f32 v97, v42, v43
    v_cvt_pk_bf16_f32 v98, v44, v45
    v_cvt_pk_bf16_f32 v99, v46, v47
    v_cvt_pk_bf16_f32 v100, v48, v49
    v_cvt_pk_bf16_f32 v101, v50, v51
    v_cvt_pk_bf16_f32 v102, v52, v53
    v_cvt_pk_bf16_f32 v103, v54, v55
    s_nop 1
    v_mfma_f32_32x32x16_bf16 v[8:23], v[144:147], v[96:99], v[8:23]
    v_mfma_f32_32x32x16_bf16 v[8:23], v[148:151], v[100:103], v[8:23]
    s_waitcnt lgkmcnt(8)
    v_mfma_f32_32x32x16_bf16 v[24:39], v[104:107], v[0:3], 0
    v_max3_f32 v174, v56, v57, v58
    v_max3_f32 v175, v59, v60, v61
    v_max3_f32 v174, v174, v62, v63
    v_max3_f32 v175, v175, v64, v65
    v_max3_f32 v174, v174, v66, v67
    v_max3_f32 v175, v175, v68, v69
    v_max3_f32 v174, v174, v70, v71
    v_max3_f32 v175, v175, v72, v73
    v_mfma_f32_32x32x16_bf16 v[24:39], v[108:111], v[4:7], v[24:39]
    v_max3_f32 v174, v174, v74, v75
    v_max3_f32 v175, v175, v76, v77
    v_max3_f32 v174, v174, v78, v79
    v_max3_f32 v175, v175, v80, v81
    v_max3_f32 v174, v174, v82, v83
    v_max3_f32 v175, v175, v84, v85
    v_max3_f32 v174, v174, v86, v87
    v_max_f32 v174, v174, v175
    v_mfma_f32_32x32x16_bf16 v[40:55], v[112:115], v[0:3], 0
    v_mov_b32 v175, v174
    s_nop 1
    v_permlane32_swap_b32 v174, v175
    s_nop 1
    v_max3_f32 v174, v174, v175, v168
    v_mfma_f32_32x32x16_bf16 v[40:55], v[116:119], v[4:7], v[40:55]
    ds_read_b128 v[120:123], v182 offset:36864
    ds_read_b128 v[124:127], v184 offset:36864
    ds_read_b128 v[128:131], v182 offset:38912
    ds_read_b128 v[132:135], v184 offset:38912
    v_sub_f32 v176, v168, v174
    v_mul_f32 v176, s30, v176
    v_exp_f32 v172, v176
    v_mov_b32 v168, v174
    v_mul_f32 v170, s30, v174
    v_sub_f32 v170, 0, v170
    v_mov_b32 v171, v170
    v_mov_b32 v173, v172
    ds_read_b64_tr_b16 v[136:137], v186 offset:32768
    ds_read_b64_tr_b16 v[138:139], v186 offset:33280
    ds_read_b64_tr_b16 v[140:141], v186 offset:33792
    ds_read_b64_tr_b16 v[142:143], v186 offset:34304
    ds_read_b64_tr_b16 v[144:145], v186 offset:34816
    ds_read_b64_tr_b16 v[146:147], v186 offset:35328
    ds_read_b64_tr_b16 v[148:149], v186 offset:35840
    ds_read_b64_tr_b16 v[150:151], v186 offset:36352
    v_pk_fma_f32 v[56:57], v[56:57], s[30:31], v[170:171]
    v_pk_fma_f32 v[58:59], v[58:59], s[30:31], v[170:171]
    v_pk_fma_f32 v[60:61], v[60:61], s[30:31], v[170:171]
    v_pk_fma_f32 v[62:63], v[62:63], s[30:31], v[170:171]
    v_pk_fma_f32 v[64:65], v[64:65], s[30:31], v[170:171]
    v_pk_fma_f32 v[66:67], v[66:67], s[30:31], v[170:171]
    v_pk_fma_f32 v[68:69], v[68:69], s[30:31], v[170:171]
    v_pk_fma_f32 v[70:71], v[70:71], s[30:31], v[170:171]
    v_pk_mul_f32 v[8:9], v[8:9], v[172:173]
    v_pk_mul_f32 v[10:11], v[10:11], v[172:173]
    v_pk_mul_f32 v[12:13], v[12:13], v[172:173]
    v_pk_mul_f32 v[14:15], v[14:15], v[172:173]
    v_pk_mul_f32 v[16:17], v[16:17], v[172:173]
    v_pk_mul_f32 v[18:19], v[18:19], v[172:173]
    v_pk_mul_f32 v[20:21], v[20:21], v[172:173]
    v_pk_mul_f32 v[22:23], v[22:23], v[172:173]
    v_exp_f32 v56, v56
    v_exp_f32 v57, v57
    v_exp_f32 v58, v58
    v_exp_f32 v59, v59
    v_exp_f32 v60, v60
    v_exp_f32 v61, v61
    v_exp_f32 v62, v62
    v_exp_f32 v63, v63
    v_exp_f32 v64, v64
    v_exp_f32 v65, v65
    v_exp_f32 v66, v66
    v_exp_f32 v67, v67
    v_exp_f32 v68, v68
    v_exp_f32 v69, v69
    v_exp_f32 v70, v70
    v_exp_f32 v71, v71
    s_nop 0
    v_cvt_pk_bf16_f32 v88, v56, v57
    v_cvt_pk_bf16_f32 v89, v58, v59
    v_cvt_pk_bf16_f32 v90, v60, v61
    v_cvt_pk_bf16_f32 v91, v62, v63
    v_cvt_pk_bf16_f32 v92, v64, v65
    v_cvt_pk_bf16_f32 v93, v66, v67
    v_cvt_pk_bf16_f32 v94, v68, v69
    v_cvt_pk_bf16_f32 v95, v70, v71
    s_waitcnt lgkmcnt(12)
    s_nop 1
    v_mfma_f32_32x32x16_bf16 v[8:23], v[152:155], v[88:91], v[8:23]
    v_mfma_f32_32x32x16_bf16 v[8:23], v[156:159], v[92:95], v[8:23]
    v_pk_fma_f32 v[72:73], v[72:73], s[30:31], v[170:171]
    v_pk_fma_f32 v[74:75], v[74:75], s[30:31], v[170:171]
    v_pk_fma_f32 v[76:77], v[76:77], s[30:31], v[170:171]
    v_pk_fma_f32 v[78:79], v[78:79], s[30:31], v[170:171]
    v_pk_fma_f32 v[80:81], v[80:81], s[30:31], v[170:171]
    v_pk_fma_f32 v[82:83], v[82:83], s[30:31], v[170:171]
    v_pk_fma_f32 v[84:85], v[84:85], s[30:31], v[170:171]
    v_pk_fma_f32 v[86:87], v[86:87], s[30:31], v[170:171]
    v_exp_f32 v72, v72
    v_exp_f32 v73, v73
    v_exp_f32 v74, v74
    v_exp_f32 v75, v75
    v_exp_f32 v76, v76
    v_exp_f32 v77, v77
    v_exp_f32 v78, v78
    v_exp_f32 v79, v79
    v_exp_f32 v80, v80
    v_exp_f32 v81, v81
    v_exp_f32 v82, v82
    v_exp_f32 v83, v83
    v_exp_f32 v84, v84
    v_exp_f32 v85, v85
    v_exp_f32 v86, v86
    v_exp_f32 v87, v87
    s_nop 0
    v_cvt_pk_bf16_f32 v96, v72, v73
    v_cvt_pk_bf16_f32 v97, v74, v75
    v_cvt_pk_bf16_f32 v98, v76, v77
    v_cvt_pk_bf16_f32 v99, v78, v79
    v_cvt_pk_bf16_f32 v100, v80, v81
    v_cvt_pk_bf16_f32 v101, v82, v83
    v_cvt_pk_bf16_f32 v102, v84, v85
    v_cvt_pk_bf16_f32 v103, v86, v87
    s_nop 1
    v_mfma_f32_32x32x16_bf16 v[8:23], v[160:163], v[96:99], v[8:23]
    v_mfma_f32_32x32x16_bf16 v[8:23], v[164:167], v[100:103], v[8:23]
    s_barrier
    s_add_u32 s25, s26, 0x6000
    s_add_u32 m0, s27, 0x0
    buffer_load_dwordx4 v188, s[8:11], s25 offen lds
    s_add_u32 s25, s26, 0x6400
    s_add_u32 m0, s27, 0x400
    buffer_load_dwordx4 v188, s[8:11], s25 offen lds
    s_add_u32 s25, s26, 0x6800
    s_add_u32 m0, s27, 0x800
    buffer_load_dwordx4 v188, s[8:11], s25 offen lds
    s_add_u32 s25, s26, 0x6c00
    s_add_u32 m0, s27, 0xc00
    buffer_load_dwordx4 v188, s[8:11], s25 offen lds
    s_waitcnt lgkmcnt(8)
    v_mfma_f32_32x32x16_bf16 v[56:71], v[120:123], v[0:3], 0
    v_max3_f32 v174, v24, v25, v26
    v_max3_f32 v175, v27, v28, v29
    v_max3_f32 v174, v174, v30, v31
    v_max3_f32 v175, v175, v32, v33
    v_max3_f32 v174, v174, v34, v35
    v_max3_f32 v175, v175, v36, v37
    v_max3_f32 v174, v174, v38, v39
    v_max3_f32 v175, v175, v40, v41
    v_mfma_f32_32x32x16_bf16 v[56:71], v[124:127], v[4:7], v[56:71]
    v_max3_f32 v174, v174, v42, v43
    v_max3_f32 v175, v175, v44, v45
    v_max3_f32 v174, v174, v46, v47
    v_max3_f32 v175, v175, v48, v49
    v_max3_f32 v174, v174, v50, v51
    v_max3_f32 v175, v175, v52, v53
    v_max3_f32 v174, v174, v54, v55
    v_max_f32 v174, v174, v175
    v_mfma_f32_32x32x16_bf16 v[72:87], v[128:131], v[0:3], 0
    v_mov_b32 v175, v174
    s_nop 1
    v_permlane32_swap_b32 v174, v175
    s_nop 1
    v_max3_f32 v174, v174, v175, v168
    v_mfma_f32_32x32x16_bf16 v[72:87], v[132:135], v[4:7], v[72:87]
    ds_read_b128 v[104:107], v183 offset:0
    ds_read_b128 v[108:111], v185 offset:0
    ds_read_b128 v[112:115], v183 offset:2048
    ds_read_b128 v[116:119], v185 offset:2048
    v_sub_f32 v176, v168, v174
    v_mul_f32 v176, s30, v176
    v_exp_f32 v172, v176
    v_mov_b32 v168, v174
    v_mul_f32 v170, s30, v174
    v_sub_f32 v170, 0, v170
    v_mov_b32 v171, v170
    v_mov_b32 v173, v172
    ds_read_b64_tr_b16 v[152:153], v186 offset:36864
    ds_read_b64_tr_b16 v[154:155], v186 offset:37376
    ds_read_b64_tr_b16 v[156:157], v186 offset:37888
    ds_read_b64_tr_b16 v[158:159], v186 offset:38400
    ds_read_b64_tr_b16 v[160:161], v186 offset:38912
    ds_read_b64_tr_b16 v[162:163], v186 offset:39424
    ds_read_b64_tr_b16 v[164:165], v186 offset:39936
    ds_read_b64_tr_b16 v[166:167], v186 offset:40448
    v_pk_fma_f32 v[24:25], v[24:25], s[30:31], v[170:171]
    v_pk_fma_f32 v[26:27], v[26:27], s[30:31], v[170:171]
    v_pk_fma_f32 v[28:29], v[28:29], s[30:31], v[170:171]
    v_pk_fma_f32 v[30:31], v[30:31], s[30:31], v[170:171]
    v_pk_fma_f32 v[32:33], v[32:33], s[30:31], v[170:171]
    v_pk_fma_f32 v[34:35], v[34:35], s[30:31], v[170:171]
    v_pk_fma_f32 v[36:37], v[36:37], s[30:31], v[170:171]
    v_pk_fma_f32 v[38:39], v[38:39], s[30:31], v[170:171]
    v_pk_mul_f32 v[8:9], v[8:9], v[172:173]
    v_pk_mul_f32 v[10:11], v[10:11], v[172:173]
    v_pk_mul_f32 v[12:13], v[12:13], v[172:173]
    v_pk_mul_f32 v[14:15], v[14:15], v[172:173]
    v_pk_mul_f32 v[16:17], v[16:17], v[172:173]
    v_pk_mul_f32 v[18:19], v[18:19], v[172:173]
    v_pk_mul_f32 v[20:21], v[20:21], v[172:173]
    v_pk_mul_f32 v[22:23], v[22:23], v[172:173]
    v_exp_f32 v24, v24
    v_exp_f32 v25, v25
    v_exp_f32 v26, v26
    v_exp_f32 v27, v27
    v_exp_f32 v28, v28
    v_exp_f32 v29, v29
    v_exp_f32 v30, v30
    v_exp_f32 v31, v31
    v_exp_f32 v32, v32
    v_exp_f32 v33, v33
    v_exp_f32 v34, v34
    v_exp_f32 v35, v35
    v_exp_f32 v36, v36
    v_exp_f32 v37, v37
    v_exp_f32 v38, v38
    v_exp_f32 v39, v39
    s_nop 0
    v_cvt_pk_bf16_f32 v88, v24, v25
    v_cvt_pk_bf16_f32 v89, v26, v27
    v_cvt_pk_bf16_f32 v90, v28, v29
    v_cvt_pk_bf16_f32 v91, v30, v31
    v_cvt_pk_bf16_f32 v92, v32, v33
    v_cvt_pk_bf16_f32 v93, v34, v35
    v_cvt_pk_bf16_f32 v94, v36, v37
    v_cvt_pk_bf16_f32 v95, v38, v39
    s_waitcnt lgkmcnt(12)
    s_nop 1
    v_mfma_f32_32x32x16_bf16 v[8:23], v[136:139], v[88:91], v[8:23]
    v_mfma_f32_32x32x16_bf16 v[8:23], v[140:143], v[92:95], v[8:23]
    v_pk_fma_f32 v[40:41], v[40:41], s[30:31], v[170:171]
    v_pk_fma_f32 v[42:43], v[42:43], s[30:31], v[170:171]
    v_pk_fma_f32 v[44:45], v[44:45], s[30:31], v[170:171]
    v_pk_fma_f32 v[46:47], v[46:47], s[30:31], v[170:171]
    v_pk_fma_f32 v[48:49], v[48:49], s[30:31], v[170:171]
    v_pk_fma_f32 v[50:51], v[50:51], s[30:31], v[170:171]
    v_pk_fma_f32 v[52:53], v[52:53], s[30:31], v[170:171]
    v_pk_fma_f32 v[54:55], v[54:55], s[30:31], v[170:171]
    v_exp_f32 v40, v40
    v_exp_f32 v41, v41
    v_exp_f32 v42, v42
    v_exp_f32 v43, v43
    v_exp_f32 v44, v44
    v_exp_f32 v45, v45
    v_exp_f32 v46, v46
    v_exp_f32 v47, v47
    v_exp_f32 v48, v48
    v_exp_f32 v49, v49
    v_exp_f32 v50, v50
    v_exp_f32 v51, v51
    v_exp_f32 v52, v52
    v_exp_f32 v53, v53
    v_exp_f32 v54, v54
    v_exp_f32 v55, v55
    s_nop 0
    v_cvt_pk_bf16_f32 v96, v40, v41
    v_cvt_pk_bf16_f32 v97, v42, v43
    v_cvt_pk_bf16_f32 v98, v44, v45
    v_cvt_pk_bf16_f32 v99, v46, v47
    v_cvt_pk_bf16_f32 v100, v48, v49
    v_cvt_pk_bf16_f32 v101, v50, v51
    v_cvt_pk_bf16_f32 v102, v52, v53
    v_cvt_pk_bf16_f32 v103, v54, v55
    s_nop 1
    v_mfma_f32_32x32x16_bf16 v[8:23], v[144:147], v[96:99], v[8:23]
    v_mfma_f32_32x32x16_bf16 v[8:23], v[148:151], v[100:103], v[8:23]
    s_waitcnt lgkmcnt(8)
    v_mfma_f32_32x32x16_bf16 v[24:39], v[104:107], v[0:3], 0
    v_max3_f32 v174, v56, v57, v58
    v_max3_f32 v175, v59, v60, v61
    v_max3_f32 v174, v174, v62, v63
    v_max3_f32 v175, v175, v64, v65
    v_max3_f32 v174, v174, v66, v67
    v_max3_f32 v175, v175, v68, v69
    v_max3_f32 v174, v174, v70, v71
    v_max3_f32 v175, v175, v72, v73
    v_mfma_f32_32x32x16_bf16 v[24:39], v[108:111], v[4:7], v[24:39]
    v_max3_f32 v174, v174, v74, v75
    v_max3_f32 v175, v175, v76, v77
    v_max3_f32 v174, v174, v78, v79
    v_max3_f32 v175, v175, v80, v81
    v_max3_f32 v174, v174, v82, v83
    v_max3_f32 v175, v175, v84, v85
    v_max3_f32 v174, v174, v86, v87
    v_max_f32 v174, v174, v175
    v_mfma_f32_32x32x16_bf16 v[40:55], v[112:115], v[0:3], 0
    v_mov_b32 v175, v174
    s_nop 1
    v_permlane32_swap_b32 v174, v175
    s_nop 1
    v_max3_f32 v174, v174, v175, v168
    v_mfma_f32_32x32x16_bf16 v[40:55], v[116:119], v[4:7], v[40:55]
    ds_read_b128 v[120:123], v183 offset:4096
    ds_read_b128 v[124:127], v185 offset:4096
    ds_read_b128 v[128:131], v183 offset:6144
    ds_read_b128 v[132:135], v185 offset:6144
    v_sub_f32 v176, v168, v174
    v_mul_f32 v176, s30, v176
    v_exp_f32 v172, v176
    v_mov_b32 v168, v174
    v_mul_f32 v170, s30, v174
    v_sub_f32 v170, 0, v170
    v_mov_b32 v171, v170
    v_mov_b32 v173, v172
    ds_read_b64_tr_b16 v[136:137], v187 offset:0
    ds_read_b64_tr_b16 v[138:139], v187 offset:512
    ds_read_b64_tr_b16 v[140:141], v187 offset:1024
    ds_read_b64_tr_b16 v[142:143], v187 offset:1536
    ds_read_b64_tr_b16 v[144:145], v187 offset:2048
    ds_read_b64_tr_b16 v[146:147], v187 offset:2560
    ds_read_b64_tr_b16 v[148:149], v187 offset:3072
    ds_read_b64_tr_b16 v[150:151], v187 offset:3584
    v_pk_fma_f32 v[56:57], v[56:57], s[30:31], v[170:171]
    v_pk_fma_f32 v[58:59], v[58:59], s[30:31], v[170:171]
    v_pk_fma_f32 v[60:61], v[60:61], s[30:31], v[170:171]
    v_pk_fma_f32 v[62:63], v[62:63], s[30:31], v[170:171]
    v_pk_fma_f32 v[64:65], v[64:65], s[30:31], v[170:171]
    v_pk_fma_f32 v[66:67], v[66:67], s[30:31], v[170:171]
    v_pk_fma_f32 v[68:69], v[68:69], s[30:31], v[170:171]
    v_pk_fma_f32 v[70:71], v[70:71], s[30:31], v[170:171]
    v_pk_mul_f32 v[8:9], v[8:9], v[172:173]
    v_pk_mul_f32 v[10:11], v[10:11], v[172:173]
    v_pk_mul_f32 v[12:13], v[12:13], v[172:173]
    v_pk_mul_f32 v[14:15], v[14:15], v[172:173]
    v_pk_mul_f32 v[16:17], v[16:17], v[172:173]
    v_pk_mul_f32 v[18:19], v[18:19], v[172:173]
    v_pk_mul_f32 v[20:21], v[20:21], v[172:173]
    v_pk_mul_f32 v[22:23], v[22:23], v[172:173]
    v_exp_f32 v56, v56
    v_exp_f32 v57, v57
    v_exp_f32 v58, v58
    v_exp_f32 v59, v59
    v_exp_f32 v60, v60
    v_exp_f32 v61, v61
    v_exp_f32 v62, v62
    v_exp_f32 v63, v63
    v_exp_f32 v64, v64
    v_exp_f32 v65, v65
    v_exp_f32 v66, v66
    v_exp_f32 v67, v67
    v_exp_f32 v68, v68
    v_exp_f32 v69, v69
    v_exp_f32 v70, v70
    v_exp_f32 v71, v71
    s_nop 0
    v_cvt_pk_bf16_f32 v88, v56, v57
    v_cvt_pk_bf16_f32 v89, v58, v59
    v_cvt_pk_bf16_f32 v90, v60, v61
    v_cvt_pk_bf16_f32 v91, v62, v63
    v_cvt_pk_bf16_f32 v92, v64, v65
    v_cvt_pk_bf16_f32 v93, v66, v67
    v_cvt_pk_bf16_f32 v94, v68, v69
    v_cvt_pk_bf16_f32 v95, v70, v71
    s_waitcnt lgkmcnt(12)
    s_nop 1
    v_mfma_f32_32x32x16_bf16 v[8:23], v[152:155], v[88:91], v[8:23]
    v_mfma_f32_32x32x16_bf16 v[8:23], v[156:159], v[92:95], v[8:23]
    v_pk_fma_f32 v[72:73], v[72:73], s[30:31], v[170:171]
    v_pk_fma_f32 v[74:75], v[74:75], s[30:31], v[170:171]
    v_pk_fma_f32 v[76:77], v[76:77], s[30:31], v[170:171]
    v_pk_fma_f32 v[78:79], v[78:79], s[30:31], v[170:171]
    v_pk_fma_f32 v[80:81], v[80:81], s[30:31], v[170:171]
    v_pk_fma_f32 v[82:83], v[82:83], s[30:31], v[170:171]
    v_pk_fma_f32 v[84:85], v[84:85], s[30:31], v[170:171]
    v_pk_fma_f32 v[86:87], v[86:87], s[30:31], v[170:171]
    v_exp_f32 v72, v72
    v_exp_f32 v73, v73
    v_exp_f32 v74, v74
    v_exp_f32 v75, v75
    v_exp_f32 v76, v76
    v_exp_f32 v77, v77
    v_exp_f32 v78, v78
    v_exp_f32 v79, v79
    v_exp_f32 v80, v80
    v_exp_f32 v81, v81
    v_exp_f32 v82, v82
    v_exp_f32 v83, v83
    v_exp_f32 v84, v84
    v_exp_f32 v85, v85
    v_exp_f32 v86, v86
    v_exp_f32 v87, v87
    s_nop 0
    v_cvt_pk_bf16_f32 v96, v72, v73
    v_cvt_pk_bf16_f32 v97, v74, v75
    v_cvt_pk_bf16_f32 v98, v76, v77
    v_cvt_pk_bf16_f32 v99, v78, v79
    v_cvt_pk_bf16_f32 v100, v80, v81
    v_cvt_pk_bf16_f32 v101, v82, v83
    v_cvt_pk_bf16_f32 v102, v84, v85
    v_cvt_pk_bf16_f32 v103, v86, v87
    s_nop 1
    v_mfma_f32_32x32x16_bf16 v[8:23], v[160:163], v[96:99], v[8:23]
    v_mfma_f32_32x32x16_bf16 v[8:23], v[164:167], v[100:103], v[8:23]
    s_waitcnt vmcnt(0)
    s_barrier
    s_add_u32 s25, s26, 0x8000
    s_add_u32 m0, s27, 0x8000
    buffer_load_dwordx4 v188, s[8:11], s25 offen lds
    s_add_u32 s25, s26, 0x8400
    s_add_u32 m0, s27, 0x8400
    buffer_load_dwordx4 v188, s[8:11], s25 offen lds
    s_add_u32 s25, s26, 0x8800
    s_add_u32 m0, s27, 0x8800
    buffer_load_dwordx4 v188, s[8:11], s25 offen lds
    s_add_u32 s25, s26, 0x8c00
    s_add_u32 m0, s27, 0x8c00
    buffer_load_dwordx4 v188, s[8:11], s25 offen lds
    s_waitcnt lgkmcnt(8)
    v_mfma_f32_32x32x16_bf16 v[56:71], v[120:123], v[0:3], 0
    v_max3_f32 v174, v24, v25, v26
    v_max3_f32 v175, v27, v28, v29
    v_max3_f32 v174, v174, v30, v31
    v_max3_f32 v175, v175, v32, v33
    v_max3_f32 v174, v174, v34, v35
    v_max3_f32 v175, v175, v36, v37
    v_max3_f32 v174, v174, v38, v39
    v_max3_f32 v175, v175, v40, v41
    v_mfma_f32_32x32x16_bf16 v[56:71], v[124:127], v[4:7], v[56:71]
    v_max3_f32 v174, v174, v42, v43
    v_max3_f32 v175, v175, v44, v45
    v_max3_f32 v174, v174, v46, v47
    v_max3_f32 v175, v175, v48, v49
    v_max3_f32 v174, v174, v50, v51
    v_max3_f32 v175, v175, v52, v53
    v_max3_f32 v174, v174, v54, v55
    v_max_f32 v174, v174, v175
    v_mfma_f32_32x32x16_bf16 v[72:87], v[128:131], v[0:3], 0
    v_mov_b32 v175, v174
    s_nop 1
    v_permlane32_swap_b32 v174, v175
    s_nop 1
    v_max3_f32 v174, v174, v175, v168
    v_mfma_f32_32x32x16_bf16 v[72:87], v[132:135], v[4:7], v[72:87]
    ds_read_b128 v[104:107], v182 offset:0
    ds_read_b128 v[108:111], v184 offset:0
    ds_read_b128 v[112:115], v182 offset:2048
    ds_read_b128 v[116:119], v184 offset:2048
    v_sub_f32 v176, v168, v174
    v_mul_f32 v176, s30, v176
    v_exp_f32 v172, v176
    v_mov_b32 v168, v174
    v_mul_f32 v170, s30, v174
    v_sub_f32 v170, 0, v170
    v_mov_b32 v171, v170
    v_mov_b32 v173, v172
    ds_read_b64_tr_b16 v[152:153], v187 offset:4096
    ds_read_b64_tr_b16 v[154:155], v187 offset:4608
    ds_read_b64_tr_b16 v[156:157], v187 offset:5120
    ds_read_b64_tr_b16 v[158:159], v187 offset:5632
    ds_read_b64_tr_b16 v[160:161], v187 offset:6144
    ds_read_b64_tr_b16 v[162:163], v187 offset:6656
    ds_read_b64_tr_b16 v[164:165], v187 offset:7168
    ds_read_b64_tr_b16 v[166:167], v187 offset:7680
    v_pk_fma_f32 v[24:25], v[24:25], s[30:31], v[170:171]
    v_pk_fma_f32 v[26:27], v[26:27], s[30:31], v[170:171]
    v_pk_fma_f32 v[28:29], v[28:29], s[30:31], v[170:171]
    v_pk_fma_f32 v[30:31], v[30:31], s[30:31], v[170:171]
    v_pk_fma_f32 v[32:33], v[32:33], s[30:31], v[170:171]
    v_pk_fma_f32 v[34:35], v[34:35], s[30:31], v[170:171]
    v_pk_fma_f32 v[36:37], v[36:37], s[30:31], v[170:171]
    v_pk_fma_f32 v[38:39], v[38:39], s[30:31], v[170:171]
    v_pk_mul_f32 v[8:9], v[8:9], v[172:173]
    v_pk_mul_f32 v[10:11], v[10:11], v[172:173]
    v_pk_mul_f32 v[12:13], v[12:13], v[172:173]
    v_pk_mul_f32 v[14:15], v[14:15], v[172:173]
    v_pk_mul_f32 v[16:17], v[16:17], v[172:173]
    v_pk_mul_f32 v[18:19], v[18:19], v[172:173]
    v_pk_mul_f32 v[20:21], v[20:21], v[172:173]
    v_pk_mul_f32 v[22:23], v[22:23], v[172:173]
    v_exp_f32 v24, v24
    v_exp_f32 v25, v25
    v_exp_f32 v26, v26
    v_exp_f32 v27, v27
    v_exp_f32 v28, v28
    v_exp_f32 v29, v29
    v_exp_f32 v30, v30
    v_exp_f32 v31, v31
    v_exp_f32 v32, v32
    v_exp_f32 v33, v33
    v_exp_f32 v34, v34
    v_exp_f32 v35, v35
    v_exp_f32 v36, v36
    v_exp_f32 v37, v37
    v_exp_f32 v38, v38
    v_exp_f32 v39, v39
    s_nop 0
    v_cvt_pk_bf16_f32 v88, v24, v25
    v_cvt_pk_bf16_f32 v89, v26, v27
    v_cvt_pk_bf16_f32 v90, v28, v29
    v_cvt_pk_bf16_f32 v91, v30, v31
    v_cvt_pk_bf16_f32 v92, v32, v33
    v_cvt_pk_bf16_f32 v93, v34, v35
    v_cvt_pk_bf16_f32 v94, v36, v37
    v_cvt_pk_bf16_f32 v95, v38, v39
    s_waitcnt lgkmcnt(12)
    s_nop 1
    v_mfma_f32_32x32x16_bf16 v[8:23], v[136:139], v[88:91], v[8:23]
    v_mfma_f32_32x32x16_bf16 v[8:23], v[140:143], v[92:95], v[8:23]
    v_pk_fma_f32 v[40:41], v[40:41], s[30:31], v[170:171]
    v_pk_fma_f32 v[42:43], v[42:43], s[30:31], v[170:171]
    v_pk_fma_f32 v[44:45], v[44:45], s[30:31], v[170:171]
    v_pk_fma_f32 v[46:47], v[46:47], s[30:31], v[170:171]
    v_pk_fma_f32 v[48:49], v[48:49], s[30:31], v[170:171]
    v_pk_fma_f32 v[50:51], v[50:51], s[30:31], v[170:171]
    v_pk_fma_f32 v[52:53], v[52:53], s[30:31], v[170:171]
    v_pk_fma_f32 v[54:55], v[54:55], s[30:31], v[170:171]
    v_exp_f32 v40, v40
    v_exp_f32 v41, v41
    v_exp_f32 v42, v42
    v_exp_f32 v43, v43
    v_exp_f32 v44, v44
    v_exp_f32 v45, v45
    v_exp_f32 v46, v46
    v_exp_f32 v47, v47
    v_exp_f32 v48, v48
    v_exp_f32 v49, v49
    v_exp_f32 v50, v50
    v_exp_f32 v51, v51
    v_exp_f32 v52, v52
    v_exp_f32 v53, v53
    v_exp_f32 v54, v54
    v_exp_f32 v55, v55
    s_nop 0
    v_cvt_pk_bf16_f32 v96, v40, v41
    v_cvt_pk_bf16_f32 v97, v42, v43
    v_cvt_pk_bf16_f32 v98, v44, v45
    v_cvt_pk_bf16_f32 v99, v46, v47
    v_cvt_pk_bf16_f32 v100, v48, v49
    v_cvt_pk_bf16_f32 v101, v50, v51
    v_cvt_pk_bf16_f32 v102, v52, v53
    v_cvt_pk_bf16_f32 v103, v54, v55
    s_nop 1
    v_mfma_f32_32x32x16_bf16 v[8:23], v[144:147], v[96:99], v[8:23]
    v_mfma_f32_32x32x16_bf16 v[8:23], v[148:151], v[100:103], v[8:23]
    s_waitcnt lgkmcnt(8)
    v_mfma_f32_32x32x16_bf16 v[24:39], v[104:107], v[0:3], 0
    v_max3_f32 v174, v56, v57, v58
    v_max3_f32 v175, v59, v60, v61
    v_max3_f32 v174, v174, v62, v63
    v_max3_f32 v175, v175, v64, v65
    v_max3_f32 v174, v174, v66, v67
    v_max3_f32 v175, v175, v68, v69
    v_max3_f32 v174, v174, v70, v71
    v_max3_f32 v175, v175, v72, v73
    v_mfma_f32_32x32x16_bf16 v[24:39], v[108:111], v[4:7], v[24:39]
    v_max3_f32 v174, v174, v74, v75
    v_max3_f32 v175, v175, v76, v77
    v_max3_f32 v174, v174, v78, v79
    v_max3_f32 v175, v175, v80, v81
    v_max3_f32 v174, v174, v82, v83
    v_max3_f32 v175, v175, v84, v85
    v_max3_f32 v174, v174, v86, v87
    v_max_f32 v174, v174, v175
    v_mfma_f32_32x32x16_bf16 v[40:55], v[112:115], v[0:3], 0
    v_mov_b32 v175, v174
    s_nop 1
    v_permlane32_swap_b32 v174, v175
    s_nop 1
    v_max3_f32 v174, v174, v175, v168
    v_mfma_f32_32x32x16_bf16 v[40:55], v[116:119], v[4:7], v[40:55]
    ds_read_b128 v[120:123], v182 offset:4096
    ds_read_b128 v[124:127], v184 offset:4096
    ds_read_b128 v[128:131], v182 offset:6144
    ds_read_b128 v[132:135], v184 offset:6144
    v_sub_f32 v176, v168, v174
    v_mul_f32 v176, s30, v176
    v_exp_f32 v172, v176
    v_mov_b32 v168, v174
    v_mul_f32 v170, s30, v174
    v_sub_f32 v170, 0, v170
    v_mov_b32 v171, v170
    v_mov_b32 v173, v172
    ds_read_b64_tr_b16 v[136:137], v186 offset:0
    ds_read_b64_tr_b16 v[138:139], v186 offset:512
    ds_read_b64_tr_b16 v[140:141], v186 offset:1024
    ds_read_b64_tr_b16 v[142:143], v186 offset:1536
    ds_read_b64_tr_b16 v[144:145], v186 offset:2048
    ds_read_b64_tr_b16 v[146:147], v186 offset:2560
    ds_read_b64_tr_b16 v[148:149], v186 offset:3072
    ds_read_b64_tr_b16 v[150:151], v186 offset:3584
    v_pk_fma_f32 v[56:57], v[56:57], s[30:31], v[170:171]
    v_pk_fma_f32 v[58:59], v[58:59], s[30:31], v[170:171]
    v_pk_fma_f32 v[60:61], v[60:61], s[30:31], v[170:171]
    v_pk_fma_f32 v[62:63], v[62:63], s[30:31], v[170:171]
    v_pk_fma_f32 v[64:65], v[64:65], s[30:31], v[170:171]
    v_pk_fma_f32 v[66:67], v[66:67], s[30:31], v[170:171]
    v_pk_fma_f32 v[68:69], v[68:69], s[30:31], v[170:171]
    v_pk_fma_f32 v[70:71], v[70:71], s[30:31], v[170:171]
    v_pk_mul_f32 v[8:9], v[8:9], v[172:173]
    v_pk_mul_f32 v[10:11], v[10:11], v[172:173]
    v_pk_mul_f32 v[12:13], v[12:13], v[172:173]
    v_pk_mul_f32 v[14:15], v[14:15], v[172:173]
    v_pk_mul_f32 v[16:17], v[16:17], v[172:173]
    v_pk_mul_f32 v[18:19], v[18:19], v[172:173]
    v_pk_mul_f32 v[20:21], v[20:21], v[172:173]
    v_pk_mul_f32 v[22:23], v[22:23], v[172:173]
    v_exp_f32 v56, v56
    v_exp_f32 v57, v57
    v_exp_f32 v58, v58
    v_exp_f32 v59, v59
    v_exp_f32 v60, v60
    v_exp_f32 v61, v61
    v_exp_f32 v62, v62
    v_exp_f32 v63, v63
    v_exp_f32 v64, v64
    v_exp_f32 v65, v65
    v_exp_f32 v66, v66
    v_exp_f32 v67, v67
    v_exp_f32 v68, v68
    v_exp_f32 v69, v69
    v_exp_f32 v70, v70
    v_exp_f32 v71, v71
    s_nop 0
    v_cvt_pk_bf16_f32 v88, v56, v57
    v_cvt_pk_bf16_f32 v89, v58, v59
    v_cvt_pk_bf16_f32 v90, v60, v61
    v_cvt_pk_bf16_f32 v91, v62, v63
    v_cvt_pk_bf16_f32 v92, v64, v65
    v_cvt_pk_bf16_f32 v93, v66, v67
    v_cvt_pk_bf16_f32 v94, v68, v69
    v_cvt_pk_bf16_f32 v95, v70, v71
    s_waitcnt lgkmcnt(12)
    s_nop 1
    v_mfma_f32_32x32x16_bf16 v[8:23], v[152:155], v[88:91], v[8:23]
    v_mfma_f32_32x32x16_bf16 v[8:23], v[156:159], v[92:95], v[8:23]
    v_pk_fma_f32 v[72:73], v[72:73], s[30:31], v[170:171]
    v_pk_fma_f32 v[74:75], v[74:75], s[30:31], v[170:171]
    v_pk_fma_f32 v[76:77], v[76:77], s[30:31], v[170:171]
    v_pk_fma_f32 v[78:79], v[78:79], s[30:31], v[170:171]
    v_pk_fma_f32 v[80:81], v[80:81], s[30:31], v[170:171]
    v_pk_fma_f32 v[82:83], v[82:83], s[30:31], v[170:171]
    v_pk_fma_f32 v[84:85], v[84:85], s[30:31], v[170:171]
    v_pk_fma_f32 v[86:87], v[86:87], s[30:31], v[170:171]
    v_exp_f32 v72, v72
    v_exp_f32 v73, v73
    v_exp_f32 v74, v74
    v_exp_f32 v75, v75
    v_exp_f32 v76, v76
    v_exp_f32 v77, v77
    v_exp_f32 v78, v78
    v_exp_f32 v79, v79
    v_exp_f32 v80, v80
    v_exp_f32 v81, v81
    v_exp_f32 v82, v82
    v_exp_f32 v83, v83
    v_exp_f32 v84, v84
    v_exp_f32 v85, v85
    v_exp_f32 v86, v86
    v_exp_f32 v87, v87
    s_nop 0
    v_cvt_pk_bf16_f32 v96, v72, v73
    v_cvt_pk_bf16_f32 v97, v74, v75
    v_cvt_pk_bf16_f32 v98, v76, v77
    v_cvt_pk_bf16_f32 v99, v78, v79
    v_cvt_pk_bf16_f32 v100, v80, v81
    v_cvt_pk_bf16_f32 v101, v82, v83
    v_cvt_pk_bf16_f32 v102, v84, v85
    v_cvt_pk_bf16_f32 v103, v86, v87
    s_nop 1
    v_mfma_f32_32x32x16_bf16 v[8:23], v[160:163], v[96:99], v[8:23]
    v_mfma_f32_32x32x16_bf16 v[8:23], v[164:167], v[100:103], v[8:23]
    s_waitcnt vmcnt(0)
    s_barrier
    s_add_u32 s25, s26, 0xa000
    s_add_u32 m0, s27, 0x10000
    buffer_load_dwordx4 v188, s[8:11], s25 offen lds
    s_add_u32 s25, s26, 0xa400
    s_add_u32 m0, s27, 0x10400
    buffer_load_dwordx4 v188, s[8:11], s25 offen lds
    s_add_u32 s25, s26, 0xa800
    s_add_u32 m0, s27, 0x10800
    buffer_load_dwordx4 v188, s[8:11], s25 offen lds
    s_add_u32 s25, s26, 0xac00
    s_add_u32 m0, s27, 0x10c00
    buffer_load_dwordx4 v188, s[8:11], s25 offen lds
    s_waitcnt lgkmcnt(8)
    v_mfma_f32_32x32x16_bf16 v[56:71], v[120:123], v[0:3], 0
    v_max3_f32 v174, v24, v25, v26
    v_max3_f32 v175, v27, v28, v29
    v_max3_f32 v174, v174, v30, v31
    v_max3_f32 v175, v175, v32, v33
    v_max3_f32 v174, v174, v34, v35
    v_max3_f32 v175, v175, v36, v37
    v_max3_f32 v174, v174, v38, v39
    v_max3_f32 v175, v175, v40, v41
    v_mfma_f32_32x32x16_bf16 v[56:71], v[124:127], v[4:7], v[56:71]
    v_max3_f32 v174, v174, v42, v43
    v_max3_f32 v175, v175, v44, v45
    v_max3_f32 v174, v174, v46, v47
    v_max3_f32 v175, v175, v48, v49
    v_max3_f32 v174, v174, v50, v51
    v_max3_f32 v175, v175, v52, v53
    v_max3_f32 v174, v174, v54, v55
    v_max_f32 v174, v174, v175
    v_mfma_f32_32x32x16_bf16 v[72:87], v[128:131], v[0:3], 0
    v_mov_b32 v175, v174
    s_nop 1
    v_permlane32_swap_b32 v174, v175
    s_nop 1
    v_max3_f32 v174, v174, v175, v168
    v_mfma_f32_32x32x16_bf16 v[72:87], v[132:135], v[4:7], v[72:87]
    ds_read_b128 v[104:107], v182 offset:32768
    ds_read_b128 v[108:111], v184 offset:32768
    ds_read_b128 v[112:115], v182 offset:34816
    ds_read_b128 v[116:119], v184 offset:34816
    v_sub_f32 v176, v168, v174
    v_mul_f32 v176, s30, v176
    v_exp_f32 v172, v176
    v_mov_b32 v168, v174
    v_mul_f32 v170, s30, v174
    v_sub_f32 v170, 0, v170
    v_mov_b32 v171, v170
    v_mov_b32 v173, v172
    ds_read_b64_tr_b16 v[152:153], v186 offset:4096
    ds_read_b64_tr_b16 v[154:155], v186 offset:4608
    ds_read_b64_tr_b16 v[156:157], v186 offset:5120
    ds_read_b64_tr_b16 v[158:159], v186 offset:5632
    ds_read_b64_tr_b16 v[160:161], v186 offset:6144
    ds_read_b64_tr_b16 v[162:163], v186 offset:6656
    ds_read_b64_tr_b16 v[164:165], v186 offset:7168
    ds_read_b64_tr_b16 v[166:167], v186 offset:7680
    v_pk_fma_f32 v[24:25], v[24:25], s[30:31], v[170:171]
    v_pk_fma_f32 v[26:27], v[26:27], s[30:31], v[170:171]
    v_pk_fma_f32 v[28:29], v[28:29], s[30:31], v[170:171]
    v_pk_fma_f32 v[30:31], v[30:31], s[30:31], v[170:171]
    v_pk_fma_f32 v[32:33], v[32:33], s[30:31], v[170:171]
    v_pk_fma_f32 v[34:35], v[34:35], s[30:31], v[170:171]
    v_pk_fma_f32 v[36:37], v[36:37], s[30:31], v[170:171]
    v_pk_fma_f32 v[38:39], v[38:39], s[30:31], v[170:171]
    v_pk_mul_f32 v[8:9], v[8:9], v[172:173]
    v_pk_mul_f32 v[10:11], v[10:11], v[172:173]
    v_pk_mul_f32 v[12:13], v[12:13], v[172:173]
    v_pk_mul_f32 v[14:15], v[14:15], v[172:173]
    v_pk_mul_f32 v[16:17], v[16:17], v[172:173]
    v_pk_mul_f32 v[18:19], v[18:19], v[172:173]
    v_pk_mul_f32 v[20:21], v[20:21], v[172:173]
    v_pk_mul_f32 v[22:23], v[22:23], v[172:173]
    v_exp_f32 v24, v24
    v_exp_f32 v25, v25
    v_exp_f32 v26, v26
    v_exp_f32 v27, v27
    v_exp_f32 v28, v28
    v_exp_f32 v29, v29
    v_exp_f32 v30, v30
    v_exp_f32 v31, v31
    v_exp_f32 v32, v32
    v_exp_f32 v33, v33
    v_exp_f32 v34, v34
    v_exp_f32 v35, v35
    v_exp_f32 v36, v36
    v_exp_f32 v37, v37
    v_exp_f32 v38, v38
    v_exp_f32 v39, v39
    s_nop 0
    v_cvt_pk_bf16_f32 v88, v24, v25
    v_cvt_pk_bf16_f32 v89, v26, v27
    v_cvt_pk_bf16_f32 v90, v28, v29
    v_cvt_pk_bf16_f32 v91, v30, v31
    v_cvt_pk_bf16_f32 v92, v32, v33
    v_cvt_pk_bf16_f32 v93, v34, v35
    v_cvt_pk_bf16_f32 v94, v36, v37
    v_cvt_pk_bf16_f32 v95, v38, v39
    s_waitcnt lgkmcnt(12)
    s_nop 1
    v_mfma_f32_32x32x16_bf16 v[8:23], v[136:139], v[88:91], v[8:23]
    v_mfma_f32_32x32x16_bf16 v[8:23], v[140:143], v[92:95], v[8:23]
    v_pk_fma_f32 v[40:41], v[40:41], s[30:31], v[170:171]
    v_pk_fma_f32 v[42:43], v[42:43], s[30:31], v[170:171]
    v_pk_fma_f32 v[44:45], v[44:45], s[30:31], v[170:171]
    v_pk_fma_f32 v[46:47], v[46:47], s[30:31], v[170:171]
    v_pk_fma_f32 v[48:49], v[48:49], s[30:31], v[170:171]
    v_pk_fma_f32 v[50:51], v[50:51], s[30:31], v[170:171]
    v_pk_fma_f32 v[52:53], v[52:53], s[30:31], v[170:171]
    v_pk_fma_f32 v[54:55], v[54:55], s[30:31], v[170:171]
    v_exp_f32 v40, v40
    v_exp_f32 v41, v41
    v_exp_f32 v42, v42
    v_exp_f32 v43, v43
    v_exp_f32 v44, v44
    v_exp_f32 v45, v45
    v_exp_f32 v46, v46
    v_exp_f32 v47, v47
    v_exp_f32 v48, v48
    v_exp_f32 v49, v49
    v_exp_f32 v50, v50
    v_exp_f32 v51, v51
    v_exp_f32 v52, v52
    v_exp_f32 v53, v53
    v_exp_f32 v54, v54
    v_exp_f32 v55, v55
    s_nop 0
    v_cvt_pk_bf16_f32 v96, v40, v41
    v_cvt_pk_bf16_f32 v97, v42, v43
    v_cvt_pk_bf16_f32 v98, v44, v45
    v_cvt_pk_bf16_f32 v99, v46, v47
    v_cvt_pk_bf16_f32 v100, v48, v49
    v_cvt_pk_bf16_f32 v101, v50, v51
    v_cvt_pk_bf16_f32 v102, v52, v53
    v_cvt_pk_bf16_f32 v103, v54, v55
    s_nop 1
    v_mfma_f32_32x32x16_bf16 v[8:23], v[144:147], v[96:99], v[8:23]
    v_mfma_f32_32x32x16_bf16 v[8:23], v[148:151], v[100:103], v[8:23]
    s_waitcnt lgkmcnt(8)
    v_mfma_f32_32x32x16_bf16 v[24:39], v[104:107], v[0:3], 0
    v_max3_f32 v174, v56, v57, v58
    v_max3_f32 v175, v59, v60, v61
    v_max3_f32 v174, v174, v62, v63
    v_max3_f32 v175, v175, v64, v65
    v_max3_f32 v174, v174, v66, v67
    v_max3_f32 v175, v175, v68, v69
    v_max3_f32 v174, v174, v70, v71
    v_max3_f32 v175, v175, v72, v73
    v_mfma_f32_32x32x16_bf16 v[24:39], v[108:111], v[4:7], v[24:39]
    v_max3_f32 v174, v174, v74, v75
    v_max3_f32 v175, v175, v76, v77
    v_max3_f32 v174, v174, v78, v79
    v_max3_f32 v175, v175, v80, v81
    v_max3_f32 v174, v174, v82, v83
    v_max3_f32 v175, v175, v84, v85
    v_max3_f32 v174, v174, v86, v87
    v_max_f32 v174, v174, v175
    v_mfma_f32_32x32x16_bf16 v[40:55], v[112:115], v[0:3], 0
    v_mov_b32 v175, v174
    s_nop 1
    v_permlane32_swap_b32 v174, v175
    s_nop 1
    v_max3_f32 v174, v174, v175, v168
    v_mfma_f32_32x32x16_bf16 v[40:55], v[116:119], v[4:7], v[40:55]
    ds_read_b128 v[120:123], v182 offset:36864
    ds_read_b128 v[124:127], v184 offset:36864
    ds_read_b128 v[128:131], v182 offset:38912
    ds_read_b128 v[132:135], v184 offset:38912
    v_sub_f32 v176, v168, v174
    v_mul_f32 v176, s30, v176
    v_exp_f32 v172, v176
    v_mov_b32 v168, v174
    v_mul_f32 v170, s30, v174
    v_sub_f32 v170, 0, v170
    v_mov_b32 v171, v170
    v_mov_b32 v173, v172
    ds_read_b64_tr_b16 v[136:137], v186 offset:32768
    ds_read_b64_tr_b16 v[138:139], v186 offset:33280
    ds_read_b64_tr_b16 v[140:141], v186 offset:33792
    ds_read_b64_tr_b16 v[142:143], v186 offset:34304
    ds_read_b64_tr_b16 v[144:145], v186 offset:34816
    ds_read_b64_tr_b16 v[146:147], v186 offset:35328
    ds_read_b64_tr_b16 v[148:149], v186 offset:35840
    ds_read_b64_tr_b16 v[150:151], v186 offset:36352
    v_pk_fma_f32 v[56:57], v[56:57], s[30:31], v[170:171]
    v_pk_fma_f32 v[58:59], v[58:59], s[30:31], v[170:171]
    v_pk_fma_f32 v[60:61], v[60:61], s[30:31], v[170:171]
    v_pk_fma_f32 v[62:63], v[62:63], s[30:31], v[170:171]
    v_pk_fma_f32 v[64:65], v[64:65], s[30:31], v[170:171]
    v_pk_fma_f32 v[66:67], v[66:67], s[30:31], v[170:171]
    v_pk_fma_f32 v[68:69], v[68:69], s[30:31], v[170:171]
    v_pk_fma_f32 v[70:71], v[70:71], s[30:31], v[170:171]
    v_pk_mul_f32 v[8:9], v[8:9], v[172:173]
    v_pk_mul_f32 v[10:11], v[10:11], v[172:173]
    v_pk_mul_f32 v[12:13], v[12:13], v[172:173]
    v_pk_mul_f32 v[14:15], v[14:15], v[172:173]
    v_pk_mul_f32 v[16:17], v[16:17], v[172:173]
    v_pk_mul_f32 v[18:19], v[18:19], v[172:173]
    v_pk_mul_f32 v[20:21], v[20:21], v[172:173]
    v_pk_mul_f32 v[22:23], v[22:23], v[172:173]
    v_exp_f32 v56, v56
    v_exp_f32 v57, v57
    v_exp_f32 v58, v58
    v_exp_f32 v59, v59
    v_exp_f32 v60, v60
    v_exp_f32 v61, v61
    v_exp_f32 v62, v62
    v_exp_f32 v63, v63
    v_exp_f32 v64, v64
    v_exp_f32 v65, v65
    v_exp_f32 v66, v66
    v_exp_f32 v67, v67
    v_exp_f32 v68, v68
    v_exp_f32 v69, v69
    v_exp_f32 v70, v70
    v_exp_f32 v71, v71
    s_nop 0
    v_cvt_pk_bf16_f32 v88, v56, v57
    v_cvt_pk_bf16_f32 v89, v58, v59
    v_cvt_pk_bf16_f32 v90, v60, v61
    v_cvt_pk_bf16_f32 v91, v62, v63
    v_cvt_pk_bf16_f32 v92, v64, v65
    v_cvt_pk_bf16_f32 v93, v66, v67
    v_cvt_pk_bf16_f32 v94, v68, v69
    v_cvt_pk_bf16_f32 v95, v70, v71
    s_waitcnt lgkmcnt(12)
    s_nop 1
    v_mfma_f32_32x32x16_bf16 v[8:23], v[152:155], v[88:91], v[8:23]
    v_mfma_f32_32x32x16_bf16 v[8:23], v[156:159], v[92:95], v[8:23]
    v_pk_fma_f32 v[72:73], v[72:73], s[30:31], v[170:171]
    v_pk_fma_f32 v[74:75], v[74:75], s[30:31], v[170:171]
    v_pk_fma_f32 v[76:77], v[76:77], s[30:31], v[170:171]
    v_pk_fma_f32 v[78:79], v[78:79], s[30:31], v[170:171]
    v_pk_fma_f32 v[80:81], v[80:81], s[30:31], v[170:171]
    v_pk_fma_f32 v[82:83], v[82:83], s[30:31], v[170:171]
    v_pk_fma_f32 v[84:85], v[84:85], s[30:31], v[170:171]
    v_pk_fma_f32 v[86:87], v[86:87], s[30:31], v[170:171]
    v_exp_f32 v72, v72
    v_exp_f32 v73, v73
    v_exp_f32 v74, v74
    v_exp_f32 v75, v75
    v_exp_f32 v76, v76
    v_exp_f32 v77, v77
    v_exp_f32 v78, v78
    v_exp_f32 v79, v79
    v_exp_f32 v80, v80
    v_exp_f32 v81, v81
    v_exp_f32 v82, v82
    v_exp_f32 v83, v83
    v_exp_f32 v84, v84
    v_exp_f32 v85, v85
    v_exp_f32 v86, v86
    v_exp_f32 v87, v87
    s_nop 0
    v_cvt_pk_bf16_f32 v96, v72, v73
    v_cvt_pk_bf16_f32 v97, v74, v75
    v_cvt_pk_bf16_f32 v98, v76, v77
    v_cvt_pk_bf16_f32 v99, v78, v79
    v_cvt_pk_bf16_f32 v100, v80, v81
    v_cvt_pk_bf16_f32 v101, v82, v83
    v_cvt_pk_bf16_f32 v102, v84, v85
    v_cvt_pk_bf16_f32 v103, v86, v87
    s_nop 1
    v_mfma_f32_32x32x16_bf16 v[8:23], v[160:163], v[96:99], v[8:23]
    v_mfma_f32_32x32x16_bf16 v[8:23], v[164:167], v[100:103], v[8:23]
    s_waitcnt vmcnt(0)
    s_barrier
    s_add_u32 s25, s26, 0xc000
    s_add_u32 m0, s27, 0x0
    buffer_load_dwordx4 v188, s[8:11], s25 offen lds
    s_add_u32 s25, s26, 0xc400
    s_add_u32 m0, s27, 0x400
    buffer_load_dwordx4 v188, s[8:11], s25 offen lds
    s_add_u32 s25, s26, 0xc800
    s_add_u32 m0, s27, 0x800
    buffer_load_dwordx4 v188, s[8:11], s25 offen lds
    s_add_u32 s25, s26, 0xcc00
    s_add_u32 m0, s27, 0xc00
    buffer_load_dwordx4 v188, s[8:11], s25 offen lds
    s_waitcnt lgkmcnt(8)
    v_mfma_f32_32x32x16_bf16 v[56:71], v[120:123], v[0:3], 0
    v_max3_f32 v174, v24, v25, v26
    v_max3_f32 v175, v27, v28, v29
    v_max3_f32 v174, v174, v30, v31
    v_max3_f32 v175, v175, v32, v33
    v_max3_f32 v174, v174, v34, v35
    v_max3_f32 v175, v175, v36, v37
    v_max3_f32 v174, v174, v38, v39
    v_max3_f32 v175, v175, v40, v41
    v_mfma_f32_32x32x16_bf16 v[56:71], v[124:127], v[4:7], v[56:71]
    v_max3_f32 v174, v174, v42, v43
    v_max3_f32 v175, v175, v44, v45
    v_max3_f32 v174, v174, v46, v47
    v_max3_f32 v175, v175, v48, v49
    v_max3_f32 v174, v174, v50, v51
    v_max3_f32 v175, v175, v52, v53
    v_max3_f32 v174, v174, v54, v55
    v_max_f32 v174, v174, v175
    v_mfma_f32_32x32x16_bf16 v[72:87], v[128:131], v[0:3], 0
    v_mov_b32 v175, v174
    s_nop 1
    v_permlane32_swap_b32 v174, v175
    s_nop 1
    v_max3_f32 v174, v174, v175, v168
    v_mfma_f32_32x32x16_bf16 v[72:87], v[132:135], v[4:7], v[72:87]
    ds_read_b128 v[104:107], v183 offset:0
    ds_read_b128 v[108:111], v185 offset:0
    ds_read_b128 v[112:115], v183 offset:2048
    ds_read_b128 v[116:119], v185 offset:2048
    v_sub_f32 v176, v168, v174
    v_mul_f32 v176, s30, v176
    v_exp_f32 v172, v176
    v_mov_b32 v168, v174
    v_mul_f32 v170, s30, v174
    v_sub_f32 v170, 0, v170
    v_mov_b32 v171, v170
    v_mov_b32 v173, v172
    ds_read_b64_tr_b16 v[152:153], v186 offset:36864
    ds_read_b64_tr_b16 v[154:155], v186 offset:37376
    ds_read_b64_tr_b16 v[156:157], v186 offset:37888
    ds_read_b64_tr_b16 v[158:159], v186 offset:38400
    ds_read_b64_tr_b16 v[160:161], v186 offset:38912
    ds_read_b64_tr_b16 v[162:163], v186 offset:39424
    ds_read_b64_tr_b16 v[164:165], v186 offset:39936
    ds_read_b64_tr_b16 v[166:167], v186 offset:40448
    v_pk_fma_f32 v[24:25], v[24:25], s[30:31], v[170:171]
    v_pk_fma_f32 v[26:27], v[26:27], s[30:31], v[170:171]
    v_pk_fma_f32 v[28:29], v[28:29], s[30:31], v[170:171]
    v_pk_fma_f32 v[30:31], v[30:31], s[30:31], v[170:171]
    v_pk_fma_f32 v[32:33], v[32:33], s[30:31], v[170:171]
    v_pk_fma_f32 v[34:35], v[34:35], s[30:31], v[170:171]
    v_pk_fma_f32 v[36:37], v[36:37], s[30:31], v[170:171]
    v_pk_fma_f32 v[38:39], v[38:39], s[30:31], v[170:171]
    v_pk_mul_f32 v[8:9], v[8:9], v[172:173]
    v_pk_mul_f32 v[10:11], v[10:11], v[172:173]
    v_pk_mul_f32 v[12:13], v[12:13], v[172:173]
    v_pk_mul_f32 v[14:15], v[14:15], v[172:173]
    v_pk_mul_f32 v[16:17], v[16:17], v[172:173]
    v_pk_mul_f32 v[18:19], v[18:19], v[172:173]
    v_pk_mul_f32 v[20:21], v[20:21], v[172:173]
    v_pk_mul_f32 v[22:23], v[22:23], v[172:173]
    v_exp_f32 v24, v24
    v_exp_f32 v25, v25
    v_exp_f32 v26, v26
    v_exp_f32 v27, v27
    v_exp_f32 v28, v28
    v_exp_f32 v29, v29
    v_exp_f32 v30, v30
    v_exp_f32 v31, v31
    v_exp_f32 v32, v32
    v_exp_f32 v33, v33
    v_exp_f32 v34, v34
    v_exp_f32 v35, v35
    v_exp_f32 v36, v36
    v_exp_f32 v37, v37
    v_exp_f32 v38, v38
    v_exp_f32 v39, v39
    s_nop 0
    v_cvt_pk_bf16_f32 v88, v24, v25
    v_cvt_pk_bf16_f32 v89, v26, v27
    v_cvt_pk_bf16_f32 v90, v28, v29
    v_cvt_pk_bf16_f32 v91, v30, v31
    v_cvt_pk_bf16_f32 v92, v32, v33
    v_cvt_pk_bf16_f32 v93, v34, v35
    v_cvt_pk_bf16_f32 v94, v36, v37
    v_cvt_pk_bf16_f32 v95, v38, v39
    s_waitcnt lgkmcnt(12)
    s_nop 1
    v_mfma_f32_32x32x16_bf16 v[8:23], v[136:139], v[88:91], v[8:23]
    v_mfma_f32_32x32x16_bf16 v[8:23], v[140:143], v[92:95], v[8:23]
    v_pk_fma_f32 v[40:41], v[40:41], s[30:31], v[170:171]
    v_pk_fma_f32 v[42:43], v[42:43], s[30:31], v[170:171]
    v_pk_fma_f32 v[44:45], v[44:45], s[30:31], v[170:171]
    v_pk_fma_f32 v[46:47], v[46:47], s[30:31], v[170:171]
    v_pk_fma_f32 v[48:49], v[48:49], s[30:31], v[170:171]
    v_pk_fma_f32 v[50:51], v[50:51], s[30:31], v[170:171]
    v_pk_fma_f32 v[52:53], v[52:53], s[30:31], v[170:171]
    v_pk_fma_f32 v[54:55], v[54:55], s[30:31], v[170:171]
    v_exp_f32 v40, v40
    v_exp_f32 v41, v41
    v_exp_f32 v42, v42
    v_exp_f32 v43, v43
    v_exp_f32 v44, v44
    v_exp_f32 v45, v45
    v_exp_f32 v46, v46
    v_exp_f32 v47, v47
    v_exp_f32 v48, v48
    v_exp_f32 v49, v49
    v_exp_f32 v50, v50
    v_exp_f32 v51, v51
    v_exp_f32 v52, v52
    v_exp_f32 v53, v53
    v_exp_f32 v54, v54
    v_exp_f32 v55, v55
    s_nop 0
    v_cvt_pk_bf16_f32 v96, v40, v41
    v_cvt_pk_bf16_f32 v97, v42, v43
    v_cvt_pk_bf16_f32 v98, v44, v45
    v_cvt_pk_bf16_f32 v99, v46, v47
    v_cvt_pk_bf16_f32 v100, v48, v49
    v_cvt_pk_bf16_f32 v101, v50, v51
    v_cvt_pk_bf16_f32 v102, v52, v53
    v_cvt_pk_bf16_f32 v103, v54, v55
    s_nop 1
    v_mfma_f32_32x32x16_bf16 v[8:23], v[144:147], v[96:99], v[8:23]
    v_mfma_f32_32x32x16_bf16 v[8:23], v[148:151], v[100:103], v[8:23]
    s_waitcnt lgkmcnt(8)
    v_mfma_f32_32x32x16_bf16 v[24:39], v[104:107], v[0:3], 0
    v_max3_f32 v174, v56, v57, v58
    v_max3_f32 v175, v59, v60, v61
    v_max3_f32 v174, v174, v62, v63
    v_max3_f32 v175, v175, v64, v65
    v_max3_f32 v174, v174, v66, v67
    v_max3_f32 v175, v175, v68, v69
    v_max3_f32 v174, v174, v70, v71
    v_max3_f32 v175, v175, v72, v73
    v_mfma_f32_32x32x16_bf16 v[24:39], v[108:111], v[4:7], v[24:39]
    v_max3_f32 v174, v174, v74, v75
    v_max3_f32 v175, v175, v76, v77
    v_max3_f32 v174, v174, v78, v79
    v_max3_f32 v175, v175, v80, v81
    v_max3_f32 v174, v174, v82, v83
    v_max3_f32 v175, v175, v84, v85
    v_max3_f32 v174, v174, v86, v87
    v_max_f32 v174, v174, v175
    v_mfma_f32_32x32x16_bf16 v[40:55], v[112:115], v[0:3], 0
    v_mov_b32 v175, v174
    s_nop 1
    v_permlane32_swap_b32 v174, v175
    s_nop 1
    v_max3_f32 v174, v174, v175, v168
    v_mfma_f32_32x32x16_bf16 v[40:55], v[116:119], v[4:7], v[40:55]
    ds_read_b128 v[120:123], v183 offset:4096
    ds_read_b128 v[124:127], v185 offset:4096
    ds_read_b128 v[128:131], v183 offset:6144
    ds_read_b128 v[132:135], v185 offset:6144
    v_sub_f32 v176, v168, v174
    v_mul_f32 v176, s30, v176
    v_exp_f32 v172, v176
    v_mov_b32 v168, v174
    v_mul_f32 v170, s30, v174
    v_sub_f32 v170, 0, v170
    v_mov_b32 v171, v170
    v_mov_b32 v173, v172
    ds_read_b64_tr_b16 v[136:137], v187 offset:0
    ds_read_b64_tr_b16 v[138:139], v187 offset:512
    ds_read_b64_tr_b16 v[140:141], v187 offset:1024
    ds_read_b64_tr_b16 v[142:143], v187 offset:1536
    ds_read_b64_tr_b16 v[144:145], v187 offset:2048
    ds_read_b64_tr_b16 v[146:147], v187 offset:2560
    ds_read_b64_tr_b16 v[148:149], v187 offset:3072
    ds_read_b64_tr_b16 v[150:151], v187 offset:3584
    v_pk_fma_f32 v[56:57], v[56:57], s[30:31], v[170:171]
    v_pk_fma_f32 v[58:59], v[58:59], s[30:31], v[170:171]
    v_pk_fma_f32 v[60:61], v[60:61], s[30:31], v[170:171]
    v_pk_fma_f32 v[62:63], v[62:63], s[30:31], v[170:171]
    v_pk_fma_f32 v[64:65], v[64:65], s[30:31], v[170:171]
    v_pk_fma_f32 v[66:67], v[66:67], s[30:31], v[170:171]
    v_pk_fma_f32 v[68:69], v[68:69], s[30:31], v[170:171]
    v_pk_fma_f32 v[70:71], v[70:71], s[30:31], v[170:171]
    v_pk_mul_f32 v[8:9], v[8:9], v[172:173]
    v_pk_mul_f32 v[10:11], v[10:11], v[172:173]
    v_pk_mul_f32 v[12:13], v[12:13], v[172:173]
    v_pk_mul_f32 v[14:15], v[14:15], v[172:173]
    v_pk_mul_f32 v[16:17], v[16:17], v[172:173]
    v_pk_mul_f32 v[18:19], v[18:19], v[172:173]
    v_pk_mul_f32 v[20:21], v[20:21], v[172:173]
    v_pk_mul_f32 v[22:23], v[22:23], v[172:173]
    v_exp_f32 v56, v56
    v_exp_f32 v57, v57
    v_exp_f32 v58, v58
    v_exp_f32 v59, v59
    v_exp_f32 v60, v60
    v_exp_f32 v61, v61
    v_exp_f32 v62, v62
    v_exp_f32 v63, v63
    v_exp_f32 v64, v64
    v_exp_f32 v65, v65
    v_exp_f32 v66, v66
    v_exp_f32 v67, v67
    v_exp_f32 v68, v68
    v_exp_f32 v69, v69
    v_exp_f32 v70, v70
    v_exp_f32 v71, v71
    s_nop 0
    v_cvt_pk_bf16_f32 v88, v56, v57
    v_cvt_pk_bf16_f32 v89, v58, v59
    v_cvt_pk_bf16_f32 v90, v60, v61
    v_cvt_pk_bf16_f32 v91, v62, v63
    v_cvt_pk_bf16_f32 v92, v64, v65
    v_cvt_pk_bf16_f32 v93, v66, v67
    v_cvt_pk_bf16_f32 v94, v68, v69
    v_cvt_pk_bf16_f32 v95, v70, v71
    s_waitcnt lgkmcnt(12)
    s_nop 1
    v_mfma_f32_32x32x16_bf16 v[8:23], v[152:155], v[88:91], v[8:23]
    v_mfma_f32_32x32x16_bf16 v[8:23], v[156:159], v[92:95], v[8:23]
    v_pk_fma_f32 v[72:73], v[72:73], s[30:31], v[170:171]
    v_pk_fma_f32 v[74:75], v[74:75], s[30:31], v[170:171]
    v_pk_fma_f32 v[76:77], v[76:77], s[30:31], v[170:171]
    v_pk_fma_f32 v[78:79], v[78:79], s[30:31], v[170:171]
    v_pk_fma_f32 v[80:81], v[80:81], s[30:31], v[170:171]
    v_pk_fma_f32 v[82:83], v[82:83], s[30:31], v[170:171]
    v_pk_fma_f32 v[84:85], v[84:85], s[30:31], v[170:171]
    v_pk_fma_f32 v[86:87], v[86:87], s[30:31], v[170:171]
    v_exp_f32 v72, v72
    v_exp_f32 v73, v73
    v_exp_f32 v74, v74
    v_exp_f32 v75, v75
    v_exp_f32 v76, v76
    v_exp_f32 v77, v77
    v_exp_f32 v78, v78
    v_exp_f32 v79, v79
    v_exp_f32 v80, v80
    v_exp_f32 v81, v81
    v_exp_f32 v82, v82
    v_exp_f32 v83, v83
    v_exp_f32 v84, v84
    v_exp_f32 v85, v85
    v_exp_f32 v86, v86
    v_exp_f32 v87, v87
    s_nop 0
    v_cvt_pk_bf16_f32 v96, v72, v73
    v_cvt_pk_bf16_f32 v97, v74, v75
    v_cvt_pk_bf16_f32 v98, v76, v77
    v_cvt_pk_bf16_f32 v99, v78, v79
    v_cvt_pk_bf16_f32 v100, v80, v81
    v_cvt_pk_bf16_f32 v101, v82, v83
    v_cvt_pk_bf16_f32 v102, v84, v85
    v_cvt_pk_bf16_f32 v103, v86, v87
    s_nop 1
    v_mfma_f32_32x32x16_bf16 v[8:23], v[160:163], v[96:99], v[8:23]
    v_mfma_f32_32x32x16_bf16 v[8:23], v[164:167], v[100:103], v[8:23]
    s_waitcnt vmcnt(0)
    s_barrier
    s_add_u32 s25, s26, 0xe000
    s_add_u32 m0, s27, 0x8000
    buffer_load_dwordx4 v188, s[8:11], s25 offen lds
    s_add_u32 s25, s26, 0xe400
    s_add_u32 m0, s27, 0x8400
    buffer_load_dwordx4 v188, s[8:11], s25 offen lds
    s_add_u32 s25, s26, 0xe800
    s_add_u32 m0, s27, 0x8800
    buffer_load_dwordx4 v188, s[8:11], s25 offen lds
    s_add_u32 s25, s26, 0xec00
    s_add_u32 m0, s27, 0x8c00
    buffer_load_dwordx4 v188, s[8:11], s25 offen lds
    s_waitcnt lgkmcnt(8)
    v_mfma_f32_32x32x16_bf16 v[56:71], v[120:123], v[0:3], 0
    v_max3_f32 v174, v24, v25, v26
    v_max3_f32 v175, v27, v28, v29
    v_max3_f32 v174, v174, v30, v31
    v_max3_f32 v175, v175, v32, v33
    v_max3_f32 v174, v174, v34, v35
    v_max3_f32 v175, v175, v36, v37
    v_max3_f32 v174, v174, v38, v39
    v_max3_f32 v175, v175, v40, v41
    v_mfma_f32_32x32x16_bf16 v[56:71], v[124:127], v[4:7], v[56:71]
    v_max3_f32 v174, v174, v42, v43
    v_max3_f32 v175, v175, v44, v45
    v_max3_f32 v174, v174, v46, v47
    v_max3_f32 v175, v175, v48, v49
    v_max3_f32 v174, v174, v50, v51
    v_max3_f32 v175, v175, v52, v53
    v_max3_f32 v174, v174, v54, v55
    v_max_f32 v174, v174, v175
    v_mfma_f32_32x32x16_bf16 v[72:87], v[128:131], v[0:3], 0
    v_mov_b32 v175, v174
    s_nop 1
    v_permlane32_swap_b32 v174, v175
    s_nop 1
    v_max3_f32 v174, v174, v175, v168
    v_mfma_f32_32x32x16_bf16 v[72:87], v[132:135], v[4:7], v[72:87]
    ds_read_b128 v[104:107], v182 offset:0
    ds_read_b128 v[108:111], v184 offset:0
    ds_read_b128 v[112:115], v182 offset:2048
    ds_read_b128 v[116:119], v184 offset:2048
    v_sub_f32 v176, v168, v174
    v_mul_f32 v176, s30, v176
    v_exp_f32 v172, v176
    v_mov_b32 v168, v174
    v_mul_f32 v170, s30, v174
    v_sub_f32 v170, 0, v170
    v_mov_b32 v171, v170
    v_mov_b32 v173, v172
    ds_read_b64_tr_b16 v[152:153], v187 offset:4096
    ds_read_b64_tr_b16 v[154:155], v187 offset:4608
    ds_read_b64_tr_b16 v[156:157], v187 offset:5120
    ds_read_b64_tr_b16 v[158:159], v187 offset:5632
    ds_read_b64_tr_b16 v[160:161], v187 offset:6144
    ds_read_b64_tr_b16 v[162:163], v187 offset:6656
    ds_read_b64_tr_b16 v[164:165], v187 offset:7168
    ds_read_b64_tr_b16 v[166:167], v187 offset:7680
    v_pk_fma_f32 v[24:25], v[24:25], s[30:31], v[170:171]
    v_pk_fma_f32 v[26:27], v[26:27], s[30:31], v[170:171]
    v_pk_fma_f32 v[28:29], v[28:29], s[30:31], v[170:171]
    v_pk_fma_f32 v[30:31], v[30:31], s[30:31], v[170:171]
    v_pk_fma_f32 v[32:33], v[32:33], s[30:31], v[170:171]
    v_pk_fma_f32 v[34:35], v[34:35], s[30:31], v[170:171]
    v_pk_fma_f32 v[36:37], v[36:37], s[30:31], v[170:171]
    v_pk_fma_f32 v[38:39], v[38:39], s[30:31], v[170:171]
    v_pk_mul_f32 v[8:9], v[8:9], v[172:173]
    v_pk_mul_f32 v[10:11], v[10:11], v[172:173]
    v_pk_mul_f32 v[12:13], v[12:13], v[172:173]
    v_pk_mul_f32 v[14:15], v[14:15], v[172:173]
    v_pk_mul_f32 v[16:17], v[16:17], v[172:173]
    v_pk_mul_f32 v[18:19], v[18:19], v[172:173]
    v_pk_mul_f32 v[20:21], v[20:21], v[172:173]
    v_pk_mul_f32 v[22:23], v[22:23], v[172:173]
    v_exp_f32 v24, v24
    v_exp_f32 v25, v25
    v_exp_f32 v26, v26
    v_exp_f32 v27, v27
    v_exp_f32 v28, v28
    v_exp_f32 v29, v29
    v_exp_f32 v30, v30
    v_exp_f32 v31, v31
    v_exp_f32 v32, v32
    v_exp_f32 v33, v33
    v_exp_f32 v34, v34
    v_exp_f32 v35, v35
    v_exp_f32 v36, v36
    v_exp_f32 v37, v37
    v_exp_f32 v38, v38
    v_exp_f32 v39, v39
    s_nop 0
    v_cvt_pk_bf16_f32 v88, v24, v25
    v_cvt_pk_bf16_f32 v89, v26, v27
    v_cvt_pk_bf16_f32 v90, v28, v29
    v_cvt_pk_bf16_f32 v91, v30, v31
    v_cvt_pk_bf16_f32 v92, v32, v33
    v_cvt_pk_bf16_f32 v93, v34, v35
    v_cvt_pk_bf16_f32 v94, v36, v37
    v_cvt_pk_bf16_f32 v95, v38, v39
    s_waitcnt lgkmcnt(12)
    s_nop 1
    v_mfma_f32_32x32x16_bf16 v[8:23], v[136:139], v[88:91], v[8:23]
    v_mfma_f32_32x32x16_bf16 v[8:23], v[140:143], v[92:95], v[8:23]
    v_pk_fma_f32 v[40:41], v[40:41], s[30:31], v[170:171]
    v_pk_fma_f32 v[42:43], v[42:43], s[30:31], v[170:171]
    v_pk_fma_f32 v[44:45], v[44:45], s[30:31], v[170:171]
    v_pk_fma_f32 v[46:47], v[46:47], s[30:31], v[170:171]
    v_pk_fma_f32 v[48:49], v[48:49], s[30:31], v[170:171]
    v_pk_fma_f32 v[50:51], v[50:51], s[30:31], v[170:171]
    v_pk_fma_f32 v[52:53], v[52:53], s[30:31], v[170:171]
    v_pk_fma_f32 v[54:55], v[54:55], s[30:31], v[170:171]
    v_exp_f32 v40, v40
    v_exp_f32 v41, v41
    v_exp_f32 v42, v42
    v_exp_f32 v43, v43
    v_exp_f32 v44, v44
    v_exp_f32 v45, v45
    v_exp_f32 v46, v46
    v_exp_f32 v47, v47
    v_exp_f32 v48, v48
    v_exp_f32 v49, v49
    v_exp_f32 v50, v50
    v_exp_f32 v51, v51
    v_exp_f32 v52, v52
    v_exp_f32 v53, v53
    v_exp_f32 v54, v54
    v_exp_f32 v55, v55
    s_nop 0
    v_cvt_pk_bf16_f32 v96, v40, v41
    v_cvt_pk_bf16_f32 v97, v42, v43
    v_cvt_pk_bf16_f32 v98, v44, v45
    v_cvt_pk_bf16_f32 v99, v46, v47
    v_cvt_pk_bf16_f32 v100, v48, v49
    v_cvt_pk_bf16_f32 v101, v50, v51
    v_cvt_pk_bf16_f32 v102, v52, v53
    v_cvt_pk_bf16_f32 v103, v54, v55
    s_nop 1
    v_mfma_f32_32x32x16_bf16 v[8:23], v[144:147], v[96:99], v[8:23]
    v_mfma_f32_32x32x16_bf16 v[8:23], v[148:151], v[100:103], v[8:23]
    s_waitcnt lgkmcnt(8)
    v_mfma_f32_32x32x16_bf16 v[24:39], v[104:107], v[0:3], 0
    v_max3_f32 v174, v56, v57, v58
    v_max3_f32 v175, v59, v60, v61
    v_max3_f32 v174, v174, v62, v63
    v_max3_f32 v175, v175, v64, v65
    v_max3_f32 v174, v174, v66, v67
    v_max3_f32 v175, v175, v68, v69
    v_max3_f32 v174, v174, v70, v71
    v_max3_f32 v175, v175, v72, v73
    v_mfma_f32_32x32x16_bf16 v[24:39], v[108:111], v[4:7], v[24:39]
    v_max3_f32 v174, v174, v74, v75
    v_max3_f32 v175, v175, v76, v77
    v_max3_f32 v174, v174, v78, v79
    v_max3_f32 v175, v175, v80, v81
    v_max3_f32 v174, v174, v82, v83
    v_max3_f32 v175, v175, v84, v85
    v_max3_f32 v174, v174, v86, v87
    v_max_f32 v174, v174, v175
    v_mfma_f32_32x32x16_bf16 v[40:55], v[112:115], v[0:3], 0
    v_mov_b32 v175, v174
    s_nop 1
    v_permlane32_swap_b32 v174, v175
    s_nop 1
    v_max3_f32 v174, v174, v175, v168
    v_mfma_f32_32x32x16_bf16 v[40:55], v[116:119], v[4:7], v[40:55]
    ds_read_b128 v[120:123], v182 offset:4096
    ds_read_b128 v[124:127], v184 offset:4096
    ds_read_b128 v[128:131], v182 offset:6144
    ds_read_b128 v[132:135], v184 offset:6144
    v_sub_f32 v176, v168, v174
    v_mul_f32 v176, s30, v176
    v_exp_f32 v172, v176
    v_mov_b32 v168, v174
    v_mul_f32 v170, s30, v174
    v_sub_f32 v170, 0, v170
    v_mov_b32 v171, v170
    v_mov_b32 v173, v172
    ds_read_b64_tr_b16 v[136:137], v186 offset:0
    ds_read_b64_tr_b16 v[138:139], v186 offset:512
    ds_read_b64_tr_b16 v[140:141], v186 offset:1024
    ds_read_b64_tr_b16 v[142:143], v186 offset:1536
    ds_read_b64_tr_b16 v[144:145], v186 offset:2048
    ds_read_b64_tr_b16 v[146:147], v186 offset:2560
    ds_read_b64_tr_b16 v[148:149], v186 offset:3072
    ds_read_b64_tr_b16 v[150:151], v186 offset:3584
    v_pk_fma_f32 v[56:57], v[56:57], s[30:31], v[170:171]
    v_pk_fma_f32 v[58:59], v[58:59], s[30:31], v[170:171]
    v_pk_fma_f32 v[60:61], v[60:61], s[30:31], v[170:171]
    v_pk_fma_f32 v[62:63], v[62:63], s[30:31], v[170:171]
    v_pk_fma_f32 v[64:65], v[64:65], s[30:31], v[170:171]
    v_pk_fma_f32 v[66:67], v[66:67], s[30:31], v[170:171]
    v_pk_fma_f32 v[68:69], v[68:69], s[30:31], v[170:171]
    v_pk_fma_f32 v[70:71], v[70:71], s[30:31], v[170:171]
    v_pk_mul_f32 v[8:9], v[8:9], v[172:173]
    v_pk_mul_f32 v[10:11], v[10:11], v[172:173]
    v_pk_mul_f32 v[12:13], v[12:13], v[172:173]
    v_pk_mul_f32 v[14:15], v[14:15], v[172:173]
    v_pk_mul_f32 v[16:17], v[16:17], v[172:173]
    v_pk_mul_f32 v[18:19], v[18:19], v[172:173]
    v_pk_mul_f32 v[20:21], v[20:21], v[172:173]
    v_pk_mul_f32 v[22:23], v[22:23], v[172:173]
    v_exp_f32 v56, v56
    v_exp_f32 v57, v57
    v_exp_f32 v58, v58
    v_exp_f32 v59, v59
    v_exp_f32 v60, v60
    v_exp_f32 v61, v61
    v_exp_f32 v62, v62
    v_exp_f32 v63, v63
    v_exp_f32 v64, v64
    v_exp_f32 v65, v65
    v_exp_f32 v66, v66
    v_exp_f32 v67, v67
    v_exp_f32 v68, v68
    v_exp_f32 v69, v69
    v_exp_f32 v70, v70
    v_exp_f32 v71, v71
    s_nop 0
    v_cvt_pk_bf16_f32 v88, v56, v57
    v_cvt_pk_bf16_f32 v89, v58, v59
    v_cvt_pk_bf16_f32 v90, v60, v61
    v_cvt_pk_bf16_f32 v91, v62, v63
    v_cvt_pk_bf16_f32 v92, v64, v65
    v_cvt_pk_bf16_f32 v93, v66, v67
    v_cvt_pk_bf16_f32 v94, v68, v69
    v_cvt_pk_bf16_f32 v95, v70, v71
    s_waitcnt lgkmcnt(12)
    s_nop 1
    v_mfma_f32_32x32x16_bf16 v[8:23], v[152:155], v[88:91], v[8:23]
    v_mfma_f32_32x32x16_bf16 v[8:23], v[156:159], v[92:95], v[8:23]
    v_pk_fma_f32 v[72:73], v[72:73], s[30:31], v[170:171]
    v_pk_fma_f32 v[74:75], v[74:75], s[30:31], v[170:171]
    v_pk_fma_f32 v[76:77], v[76:77], s[30:31], v[170:171]
    v_pk_fma_f32 v[78:79], v[78:79], s[30:31], v[170:171]
    v_pk_fma_f32 v[80:81], v[80:81], s[30:31], v[170:171]
    v_pk_fma_f32 v[82:83], v[82:83], s[30:31], v[170:171]
    v_pk_fma_f32 v[84:85], v[84:85], s[30:31], v[170:171]
    v_pk_fma_f32 v[86:87], v[86:87], s[30:31], v[170:171]
    v_exp_f32 v72, v72
    v_exp_f32 v73, v73
    v_exp_f32 v74, v74
    v_exp_f32 v75, v75
    v_exp_f32 v76, v76
    v_exp_f32 v77, v77
    v_exp_f32 v78, v78
    v_exp_f32 v79, v79
    v_exp_f32 v80, v80
    v_exp_f32 v81, v81
    v_exp_f32 v82, v82
    v_exp_f32 v83, v83
    v_exp_f32 v84, v84
    v_exp_f32 v85, v85
    v_exp_f32 v86, v86
    v_exp_f32 v87, v87
    s_nop 0
    v_cvt_pk_bf16_f32 v96, v72, v73
    v_cvt_pk_bf16_f32 v97, v74, v75
    v_cvt_pk_bf16_f32 v98, v76, v77
    v_cvt_pk_bf16_f32 v99, v78, v79
    v_cvt_pk_bf16_f32 v100, v80, v81
    v_cvt_pk_bf16_f32 v101, v82, v83
    v_cvt_pk_bf16_f32 v102, v84, v85
    v_cvt_pk_bf16_f32 v103, v86, v87
    s_nop 1
    v_mfma_f32_32x32x16_bf16 v[8:23], v[160:163], v[96:99], v[8:23]
    v_mfma_f32_32x32x16_bf16 v[8:23], v[164:167], v[100:103], v[8:23]
    s_waitcnt vmcnt(0)
    s_barrier
    s_waitcnt lgkmcnt(8)
    v_mfma_f32_32x32x16_bf16 v[56:71], v[120:123], v[0:3], 0
    v_max3_f32 v174, v24, v25, v26
    v_max3_f32 v175, v27, v28, v29
    v_max3_f32 v174, v174, v30, v31
    v_max3_f32 v175, v175, v32, v33
    v_max3_f32 v174, v174, v34, v35
    v_max3_f32 v175, v175, v36, v37
    v_max3_f32 v174, v174, v38, v39
    v_max3_f32 v175, v175, v40, v41
    v_mfma_f32_32x32x16_bf16 v[56:71], v[124:127], v[4:7], v[56:71]
    v_max3_f32 v174, v174, v42, v43
    v_max3_f32 v175, v175, v44, v45
    v_max3_f32 v174, v174, v46, v47
    v_max3_f32 v175, v175, v48, v49
    v_max3_f32 v174, v174, v50, v51
    v_max3_f32 v175, v175, v52, v53
    v_max3_f32 v174, v174, v54, v55
    v_max_f32 v174, v174, v175
    v_mfma_f32_32x32x16_bf16 v[72:87], v[128:131], v[0:3], 0
    v_mov_b32 v175, v174
    s_nop 1
    v_permlane32_swap_b32 v174, v175
    s_nop 1
    v_max3_f32 v174, v174, v175, v168
    v_mfma_f32_32x32x16_bf16 v[72:87], v[132:135], v[4:7], v[72:87]
    ds_read_b128 v[104:107], v182 offset:32768
    ds_read_b128 v[108:111], v184 offset:32768
    ds_read_b128 v[112:115], v182 offset:34816
    ds_read_b128 v[116:119], v184 offset:34816
    v_sub_f32 v176, v168, v174
    v_mul_f32 v176, s30, v176
    v_exp_f32 v172, v176
    v_mov_b32 v168, v174
    v_mul_f32 v170, s30, v174
    v_sub_f32 v170, 0, v170
    v_mov_b32 v171, v170
    v_mov_b32 v173, v172
    ds_read_b64_tr_b16 v[152:153], v186 offset:4096
    ds_read_b64_tr_b16 v[154:155], v186 offset:4608
    ds_read_b64_tr_b16 v[156:157], v186 offset:5120
    ds_read_b64_tr_b16 v[158:159], v186 offset:5632
    ds_read_b64_tr_b16 v[160:161], v186 offset:6144
    ds_read_b64_tr_b16 v[162:163], v186 offset:6656
    ds_read_b64_tr_b16 v[164:165], v186 offset:7168
    ds_read_b64_tr_b16 v[166:167], v186 offset:7680
    v_pk_fma_f32 v[24:25], v[24:25], s[30:31], v[170:171]
    v_pk_fma_f32 v[26:27], v[26:27], s[30:31], v[170:171]
    v_pk_fma_f32 v[28:29], v[28:29], s[30:31], v[170:171]
    v_pk_fma_f32 v[30:31], v[30:31], s[30:31], v[170:171]
    v_pk_fma_f32 v[32:33], v[32:33], s[30:31], v[170:171]
    v_pk_fma_f32 v[34:35], v[34:35], s[30:31], v[170:171]
    v_pk_fma_f32 v[36:37], v[36:37], s[30:31], v[170:171]
    v_pk_fma_f32 v[38:39], v[38:39], s[30:31], v[170:171]
    v_pk_mul_f32 v[8:9], v[8:9], v[172:173]
    v_pk_mul_f32 v[10:11], v[10:11], v[172:173]
    v_pk_mul_f32 v[12:13], v[12:13], v[172:173]
    v_pk_mul_f32 v[14:15], v[14:15], v[172:173]
    v_pk_mul_f32 v[16:17], v[16:17], v[172:173]
    v_pk_mul_f32 v[18:19], v[18:19], v[172:173]
    v_pk_mul_f32 v[20:21], v[20:21], v[172:173]
    v_pk_mul_f32 v[22:23], v[22:23], v[172:173]
    v_exp_f32 v24, v24
    v_exp_f32 v25, v25
    v_exp_f32 v26, v26
    v_exp_f32 v27, v27
    v_exp_f32 v28, v28
    v_exp_f32 v29, v29
    v_exp_f32 v30, v30
    v_exp_f32 v31, v31
    v_exp_f32 v32, v32
    v_exp_f32 v33, v33
    v_exp_f32 v34, v34
    v_exp_f32 v35, v35
    v_exp_f32 v36, v36
    v_exp_f32 v37, v37
    v_exp_f32 v38, v38
    v_exp_f32 v39, v39
    s_nop 0
    v_cvt_pk_bf16_f32 v88, v24, v25
    v_cvt_pk_bf16_f32 v89, v26, v27
    v_cvt_pk_bf16_f32 v90, v28, v29
    v_cvt_pk_bf16_f32 v91, v30, v31
    v_cvt_pk_bf16_f32 v92, v32, v33
    v_cvt_pk_bf16_f32 v93, v34, v35
    v_cvt_pk_bf16_f32 v94, v36, v37
    v_cvt_pk_bf16_f32 v95, v38, v39
    s_waitcnt lgkmcnt(12)
    s_nop 1
    v_mfma_f32_32x32x16_bf16 v[8:23], v[136:139], v[88:91], v[8:23]
    v_mfma_f32_32x32x16_bf16 v[8:23], v[140:143], v[92:95], v[8:23]
    v_pk_fma_f32 v[40:41], v[40:41], s[30:31], v[170:171]
    v_pk_fma_f32 v[42:43], v[42:43], s[30:31], v[170:171]
    v_pk_fma_f32 v[44:45], v[44:45], s[30:31], v[170:171]
    v_pk_fma_f32 v[46:47], v[46:47], s[30:31], v[170:171]
    v_pk_fma_f32 v[48:49], v[48:49], s[30:31], v[170:171]
    v_pk_fma_f32 v[50:51], v[50:51], s[30:31], v[170:171]
    v_pk_fma_f32 v[52:53], v[52:53], s[30:31], v[170:171]
    v_pk_fma_f32 v[54:55], v[54:55], s[30:31], v[170:171]
    v_exp_f32 v40, v40
    v_exp_f32 v41, v41
    v_exp_f32 v42, v42
    v_exp_f32 v43, v43
    v_exp_f32 v44, v44
    v_exp_f32 v45, v45
    v_exp_f32 v46, v46
    v_exp_f32 v47, v47
    v_exp_f32 v48, v48
    v_exp_f32 v49, v49
    v_exp_f32 v50, v50
    v_exp_f32 v51, v51
    v_exp_f32 v52, v52
    v_exp_f32 v53, v53
    v_exp_f32 v54, v54
    v_exp_f32 v55, v55
    s_nop 0
    v_cvt_pk_bf16_f32 v96, v40, v41
    v_cvt_pk_bf16_f32 v97, v42, v43
    v_cvt_pk_bf16_f32 v98, v44, v45
    v_cvt_pk_bf16_f32 v99, v46, v47
    v_cvt_pk_bf16_f32 v100, v48, v49
    v_cvt_pk_bf16_f32 v101, v50, v51
    v_cvt_pk_bf16_f32 v102, v52, v53
    v_cvt_pk_bf16_f32 v103, v54, v55
    s_nop 1
    v_mfma_f32_32x32x16_bf16 v[8:23], v[144:147], v[96:99], v[8:23]
    v_mfma_f32_32x32x16_bf16 v[8:23], v[148:151], v[100:103], v[8:23]
    s_waitcnt lgkmcnt(8)
    v_mfma_f32_32x32x16_bf16 v[24:39], v[104:107], v[0:3], 0
    v_max3_f32 v174, v56, v57, v58
    v_max3_f32 v175, v59, v60, v61
    v_max3_f32 v174, v174, v62, v63
    v_max3_f32 v175, v175, v64, v65
    v_max3_f32 v174, v174, v66, v67
    v_max3_f32 v175, v175, v68, v69
    v_max3_f32 v174, v174, v70, v71
    v_max3_f32 v175, v175, v72, v73
    v_mfma_f32_32x32x16_bf16 v[24:39], v[108:111], v[4:7], v[24:39]
    v_max3_f32 v174, v174, v74, v75
    v_max3_f32 v175, v175, v76, v77
    v_max3_f32 v174, v174, v78, v79
    v_max3_f32 v175, v175, v80, v81
    v_max3_f32 v174, v174, v82, v83
    v_max3_f32 v175, v175, v84, v85
    v_max3_f32 v174, v174, v86, v87
    v_max_f32 v174, v174, v175
    v_mfma_f32_32x32x16_bf16 v[40:55], v[112:115], v[0:3], 0
    v_mov_b32 v175, v174
    s_nop 1
    v_permlane32_swap_b32 v174, v175
    s_nop 1
    v_max3_f32 v174, v174, v175, v168
    v_mfma_f32_32x32x16_bf16 v[40:55], v[116:119], v[4:7], v[40:55]
    ds_read_b128 v[120:123], v182 offset:36864
    ds_read_b128 v[124:127], v184 offset:36864
    ds_read_b128 v[128:131], v182 offset:38912
    ds_read_b128 v[132:135], v184 offset:38912
    v_sub_f32 v176, v168, v174
    v_mul_f32 v176, s30, v176
    v_exp_f32 v172, v176
    v_mov_b32 v168, v174
    v_mul_f32 v170, s30, v174
    v_sub_f32 v170, 0, v170
    v_mov_b32 v171, v170
    v_mov_b32 v173, v172
    ds_read_b64_tr_b16 v[136:137], v186 offset:32768
    ds_read_b64_tr_b16 v[138:139], v186 offset:33280
    ds_read_b64_tr_b16 v[140:141], v186 offset:33792
    ds_read_b64_tr_b16 v[142:143], v186 offset:34304
    ds_read_b64_tr_b16 v[144:145], v186 offset:34816
    ds_read_b64_tr_b16 v[146:147], v186 offset:35328
    ds_read_b64_tr_b16 v[148:149], v186 offset:35840
    ds_read_b64_tr_b16 v[150:151], v186 offset:36352
    v_pk_fma_f32 v[56:57], v[56:57], s[30:31], v[170:171]
    v_pk_fma_f32 v[58:59], v[58:59], s[30:31], v[170:171]
    v_pk_fma_f32 v[60:61], v[60:61], s[30:31], v[170:171]
    v_pk_fma_f32 v[62:63], v[62:63], s[30:31], v[170:171]
    v_pk_fma_f32 v[64:65], v[64:65], s[30:31], v[170:171]
    v_pk_fma_f32 v[66:67], v[66:67], s[30:31], v[170:171]
    v_pk_fma_f32 v[68:69], v[68:69], s[30:31], v[170:171]
    v_pk_fma_f32 v[70:71], v[70:71], s[30:31], v[170:171]
    v_pk_mul_f32 v[8:9], v[8:9], v[172:173]
    v_pk_mul_f32 v[10:11], v[10:11], v[172:173]
    v_pk_mul_f32 v[12:13], v[12:13], v[172:173]
    v_pk_mul_f32 v[14:15], v[14:15], v[172:173]
    v_pk_mul_f32 v[16:17], v[16:17], v[172:173]
    v_pk_mul_f32 v[18:19], v[18:19], v[172:173]
    v_pk_mul_f32 v[20:21], v[20:21], v[172:173]
    v_pk_mul_f32 v[22:23], v[22:23], v[172:173]
    v_exp_f32 v56, v56
    v_exp_f32 v57, v57
    v_exp_f32 v58, v58
    v_exp_f32 v59, v59
    v_exp_f32 v60, v60
    v_exp_f32 v61, v61
    v_exp_f32 v62, v62
    v_exp_f32 v63, v63
    v_exp_f32 v64, v64
    v_exp_f32 v65, v65
    v_exp_f32 v66, v66
    v_exp_f32 v67, v67
    v_exp_f32 v68, v68
    v_exp_f32 v69, v69
    v_exp_f32 v70, v70
    v_exp_f32 v71, v71
    s_nop 0
    v_cvt_pk_bf16_f32 v88, v56, v57
    v_cvt_pk_bf16_f32 v89, v58, v59
    v_cvt_pk_bf16_f32 v90, v60, v61
    v_cvt_pk_bf16_f32 v91, v62, v63
    v_cvt_pk_bf16_f32 v92, v64, v65
    v_cvt_pk_bf16_f32 v93, v66, v67
    v_cvt_pk_bf16_f32 v94, v68, v69
    v_cvt_pk_bf16_f32 v95, v70, v71
    s_waitcnt lgkmcnt(12)
    s_nop 1
    v_mfma_f32_32x32x16_bf16 v[8:23], v[152:155], v[88:91], v[8:23]
    v_mfma_f32_32x32x16_bf16 v[8:23], v[156:159], v[92:95], v[8:23]
    v_pk_fma_f32 v[72:73], v[72:73], s[30:31], v[170:171]
    v_pk_fma_f32 v[74:75], v[74:75], s[30:31], v[170:171]
    v_pk_fma_f32 v[76:77], v[76:77], s[30:31], v[170:171]
    v_pk_fma_f32 v[78:79], v[78:79], s[30:31], v[170:171]
    v_pk_fma_f32 v[80:81], v[80:81], s[30:31], v[170:171]
    v_pk_fma_f32 v[82:83], v[82:83], s[30:31], v[170:171]
    v_pk_fma_f32 v[84:85], v[84:85], s[30:31], v[170:171]
    v_pk_fma_f32 v[86:87], v[86:87], s[30:31], v[170:171]
    v_exp_f32 v72, v72
    v_exp_f32 v73, v73
    v_exp_f32 v74, v74
    v_exp_f32 v75, v75
    v_exp_f32 v76, v76
    v_exp_f32 v77, v77
    v_exp_f32 v78, v78
    v_exp_f32 v79, v79
    v_exp_f32 v80, v80
    v_exp_f32 v81, v81
    v_exp_f32 v82, v82
    v_exp_f32 v83, v83
    v_exp_f32 v84, v84
    v_exp_f32 v85, v85
    v_exp_f32 v86, v86
    v_exp_f32 v87, v87
    s_nop 0
    v_cvt_pk_bf16_f32 v96, v72, v73
    v_cvt_pk_bf16_f32 v97, v74, v75
    v_cvt_pk_bf16_f32 v98, v76, v77
    v_cvt_pk_bf16_f32 v99, v78, v79
    v_cvt_pk_bf16_f32 v100, v80, v81
    v_cvt_pk_bf16_f32 v101, v82, v83
    v_cvt_pk_bf16_f32 v102, v84, v85
    v_cvt_pk_bf16_f32 v103, v86, v87
    s_nop 1
    v_mfma_f32_32x32x16_bf16 v[8:23], v[160:163], v[96:99], v[8:23]
    v_mfma_f32_32x32x16_bf16 v[8:23], v[164:167], v[100:103], v[8:23]
    s_waitcnt lgkmcnt(8)
    v_mfma_f32_32x32x16_bf16 v[56:71], v[120:123], v[0:3], 0
    v_max3_f32 v174, v24, v25, v26
    v_max3_f32 v175, v27, v28, v29
    v_max3_f32 v174, v174, v30, v31
    v_max3_f32 v175, v175, v32, v33
    v_max3_f32 v174, v174, v34, v35
    v_max3_f32 v175, v175, v36, v37
    v_max3_f32 v174, v174, v38, v39
    v_max3_f32 v175, v175, v40, v41
    v_mfma_f32_32x32x16_bf16 v[56:71], v[124:127], v[4:7], v[56:71]
    v_max3_f32 v174, v174, v42, v43
    v_max3_f32 v175, v175, v44, v45
    v_max3_f32 v174, v174, v46, v47
    v_max3_f32 v175, v175, v48, v49
    v_max3_f32 v174, v174, v50, v51
    v_max3_f32 v175, v175, v52, v53
    v_max3_f32 v174, v174, v54, v55
    v_max_f32 v174, v174, v175
    v_mfma_f32_32x32x16_bf16 v[72:87], v[128:131], v[0:3], 0
    v_mov_b32 v175, v174
    s_nop 1
    v_permlane32_swap_b32 v174, v175
    s_nop 1
    v_max3_f32 v174, v174, v175, v168
    v_mfma_f32_32x32x16_bf16 v[72:87], v[132:135], v[4:7], v[72:87]
    v_sub_f32 v176, v168, v174
    v_mul_f32 v176, s30, v176
    v_exp_f32 v172, v176
    v_mov_b32 v168, v174
    v_mul_f32 v170, s30, v174
    v_sub_f32 v170, 0, v170
    v_mov_b32 v171, v170
    v_mov_b32 v173, v172
    ds_read_b64_tr_b16 v[152:153], v186 offset:36864
    ds_read_b64_tr_b16 v[154:155], v186 offset:37376
    ds_read_b64_tr_b16 v[156:157], v186 offset:37888
    ds_read_b64_tr_b16 v[158:159], v186 offset:38400
    ds_read_b64_tr_b16 v[160:161], v186 offset:38912
    ds_read_b64_tr_b16 v[162:163], v186 offset:39424
    ds_read_b64_tr_b16 v[164:165], v186 offset:39936
    ds_read_b64_tr_b16 v[166:167], v186 offset:40448
    v_pk_fma_f32 v[24:25], v[24:25], s[30:31], v[170:171]
    v_pk_fma_f32 v[26:27], v[26:27], s[30:31], v[170:171]
    v_pk_fma_f32 v[28:29], v[28:29], s[30:31], v[170:171]
    v_pk_fma_f32 v[30:31], v[30:31], s[30:31], v[170:171]
    v_pk_fma_f32 v[32:33], v[32:33], s[30:31], v[170:171]
    v_pk_fma_f32 v[34:35], v[34:35], s[30:31], v[170:171]
    v_pk_fma_f32 v[36:37], v[36:37], s[30:31], v[170:171]
    v_pk_fma_f32 v[38:39], v[38:39], s[30:31], v[170:171]
    v_pk_mul_f32 v[8:9], v[8:9], v[172:173]
    v_pk_mul_f32 v[10:11], v[10:11], v[172:173]
    v_pk_mul_f32 v[12:13], v[12:13], v[172:173]
    v_pk_mul_f32 v[14:15], v[14:15], v[172:173]
    v_pk_mul_f32 v[16:17], v[16:17], v[172:173]
    v_pk_mul_f32 v[18:19], v[18:19], v[172:173]
    v_pk_mul_f32 v[20:21], v[20:21], v[172:173]
    v_pk_mul_f32 v[22:23], v[22:23], v[172:173]
    v_exp_f32 v24, v24
    v_exp_f32 v25, v25
    v_exp_f32 v26, v26
    v_exp_f32 v27, v27
    v_exp_f32 v28, v28
    v_exp_f32 v29, v29
    v_exp_f32 v30, v30
    v_exp_f32 v31, v31
    v_exp_f32 v32, v32
    v_exp_f32 v33, v33
    v_exp_f32 v34, v34
    v_exp_f32 v35, v35
    v_exp_f32 v36, v36
    v_exp_f32 v37, v37
    v_exp_f32 v38, v38
    v_exp_f32 v39, v39
    s_nop 0
    v_cvt_pk_bf16_f32 v88, v24, v25
    v_cvt_pk_bf16_f32 v89, v26, v27
    v_cvt_pk_bf16_f32 v90, v28, v29
    v_cvt_pk_bf16_f32 v91, v30, v31
    v_cvt_pk_bf16_f32 v92, v32, v33
    v_cvt_pk_bf16_f32 v93, v34, v35
    v_cvt_pk_bf16_f32 v94, v36, v37
    v_cvt_pk_bf16_f32 v95, v38, v39
    s_waitcnt lgkmcnt(8)
    s_nop 1
    v_mfma_f32_32x32x16_bf16 v[8:23], v[136:139], v[88:91], v[8:23]
    v_mfma_f32_32x32x16_bf16 v[8:23], v[140:143], v[92:95], v[8:23]
    v_pk_fma_f32 v[40:41], v[40:41], s[30:31], v[170:171]
    v_pk_fma_f32 v[42:43], v[42:43], s[30:31], v[170:171]
    v_pk_fma_f32 v[44:45], v[44:45], s[30:31], v[170:171]
    v_pk_fma_f32 v[46:47], v[46:47], s[30:31], v[170:171]
    v_pk_fma_f32 v[48:49], v[48:49], s[30:31], v[170:171]
    v_pk_fma_f32 v[50:51], v[50:51], s[30:31], v[170:171]
    v_pk_fma_f32 v[52:53], v[52:53], s[30:31], v[170:171]
    v_pk_fma_f32 v[54:55], v[54:55], s[30:31], v[170:171]
    v_exp_f32 v40, v40
    v_exp_f32 v41, v41
    v_exp_f32 v42, v42
    v_exp_f32 v43, v43
    v_exp_f32 v44, v44
    v_exp_f32 v45, v45
    v_exp_f32 v46, v46
    v_exp_f32 v47, v47
    v_exp_f32 v48, v48
    v_exp_f32 v49, v49
    v_exp_f32 v50, v50
    v_exp_f32 v51, v51
    v_exp_f32 v52, v52
    v_exp_f32 v53, v53
    v_exp_f32 v54, v54
    v_exp_f32 v55, v55
    s_nop 0
    v_cvt_pk_bf16_f32 v96, v40, v41
    v_cvt_pk_bf16_f32 v97, v42, v43
    v_cvt_pk_bf16_f32 v98, v44, v45
    v_cvt_pk_bf16_f32 v99, v46, v47
    v_cvt_pk_bf16_f32 v100, v48, v49
    v_cvt_pk_bf16_f32 v101, v50, v51
    v_cvt_pk_bf16_f32 v102, v52, v53
    v_cvt_pk_bf16_f32 v103, v54, v55
    s_nop 1
    v_mfma_f32_32x32x16_bf16 v[8:23], v[144:147], v[96:99], v[8:23]
    v_mfma_f32_32x32x16_bf16 v[8:23], v[148:151], v[100:103], v[8:23]
    v_max3_f32 v174, v56, v57, v58
    v_max3_f32 v175, v59, v60, v61
    v_max3_f32 v174, v174, v62, v63
    v_max3_f32 v175, v175, v64, v65
    v_max3_f32 v174, v174, v66, v67
    v_max3_f32 v175, v175, v68, v69
    v_max3_f32 v174, v174, v70, v71
    v_max3_f32 v175, v175, v72, v73
    v_max3_f32 v174, v174, v74, v75
    v_max3_f32 v175, v175, v76, v77
    v_max3_f32 v174, v174, v78, v79
    v_max3_f32 v175, v175, v80, v81
    v_max3_f32 v174, v174, v82, v83
    v_max3_f32 v175, v175, v84, v85
    v_max3_f32 v174, v174, v86, v87
    v_max_f32 v174, v174, v175
    v_mov_b32 v175, v174
    s_nop 1
    v_permlane32_swap_b32 v174, v175
    s_nop 1
    v_max3_f32 v174, v174, v175, v168
    v_sub_f32 v176, v168, v174
    v_mul_f32 v176, s30, v176
    v_exp_f32 v172, v176
    v_mov_b32 v168, v174
    v_mul_f32 v170, s30, v174
    v_sub_f32 v170, 0, v170
    v_mov_b32 v171, v170
    v_mov_b32 v173, v172
    v_pk_fma_f32 v[56:57], v[56:57], s[30:31], v[170:171]
    v_pk_fma_f32 v[58:59], v[58:59], s[30:31], v[170:171]
    v_pk_fma_f32 v[60:61], v[60:61], s[30:31], v[170:171]
    v_pk_fma_f32 v[62:63], v[62:63], s[30:31], v[170:171]
    v_pk_fma_f32 v[64:65], v[64:65], s[30:31], v[170:171]
    v_pk_fma_f32 v[66:67], v[66:67], s[30:31], v[170:171]
    v_pk_fma_f32 v[68:69], v[68:69], s[30:31], v[170:171]
    v_pk_fma_f32 v[70:71], v[70:71], s[30:31], v[170:171]
    v_pk_mul_f32 v[8:9], v[8:9], v[172:173]
    v_pk_mul_f32 v[10:11], v[10:11], v[172:173]
    v_pk_mul_f32 v[12:13], v[12:13], v[172:173]
    v_pk_mul_f32 v[14:15], v[14:15], v[172:173]
    v_pk_mul_f32 v[16:17], v[16:17], v[172:173]
    v_pk_mul_f32 v[18:19], v[18:19], v[172:173]
    v_pk_mul_f32 v[20:21], v[20:21], v[172:173]
    v_pk_mul_f32 v[22:23], v[22:23], v[172:173]
    v_exp_f32 v56, v56
    v_exp_f32 v57, v57
    v_exp_f32 v58, v58
    v_exp_f32 v59, v59
    v_exp_f32 v60, v60
    v_exp_f32 v61, v61
    v_exp_f32 v62, v62
    v_exp_f32 v63, v63
    v_exp_f32 v64, v64
    v_exp_f32 v65, v65
    v_exp_f32 v66, v66
    v_exp_f32 v67, v67
    v_exp_f32 v68, v68
    v_exp_f32 v69, v69
    v_exp_f32 v70, v70
    v_exp_f32 v71, v71
    s_nop 0
    v_cvt_pk_bf16_f32 v88, v56, v57
    v_cvt_pk_bf16_f32 v89, v58, v59
    v_cvt_pk_bf16_f32 v90, v60, v61
    v_cvt_pk_bf16_f32 v91, v62, v63
    v_cvt_pk_bf16_f32 v92, v64, v65
    v_cvt_pk_bf16_f32 v93, v66, v67
    v_cvt_pk_bf16_f32 v94, v68, v69
    v_cvt_pk_bf16_f32 v95, v70, v71
    s_waitcnt lgkmcnt(0)
    s_nop 1
    v_mfma_f32_32x32x16_bf16 v[8:23], v[152:155], v[88:91], v[8:23]
    v_mfma_f32_32x32x16_bf16 v[8:23], v[156:159], v[92:95], v[8:23]
    v_pk_fma_f32 v[72:73], v[72:73], s[30:31], v[170:171]
    v_pk_fma_f32 v[74:75], v[74:75], s[30:31], v[170:171]
    v_pk_fma_f32 v[76:77], v[76:77], s[30:31], v[170:171]
    v_pk_fma_f32 v[78:79], v[78:79], s[30:31], v[170:171]
    v_pk_fma_f32 v[80:81], v[80:81], s[30:31], v[170:171]
    v_pk_fma_f32 v[82:83], v[82:83], s[30:31], v[170:171]
    v_pk_fma_f32 v[84:85], v[84:85], s[30:31], v[170:171]
    v_pk_fma_f32 v[86:87], v[86:87], s[30:31], v[170:171]
    v_exp_f32 v72, v72
    v_exp_f32 v73, v73
    v_exp_f32 v74, v74
    v_exp_f32 v75, v75
    v_exp_f32 v76, v76
    v_exp_f32 v77, v77
    v_exp_f32 v78, v78
    v_exp_f32 v79, v79
    v_exp_f32 v80, v80
    v_exp_f32 v81, v81
    v_exp_f32 v82, v82
    v_exp_f32 v83, v83
    v_exp_f32 v84, v84
    v_exp_f32 v85, v85
    v_exp_f32 v86, v86
    v_exp_f32 v87, v87
    s_nop 0
    v_cvt_pk_bf16_f32 v96, v72, v73
    v_cvt_pk_bf16_f32 v97, v74, v75
    v_cvt_pk_bf16_f32 v98, v76, v77
    v_cvt_pk_bf16_f32 v99, v78, v79
    v_cvt_pk_bf16_f32 v100, v80, v81
    v_cvt_pk_bf16_f32 v101, v82, v83
    v_cvt_pk_bf16_f32 v102, v84, v85
    v_cvt_pk_bf16_f32 v103, v86, v87
    s_nop 1
    v_mfma_f32_32x32x16_bf16 v[8:23], v[160:163], v[96:99], v[8:23]
    v_mfma_f32_32x32x16_bf16 v[8:23], v[164:167], v[100:103], v[8:23]
    s_nop 7
    s_nop 7
    s_and_b32 s25, s22, 3
    s_mul_i32 s25, s25, 4352
    s_add_u32 s25, s25, 65536
    v_lshlrev_b32 v174, 2, v189
    v_add_u32 v174, s25, v174
    s_cmp_lt_u32 s22, 4
    s_cbranch_scc1 k_attn_kernel_hi
    ds_write_b32 v174, v8 offset:0
    ds_write_b32 v174, v9 offset:256
    ds_write_b32 v174, v10 offset:512
    ds_write_b32 v174, v11 offset:768
    ds_write_b32 v174, v12 offset:1024
    ds_write_b32 v174, v13 offset:1280
    ds_write_b32 v174, v14 offset:1536
    ds_write_b32 v174, v15 offset:1792
    ds_write_b32 v174, v16 offset:2048
    ds_write_b32 v174, v17 offset:2304
    ds_write_b32 v174, v18 offset:2560
    ds_write_b32 v174, v19 offset:2816
    ds_write_b32 v174, v20 offset:3072
    ds_write_b32 v174, v21 offset:3328
    ds_write_b32 v174, v22 offset:3584
    ds_write_b32 v174, v23 offset:3840
    ds_write_b32 v174, v168 offset:4096
    s_waitcnt lgkmcnt(0)
    s_barrier
    s_branch k_attn_kernel_end
k_attn_kernel_hi:
    s_barrier
    ds_read_b32 v24, v174 offset:0
    ds_read_b32 v25, v174 offset:256
    ds_read_b32 v26, v174 offset:512
    ds_read_b32 v27, v174 offset:768
    ds_read_b32 v28, v174 offset:1024
    ds_read_b32 v29, v174 offset:1280
    ds_read_b32 v30, v174 offset:1536
    ds_read_b32 v31, v174 offset:1792
    ds_read_b32 v32, v174 offset:2048
    ds_read_b32 v33, v174 offset:2304
    ds_read_b32 v34, v174 offset:2560
    ds_read_b32 v35, v174 offset:2816
    ds_read_b32 v36, v174 offset:3072
    ds_read_b32 v37, v174 offset:3328
    ds_read_b32 v38, v174 offset:3584
    ds_read_b32 v39, v174 offset:3840
    ds_read_b32 v175, v174 offset:4096
    s_waitcnt lgkmcnt(0)
    v_max_f32 v176, v168, v175
    v_sub_f32 v172, v168, v176
    v_sub_f32 v170, v175, v176
    v_mul_f32 v172, s30, v172
    v_mul_f32 v170, s30, v170
    v_exp_f32 v172, v172
    v_exp_f32 v170, v170
    s_nop 0
    v_mul_f32 v8, v8, v172
    v_fmac_f32 v8, v24, v170
    v_mul_f32 v9, v9, v172
    v_fmac_f32 v9, v25, v170
    v_mul_f32 v10, v10, v172
    v_fmac_f32 v10, v26, v170
    v_mul_f32 v11, v11, v172
    v_fmac_f32 v11, v27, v170
    v_mul_f32 v12, v12, v172
    v_fmac_f32 v12, v28, v170
    v_mul_f32 v13, v13, v172
    v_fmac_f32 v13, v29, v170
    v_mul_f32 v14, v14, v172
    v_fmac_f32 v14, v30, v170
    v_mul_f32 v15, v15, v172
    v_fmac_f32 v15, v31, v170
    v_mul_f32 v16, v16, v172
    v_fmac_f32 v16, v32, v170
    v_mul_f32 v17, v17, v172
    v_fmac_f32 v17, v33, v170
    v_mul_f32 v18, v18, v172
    v_fmac_f32 v18, v34, v170
    v_mul_f32 v19, v19, v172
    v_fmac_f32 v19, v35, v170
    v_mul_f32 v20, v20, v172
    v_fmac_f32 v20, v36, v170
    v_mul_f32 v21, v21, v172
    v_fmac_f32 v21, v37, v170
    v_mul_f32 v22, v22, v172
    v_fmac_f32 v22, v38, v170
    v_mul_f32 v23, v23, v172
    v_fmac_f32 v23, v39, v170
    v_mov_b32 v176, v20
    v_mov_b32 v177, v20
    s_nop 1
    v_permlane32_swap_b32 v176, v177
    s_nop 1
    v_rcp_f32 v177, v177
    s_nop 0
    v_mul_f32 v8, v8, v177
    v_mul_f32 v9, v9, v177
    v_mul_f32 v10, v10, v177
    v_mul_f32 v11, v11, v177
    v_mul_f32 v12, v12, v177
    v_mul_f32 v13, v13, v177
    v_mul_f32 v14, v14, v177
    v_mul_f32 v15, v15, v177
    v_mul_f32 v16, v16, v177
    v_mul_f32 v17, v17, v177
    v_mul_f32 v18, v18, v177
    v_mul_f32 v19, v19, v177
    v_mul_f32 v20, v20, v177
    v_mul_f32 v21, v21, v177
    v_mul_f32 v22, v22, v177
    v_mul_f32 v23, v23, v177
    v_cvt_pk_bf16_f32 v88, v8, v9
    v_cvt_pk_bf16_f32 v89, v10, v11
    v_cvt_pk_bf16_f32 v90, v12, v13
    v_cvt_pk_bf16_f32 v91, v14, v15
    v_cvt_pk_bf16_f32 v92, v16, v17
    v_cvt_pk_bf16_f32 v93, v18, v19
    v_cvt_pk_bf16_f32 v94, v20, v21
    v_cvt_pk_bf16_f32 v95, v22, v23
    s_mul_i32 s25, s23, 28
    v_lshrrev_b32 v174, 5, v189
    v_lshl_add_u32 v174, v174, 2, s25
    v_lshrrev_b32 v175, 5, v190
    v_mul_u32_u24 v175, 28672, v175
    v_and_b32 v176, 31, v190
    v_lshl_add_u32 v175, v176, 4, v175
    v_add_u32 v176, 0, v174
    v_lshrrev_b32 v177, 4, v176
    v_lshl_add_u32 v177, v177, 10, v175
    v_bfe_u32 v178, v176, 3, 1
    v_lshl_add_u32 v177, v178, 9, v177
    v_and_b32 v178, 7, v176
    v_lshl_add_u32 v177, v178, 1, v177
    buffer_store_dword v88, v177, s[16:19], 0 offen
    s_nop 0
    v_add_u32 v176, 2, v174
    v_lshrrev_b32 v177, 4, v176
    v_lshl_add_u32 v177, v177, 10, v175
    v_bfe_u32 v178, v176, 3, 1
    v_lshl_add_u32 v177, v178, 9, v177
    v_and_b32 v178, 7, v176
    v_lshl_add_u32 v177, v178, 1, v177
    buffer_store_dword v89, v177, s[16:19], 0 offen
    s_nop 0
    v_add_u32 v176, 8, v174
    v_lshrrev_b32 v177, 4, v176
    v_lshl_add_u32 v177, v177, 10, v175
    v_bfe_u32 v178, v176, 3, 1
    v_lshl_add_u32 v177, v178, 9, v177
    v_and_b32 v178, 7, v176
    v_lshl_add_u32 v177, v178, 1, v177
    buffer_store_dword v90, v177, s[16:19], 0 offen
    s_nop 0
    v_add_u32 v176, 10, v174
    v_lshrrev_b32 v177, 4, v176
    v_lshl_add_u32 v177, v177, 10, v175
    v_bfe_u32 v178, v176, 3, 1
    v_lshl_add_u32 v177, v178, 9, v177
    v_and_b32 v178, 7, v176
    v_lshl_add_u32 v177, v178, 1, v177
    buffer_store_dword v91, v177, s[16:19], 0 offen
    s_nop 0
    v_add_u32 v176, 16, v174
    v_lshrrev_b32 v177, 4, v176
    v_lshl_add_u32 v177, v177, 10, v175
    v_bfe_u32 v178, v176, 3, 1
    v_lshl_add_u32 v177, v178, 9, v177
    v_and_b32 v178, 7, v176
    v_lshl_add_u32 v177, v178, 1, v177
    buffer_store_dword v92, v177, s[16:19], 0 offen
    s_nop 0
    v_add_u32 v176, 18, v174
    v_lshrrev_b32 v177, 4, v176
    v_lshl_add_u32 v177, v177, 10, v175
    v_bfe_u32 v178, v176, 3, 1
    v_lshl_add_u32 v177, v178, 9, v177
    v_and_b32 v178, 7, v176
    v_lshl_add_u32 v177, v178, 1, v177
    buffer_store_dword v93, v177, s[16:19], 0 offen
    s_nop 0
    v_add_u32 v176, 24, v174
    v_lshrrev_b32 v177, 4, v176
    v_lshl_add_u32 v177, v177, 10, v175
    v_bfe_u32 v178, v176, 3, 1
    v_lshl_add_u32 v177, v178, 9, v177
    v_and_b32 v178, 7, v176
    v_lshl_add_u32 v177, v178, 1, v177
    s_mov_b32 exec_hi, 0
    buffer_store_dword v94, v177, s[16:19], 0 offen
    s_nop 0
    v_add_u32 v176, 26, v174
    v_lshrrev_b32 v177, 4, v176
    v_lshl_add_u32 v177, v177, 10, v175
    v_bfe_u32 v178, v176, 3, 1
    v_lshl_add_u32 v177, v178, 9, v177
    v_and_b32 v178, 7, v176
    v_lshl_add_u32 v177, v178, 1, v177
    buffer_store_dword v95, v177, s[16:19], 0 offen
    s_nop 0
    s_waitcnt vmcnt(0)
k_attn_kernel_end:
    s_endpgm

.globl k_oproj1_kernel
.p2align 8
.type k_oproj1_kernel,@function
k_oproj1_kernel:
    s_cmp_ge_u32 s2, 224
    s_cbranch_scc1 k_oproj1_kernel_end
    s_load_dwordx2 s[28:29], s[0:1], 72
    s_load_dwordx2 s[30:31], s[0:1], 16
    s_load_dwordx2 s[34:35], s[0:1], 72
    s_load_dwordx2 s[44:45], s[0:1], 0
    v_and_b32 v152, 63, v0
    v_lshrrev_b32 v136, 6, v0
    s_and_b32 s37, s2, 7
    s_lshl_b32 s37, s37, 1
    v_readfirstlane_b32 s36, v136
    s_lshr_b32 s38, s2, 3
    s_and_b32 s42, s38, 1
    s_add_u32 s37, s37, s42
    s_lshr_b32 s38, s38, 1
    s_waitcnt lgkmcnt(0)
    s_add_u32 s8, s28, 0x600000
    s_addc_u32 s9, s29, 0
    s_mov_b32 s10, 0x1c0000
    s_mov_b32 s11, 0x20000
    s_mov_b32 s12, s30
    s_mov_b32 s13, s31
    s_mov_b32 s14, 0x62000
    s_mov_b32 s15, 0x20000
    s_add_u32 s20, s34, 0x800000
    s_addc_u32 s21, s35, 0
    s_mov_b32 s22, 0x1c0000
    s_mov_b32 s23, 0x20000
    s_mov_b32 s24, s44
    s_mov_b32 s25, s45
    s_mov_b32 s26, 0x1c0000
    s_mov_b32 s27, 0x20000
    s_lshl_b32 s48, s37, 2
    s_add_u32 s48, s48, s36
    s_lshl_b32 s42, s48, 5
    v_and_b32 v158, 31, v152
    v_add_u32 v158, s42, v158
    s_mul_i32 s42, s48, 28672
    v_lshlrev_b32 v156, 4, v152
    v_add_u32 v156, s42, v156
    buffer_load_dwordx4 v[0:3], v156, s[8:11], 0 offen offset:0
    buffer_load_dwordx4 v[4:7], v156, s[8:11], 0 offen offset:1024
    buffer_load_dwordx4 v[8:11], v156, s[8:11], 0 offen offset:2048
    buffer_load_dwordx4 v[12:15], v156, s[8:11], 0 offen offset:3072
    v_add_u32 v156, 4096, v156
    buffer_load_dwordx4 v[16:19], v156, s[8:11], 0 offen offset:0
    buffer_load_dwordx4 v[20:23], v156, s[8:11], 0 offen offset:1024
    buffer_load_dwordx4 v[24:27], v156, s[8:11], 0 offen offset:2048
    buffer_load_dwordx4 v[28:31], v156, s[8:11], 0 offen offset:3072
    v_add_u32 v156, 4096, v156
    buffer_load_dwordx4 v[32:35], v156, s[8:11], 0 offen offset:0
    buffer_load_dwordx4 v[36:39], v156, s[8:11], 0 offen offset:1024
    buffer_load_dwordx4 v[40:43], v156, s[8:11], 0 offen offset:2048
    buffer_load_dwordx4 v[44:47], v156, s[8:11], 0 offen offset:3072
    v_add_u32 v156, 4096, v156
    buffer_load_dwordx4 v[48:51], v156, s[8:11], 0 offen offset:0
    buffer_load_dwordx4 v[52:55], v156, s[8:11], 0 offen offset:1024
    buffer_load_dwordx4 v[56:59], v156, s[8:11], 0 offen offset:2048
    buffer_load_dwordx4 v[60:63], v156, s[8:11], 0 offen offset:3072
    v_add_u32 v156, 4096, v156
    buffer_load_dwordx4 v[64:67], v156, s[8:11], 0 offen offset:0
    buffer_load_dwordx4 v[68:71], v156, s[8:11], 0 offen offset:1024
    buffer_load_dwordx4 v[72:75], v156, s[8:11], 0 offen offset:2048
    buffer_load_dwordx4 v[76:79], v156, s[8:11], 0 offen offset:3072
    v_add_u32 v156, 4096, v156
    buffer_load_dwordx4 v[80:83], v156, s[8:11], 0 offen offset:0
    buffer_load_dwordx4 v[84:87], v156, s[8:11], 0 offen offset:1024
    buffer_load_dwordx4 v[88:91], v156, s[8:11], 0 offen offset:2048
    buffer_load_dwordx4 v[92:95], v156, s[8:11], 0 offen offset:3072
    v_add_u32 v156, 4096, v156
    buffer_load_dwordx4 v[96:99], v156, s[8:11], 0 offen offset:0
    buffer_load_dwordx4 v[100:103], v156, s[8:11], 0 offen offset:1024
    buffer_load_dwordx4 v[104:107], v156, s[8:11], 0 offen offset:2048
    buffer_load_dwordx4 v[108:111], v156, s[8:11], 0 offen offset:3072
    s_lshl_b32 s42, s36, 6
    v_add_u32 v155, s42, v152
    v_mul_u32_u24 v136, 64, v155
    v_lshrrev_b32 v136, 8, v136
    v_mul_u32_u24 v137, 4, v136
    v_sub_u32 v137, v155, v137
    v_mul_u32_u24 v155, 896, v136
    v_lshl_add_u32 v155, v137, 4, v155
    s_mul_i32 s43, s38, 32
    s_lshl_b32 s40, s43, 1
    s_lshl_b32 s39, s36, 10
    v_lshrrev_b32 v136, 5, v152
    v_lshlrev_b32 v136, 3, v136
    v_bfe_u32 v137, v152, 2, 2
    v_add_u32 v136, v136, v137
    v_mul_u32_u24 v153, 64, v136
    v_bfe_u32 v138, v152, 4, 1
    v_lshlrev_b32 v138, 5, v138
    v_and_b32 v139, 3, v152
    v_lshl_add_u32 v138, v139, 3, v138
    v_add_u32 v153, v153, v138
    s_add_u32 s42, s40, 0x0
    s_add_u32 m0, s39, 0
    buffer_load_dwordx4 v155, s[12:15], s42 offen lds
    s_add_u32 s42, s40, 0xe000
    s_add_u32 m0, s39, 4096
    buffer_load_dwordx4 v155, s[12:15], s42 offen lds
    s_waitcnt vmcnt(2)
    s_waitcnt vmcnt(1)
    s_barrier
    s_add_u32 s42, s40, 0x1c000
    s_add_u32 m0, s39, 8192
    buffer_load_dwordx4 v155, s[12:15], s42 offen lds
    ds_read_b64_tr_b16 v[128:129], v153 offset:0
    ds_read_b64_tr_b16 v[130:131], v153 offset:256
    ds_read_b64_tr_b16 v[132:133], v153 offset:1024
    ds_read_b64_tr_b16 v[134:135], v153 offset:1280
    s_waitcnt lgkmcnt(2)
    v_mfma_f32_32x32x16_bf16 v[112:127], v[128:131], v[0:3], 0
    ds_read_b64_tr_b16 v[128:129], v153 offset:2048
    ds_read_b64_tr_b16 v[130:131], v153 offset:2304
    s_waitcnt lgkmcnt(2)
    v_mfma_f32_32x32x16_bf16 v[112:127], v[132:135], v[4:7], v[112:127]
    ds_read_b64_tr_b16 v[132:133], v153 offset:3072
    ds_read_b64_tr_b16 v[134:135], v153 offset:3328
    s_waitcnt lgkmcnt(2)
    v_mfma_f32_32x32x16_bf16 v[112:127], v[128:131], v[8:11], v[112:127]
    s_waitcnt vmcnt(1)
    s_barrier
    s_add_u32 s42, s40, 0x2a000
    s_add_u32 m0, s39, 12288
    buffer_load_dwordx4 v155, s[12:15], s42 offen lds
    ds_read_b64_tr_b16 v[128:129], v153 offset:4096
    ds_read_b64_tr_b16 v[130:131], v153 offset:4352
    s_waitcnt lgkmcnt(2)
    v_mfma_f32_32x32x16_bf16 v[112:127], v[132:135], v[12:15], v[112:127]
    ds_read_b64_tr_b16 v[132:133], v153 offset:5120
    ds_read_b64_tr_b16 v[134:135], v153 offset:5376
    s_waitcnt lgkmcnt(2)
    v_mfma_f32_32x32x16_bf16 v[112:127], v[128:131], v[16:19], v[112:127]
    ds_read_b64_tr_b16 v[128:129], v153 offset:6144
    ds_read_b64_tr_b16 v[130:131], v153 offset:6400
    s_waitcnt lgkmcnt(2)
    v_mfma_f32_32x32x16_bf16 v[112:127], v[132:135], v[20:23], v[112:127]
    ds_read_b64_tr_b16 v[132:133], v153 offset:7168
    ds_read_b64_tr_b16 v[134:135], v153 offset:7424
    s_waitcnt lgkmcnt(2)
    v_mfma_f32_32x32x16_bf16 v[112:127], v[128:131], v[24:27], v[112:127]
    s_waitcnt vmcnt(1)
    s_barrier
    s_add_u32 s42, s40, 0x38000
    s_add_u32 m0, s39, 0
    buffer_load_dwordx4 v155, s[12:15], s42 offen lds
    ds_read_b64_tr_b16 v[128:129], v153 offset:8192
    ds_read_b64_tr_b16 v[130:131], v153 offset:8448
    s_waitcnt lgkmcnt(2)
    v_mfma_f32_32x32x16_bf16 v[112:127], v[132:135], v[28:31], v[112:127]
    ds_read_b64_tr_b16 v[132:133], v153 offset:9216
    ds_read_b64_tr_b16 v[134:135], v153 offset:9472
    s_waitcnt lgkmcnt(2)
    v_mfma_f32_32x32x16_bf16 v[112:127], v[128:131], v[32:35], v[112:127]
    ds_read_b64_tr_b16 v[128:129], v153 offset:10240
    ds_read_b64_tr_b16 v[130:131], v153 offset:10496
    s_waitcnt lgkmcnt(2)
    v_mfma_f32_32x32x16_bf16 v[112:127], v[132:135], v[36:39], v[112:127]
    ds_read_b64_tr_b16 v[132:133], v153 offset:11264
    ds_read_b64_tr_b16 v[134:135], v153 offset:11520
    s_waitcnt lgkmcnt(2)
    v_mfma_f32_32x32x16_bf16 v[112:127], v[128:131], v[40:43], v[112:127]
    s_waitcnt vmcnt(1)
    s_barrier
    s_add_u32 s42, s40, 0x46000
    s_add_u32 m0, s39, 4096
    buffer_load_dwordx4 v155, s[12:15], s42 offen lds
    ds_read_b64_tr_b16 v[128:129], v153 offset:12288
    ds_read_b64_tr_b16 v[130:131], v153 offset:12544
    s_waitcnt lgkmcnt(2)
    v_mfma_f32_32x32x16_bf16 v[112:127], v[132:135], v[44:47], v[112:127]
    ds_read_b64_tr_b16 v[132:133], v153 offset:13312
    ds_read_b64_tr_b16 v[134:135], v153 offset:13568
    s_waitcnt lgkmcnt(2)
    v_mfma_f32_32x32x16_bf16 v[112:127], v[128:131], v[48:51], v[112:127]
    ds_read_b64_tr_b16 v[128:129], v153 offset:14336
    ds_read_b64_tr_b16 v[130:131], v153 offset:14592
    s_waitcnt lgkmcnt(2)
    v_mfma_f32_32x32x16_bf16 v[112:127], v[132:135], v[52:55], v[112:127]
    ds_read_b64_tr_b16 v[132:133], v153 offset:15360
    ds_read_b64_tr_b16 v[134:135], v153 offset:15616
    s_waitcnt lgkmcnt(2)
    v_mfma_f32_32x32x16_bf16 v[112:127], v[128:131], v[56:59], v[112:127]
    s_waitcnt vmcnt(1)
    s_barrier
    s_add_u32 s42, s40, 0x54000
    s_add_u32 m0, s39, 8192
    buffer_load_dwordx4 v155, s[12:15], s42 offen lds
    ds_read_b64_tr_b16 v[128:129], v153 offset:0
    ds_read_b64_tr_b16 v[130:131], v153 offset:256
    s_waitcnt lgkmcnt(2)
    v_mfma_f32_32x32x16_bf16 v[112:127], v[132:135], v[60:63], v[112:127]
    ds_read_b64_tr_b16 v[132:133], v153 offset:1024
    ds_read_b64_tr_b16 v[134:135], v153 offset:1280
    s_waitcnt lgkmcnt(2)
    v_mfma_f32_32x32x16_bf16 v[112:127], v[128:131], v[64:67], v[112:127]
    ds_read_b64_tr_b16 v[128:129], v153 offset:2048
    ds_read_b64_tr_b16 v[130:131], v153 offset:2304
    s_waitcnt lgkmcnt(2)
    v_mfma_f32_32x32x16_bf16 v[112:127], v[132:135], v[68:71], v[112:127]
    ds_read_b64_tr_b16 v[132:133], v153 offset:3072
    ds_read_b64_tr_b16 v[134:135], v153 offset:3328
    s_waitcnt lgkmcnt(2)
    v_mfma_f32_32x32x16_bf16 v[112:127], v[128:131], v[72:75], v[112:127]
    s_waitcnt vmcnt(1)
    s_barrier
    ds_read_b64_tr_b16 v[128:129], v153 offset:4096
    ds_read_b64_tr_b16 v[130:131], v153 offset:4352
    s_waitcnt lgkmcnt(2)
    v_mfma_f32_32x32x16_bf16 v[112:127], v[132:135], v[76:79], v[112:127]
    ds_read_b64_tr_b16 v[132:133], v153 offset:5120
    ds_read_b64_tr_b16 v[134:135], v153 offset:5376
    s_waitcnt lgkmcnt(2)
    v_mfma_f32_32x32x16_bf16 v[112:127], v[128:131], v[80:83], v[112:127]
    ds_read_b64_tr_b16 v[128:129], v153 offset:6144
    ds_read_b64_tr_b16 v[130:131], v153 offset:6400
    s_waitcnt lgkmcnt(2)
    v_mfma_f32_32x32x16_bf16 v[112:127], v[132:135], v[84:87], v[112:127]
    ds_read_b64_tr_b16 v[132:133], v153 offset:7168
    ds_read_b64_tr_b16 v[134:135], v153 offset:7424
    s_waitcnt lgkmcnt(2)
    v_mfma_f32_32x32x16_bf16 v[112:127], v[128:131], v[88:91], v[112:127]
    s_waitcnt vmcnt(0)
    s_barrier
    ds_read_b64_tr_b16 v[128:129], v153 offset:8192
    ds_read_b64_tr_b16 v[130:131], v153 offset:8448
    s_waitcnt lgkmcnt(2)
    v_mfma_f32_32x32x16_bf16 v[112:127], v[132:135], v[92:95], v[112:127]
    ds_read_b64_tr_b16 v[132:133], v153 offset:9216
    ds_read_b64_tr_b16 v[134:135], v153 offset:9472
    s_waitcnt lgkmcnt(2)
    v_mfma_f32_32x32x16_bf16 v[112:127], v[128:131], v[96:99], v[112:127]
    ds_read_b64_tr_b16 v[128:129], v153 offset:10240
    ds_read_b64_tr_b16 v[130:131], v153 offset:10496
    s_waitcnt lgkmcnt(2)
    v_mfma_f32_32x32x16_bf16 v[112:127], v[132:135], v[100:103], v[112:127]
    ds_read_b64_tr_b16 v[132:133], v153 offset:11264
    ds_read_b64_tr_b16 v[134:135], v153 offset:11520
    s_waitcnt lgkmcnt(2)
    v_mfma_f32_32x32x16_bf16 v[112:127], v[128:131], v[104:107], v[112:127]
    s_waitcnt lgkmcnt(0)
    v_mfma_f32_32x32x16_bf16 v[112:127], v[132:135], v[108:111], v[112:127]
    s_nop 15
    s_nop 3
    s_mul_i32 s41, s48, 28
    s_lshr_b32 s49, s43, 4
    s_add_u32 s41, s41, s49
    s_lshl_b32 s41, s41, 10
    v_lshlrev_b32 v144, 4, v152
    v_add_u32 v144, s41, v144
    v_mul_u32_u24 v145, 896, v158
    v_lshrrev_b32 v160, 5, v152
    v_lshl_add_u32 v145, v160, 4, v145
    s_lshl_b32 s49, s43, 1
    v_add_u32 v145, s49, v145
    buffer_load_dwordx4 v[160:163], v145, s[24:27], 0 offen offset:0
    buffer_load_dwordx4 v[164:167], v145, s[24:27], 0 offen offset:32
    v_cvt_pk_bf16_f32 v136, v112, v113
    v_cvt_pk_bf16_f32 v137, v114, v115
    v_cvt_pk_bf16_f32 v138, v116, v117
    v_cvt_pk_bf16_f32 v139, v118, v119
    v_cvt_pk_bf16_f32 v140, v120, v121
    v_cvt_pk_bf16_f32 v141, v122, v123
    v_cvt_pk_bf16_f32 v142, v124, v125
    v_cvt_pk_bf16_f32 v143, v126, v127
    s_nop 1
    v_permlane32_swap_b32 v136, v138
    v_permlane32_swap_b32 v137, v139
    v_permlane32_swap_b32 v140, v142
    v_permlane32_swap_b32 v141, v143
    s_nop 1
    s_waitcnt vmcnt(1)
    v_lshlrev_b32 v112, 16, v136
    v_and_b32 v113, 0xffff0000, v136
    v_lshlrev_b32 v114, 16, v160
    v_and_b32 v115, 0xffff0000, v160
    v_add_f32 v112, v112, v114
    v_add_f32 v113, v113, v115
    v_cvt_pk_bf16_f32 v136, v112, v113
    v_lshlrev_b32 v112, 16, v137
    v_and_b32 v113, 0xffff0000, v137
    v_lshlrev_b32 v114, 16, v161
    v_and_b32 v115, 0xffff0000, v161
    v_add_f32 v112, v112, v114
    v_add_f32 v113, v113, v115
    v_cvt_pk_bf16_f32 v137, v112, v113
    v_lshlrev_b32 v112, 16, v138
    v_and_b32 v113, 0xffff0000, v138
    v_lshlrev_b32 v114, 16, v162
    v_and_b32 v115, 0xffff0000, v162
    v_add_f32 v112, v112, v114
    v_add_f32 v113, v113, v115
    v_cvt_pk_bf16_f32 v138, v112, v113
    v_lshlrev_b32 v112, 16, v139
    v_and_b32 v113, 0xffff0000, v139
    v_lshlrev_b32 v114, 16, v163
    v_and_b32 v115, 0xffff0000, v163
    v_add_f32 v112, v112, v114
    v_add_f32 v113, v113, v115
    v_cvt_pk_bf16_f32 v139, v112, v113
    buffer_store_dwordx4 v[136:139], v144, s[20:23], 0 offen offset:0
    s_waitcnt vmcnt(1)
    v_lshlrev_b32 v112, 16, v140
    v_and_b32 v113, 0xffff0000, v140
    v_lshlrev_b32 v114, 16, v164
    v_and_b32 v115, 0xffff0000, v164
    v_add_f32 v112, v112, v114
    v_add_f32 v113, v113, v115
    v_cvt_pk_bf16_f32 v140, v112, v113
    v_lshlrev_b32 v112, 16, v141
    v_and_b32 v113, 0xffff0000, v141
    v_lshlrev_b32 v114, 16, v165
    v_and_b32 v115, 0xffff0000, v165
    v_add_f32 v112, v112, v114
    v_add_f32 v113, v113, v115
    v_cvt_pk_bf16_f32 v141, v112, v113
    v_lshlrev_b32 v112, 16, v142
    v_and_b32 v113, 0xffff0000, v142
    v_lshlrev_b32 v114, 16, v166
    v_and_b32 v115, 0xffff0000, v166
    v_add_f32 v112, v112, v114
    v_add_f32 v113, v113, v115
    v_cvt_pk_bf16_f32 v142, v112, v113
    v_lshlrev_b32 v112, 16, v143
    v_and_b32 v113, 0xffff0000, v143
    v_lshlrev_b32 v114, 16, v167
    v_and_b32 v115, 0xffff0000, v167
    v_add_f32 v112, v112, v114
    v_add_f32 v113, v113, v115
    v_cvt_pk_bf16_f32 v143, v112, v113
    buffer_store_dwordx4 v[140:143], v144, s[20:23], 0 offen offset:1024
    s_nop 1
    s_waitcnt vmcnt(0)
k_oproj1_kernel_end:
    s_endpgm

.globl k_glu_kernel
.p2align 8
.type k_glu_kernel,@function
k_glu_kernel:
    s_cmp_ge_u32 s2, 224
    s_cbranch_scc1 k_glu_kernel_end
    s_load_dwordx2 s[28:29], s[0:1], 72
    s_load_dwordx2 s[30:31], s[0:1], 32
    s_load_dwordx2 s[32:33], s[0:1], 40
    s_load_dwordx2 s[34:35], s[0:1], 72
    v_and_b32 v224, 63, v0
    v_lshrrev_b32 v208, 6, v0
    s_and_b32 s37, s2, 7
    s_lshl_b32 s37, s37, 1
    v_readfirstlane_b32 s36, v208
    s_lshr_b32 s38, s2, 3
    s_and_b32 s42, s38, 1
    s_add_u32 s37, s37, s42
    s_lshr_b32 s38, s38, 1
    s_waitcnt lgkmcnt(0)
    s_add_u32 s8, s28, 0x800000
    s_addc_u32 s9, s29, 0
    s_mov_b32 s10, 0x1c0000
    s_mov_b32 s11, 0x20000
    s_mov_b32 s12, s30
    s_mov_b32 s13, s31
    s_mov_b32 s14, 0x188000
    s_mov_b32 s15, 0x20000
    s_mov_b32 s16, s32
    s_mov_b32 s17, s33
    s_mov_b32 s18, 0x188000
    s_mov_b32 s19, 0x20000
    s_add_u32 s20, s34, 0xa00000
    s_addc_u32 s21, s35, 0
    s_mov_b32 s22, 0x700000
    s_mov_b32 s23, 0x20000
    s_lshl_b32 s48, s37, 2
    s_add_u32 s48, s48, s36
    s_lshl_b32 s42, s48, 5
    v_and_b32 v233, 31, v224
    v_add_u32 v233, s42, v233
    s_mul_i32 s42, s48, 28672
    v_lshlrev_b32 v231, 4, v224
    v_add_u32 v231, s42, v231
    buffer_load_dwordx4 v[0:3], v231, s[8:11], 0 offen offset:0
    buffer_load_dwordx4 v[4:7], v231, s[8:11], 0 offen offset:1024
    buffer_load_dwordx4 v[8:11], v231, s[8:11], 0 offen offset:2048
    buffer_load_dwordx4 v[12:15], v231, s[8:11], 0 offen offset:3072
    v_add_u32 v231, 4096, v231
    buffer_load_dwordx4 v[16:19], v231, s[8:11], 0 offen offset:0
    buffer_load_dwordx4 v[20:23], v231, s[8:11], 0 offen offset:1024
    buffer_load_dwordx4 v[24:27], v231, s[8:11], 0 offen offset:2048
    buffer_load_dwordx4 v[28:31], v231, s[8:11], 0 offen offset:3072
    v_add_u32 v231, 4096, v231
    buffer_load_dwordx4 v[32:35], v231, s[8:11], 0 offen offset:0
    buffer_load_dwordx4 v[36:39], v231, s[8:11], 0 offen offset:1024
    buffer_load_dwordx4 v[40:43], v231, s[8:11], 0 offen offset:2048
    buffer_load_dwordx4 v[44:47], v231, s[8:11], 0 offen offset:3072
    v_add_u32 v231, 4096, v231
    buffer_load_dwordx4 v[48:51], v231, s[8:11], 0 offen offset:0
    buffer_load_dwordx4 v[52:55], v231, s[8:11], 0 offen offset:1024
    buffer_load_dwordx4 v[56:59], v231, s[8:11], 0 offen offset:2048
    buffer_load_dwordx4 v[60:63], v231, s[8:11], 0 offen offset:3072
    v_add_u32 v231, 4096, v231
    buffer_load_dwordx4 v[64:67], v231, s[8:11], 0 offen offset:0
    buffer_load_dwordx4 v[68:71], v231, s[8:11], 0 offen offset:1024
    buffer_load_dwordx4 v[72:75], v231, s[8:11], 0 offen offset:2048
    buffer_load_dwordx4 v[76:79], v231, s[8:11], 0 offen offset:3072
    v_add_u32 v231, 4096, v231
    buffer_load_dwordx4 v[80:83], v231, s[8:11], 0 offen offset:0
    buffer_load_dwordx4 v[84:87], v231, s[8:11], 0 offen offset:1024
    buffer_load_dwordx4 v[88:91], v231, s[8:11], 0 offen offset:2048
    buffer_load_dwordx4 v[92:95], v231, s[8:11], 0 offen offset:3072
    v_add_u32 v231, 4096, v231
    buffer_load_dwordx4 v[96:99], v231, s[8:11], 0 offen offset:0
    buffer_load_dwordx4 v[100:103], v231, s[8:11], 0 offen offset:1024
    buffer_load_dwordx4 v[104:107], v231, s[8:11], 0 offen offset:2048
    buffer_load_dwordx4 v[108:111], v231, s[8:11], 0 offen offset:3072
    s_lshl_b32 s42, s36, 6
    v_add_u32 v227, s42, v224
    v_mul_u32_u24 v208, 32, v227
    v_lshrrev_b32 v208, 8, v208
    v_mul_u32_u24 v209, 8, v208
    v_sub_u32 v209, v227, v209
    v_lshrrev_b32 v210, 1, v208
    v_and_b32 v210, 1, v210
    v_lshlrev_b32 v210, 2, v210
    v_xor_b32 v209, v209, v210
    v_mul_u32_u24 v227, 3584, v208
    v_lshl_add_u32 v227, v209, 4, v227
    v_add_u32 v228, s42, v224
    v_add_u32 v228, 256, v228
    v_mul_u32_u24 v208, 32, v228
    v_lshrrev_b32 v208, 8, v208
    v_mul_u32_u24 v209, 8, v208
    v_sub_u32 v209, v228, v209
    v_lshrrev_b32 v210, 1, v208
    v_and_b32 v210, 1, v210
    v_lshlrev_b32 v210, 2, v210
    v_xor_b32 v209, v209, v210
    v_mul_u32_u24 v228, 3584, v208
    v_lshl_add_u32 v228, v209, 4, v228
    v_add_u32 v229, s42, v224
    v_mul_u32_u24 v208, 32, v229
    v_lshrrev_b32 v208, 8, v208
    v_mul_u32_u24 v209, 8, v208
    v_sub_u32 v209, v229, v209
    v_lshrrev_b32 v210, 1, v208
    v_and_b32 v210, 1, v210
    v_lshlrev_b32 v210, 2, v210
    v_xor_b32 v209, v209, v210
    v_mul_u32_u24 v229, 3584, v208
    v_lshl_add_u32 v229, v209, 4, v229
    v_add_u32 v230, s42, v224
    v_add_u32 v230, 256, v230
    v_mul_u32_u24 v208, 32, v230
    v_lshrrev_b32 v208, 8, v208
    v_mul_u32_u24 v209, 8, v208
    v_sub_u32 v209, v230, v209
    v_lshrrev_b32 v210, 1, v208
    v_and_b32 v210, 1, v210
    v_lshlrev_b32 v210, 2, v210
    v_xor_b32 v209, v209, v210
    v_mul_u32_u24 v230, 3584, v208
    v_lshl_add_u32 v230, v209, 4, v230
    s_mul_i32 s43, s38, 128
    s_lshl_b32 s40, s43, 1
    s_lshl_b32 s39, s36, 10
    v_lshrrev_b32 v208, 5, v224
    v_lshlrev_b32 v208, 3, v208
    v_bfe_u32 v209, v224, 2, 2
    v_add_u32 v208, v208, v209
    v_mul_u32_u24 v225, 128, v208
    v_bfe_u32 v210, v224, 4, 1
    v_lshlrev_b32 v210, 5, v210
    v_and_b32 v211, 3, v224
    v_lshl_add_u32 v210, v211, 3, v210
    v_bfe_u32 v211, v224, 3, 1
    v_lshlrev_b32 v211, 6, v211
    v_add3_u32 v226, v225, v210, v211
    v_sub_u32 v211, v210, v211
    v_add_u32 v225, v225, v211
    s_add_u32 s42, s40, 0x0
    s_add_u32 m0, s39, 0
    buffer_load_dwordx4 v227, s[12:15], s42 offen lds
    s_add_u32 s42, s40, 0x0
    s_add_u32 m0, s39, 4096
    buffer_load_dwordx4 v228, s[12:15], s42 offen lds
    s_add_u32 s42, s40, 0x0
    s_add_u32 m0, s39, 8192
    buffer_load_dwordx4 v229, s[16:19], s42 offen lds
    s_add_u32 s42, s40, 0x0
    s_add_u32 m0, s39, 12288
    buffer_load_dwordx4 v230, s[16:19], s42 offen lds
    s_add_u32 s42, s40, 0x38000
    s_add_u32 m0, s39, 16384
    buffer_load_dwordx4 v227, s[12:15], s42 offen lds
    s_add_u32 s42, s40, 0x38000
    s_add_u32 m0, s39, 20480
    buffer_load_dwordx4 v228, s[12:15], s42 offen lds
    s_add_u32 s42, s40, 0x38000
    s_add_u32 m0, s39, 24576
    buffer_load_dwordx4 v229, s[16:19], s42 offen lds
    s_add_u32 s42, s40, 0x38000
    s_add_u32 m0, s39, 28672
    buffer_load_dwordx4 v230, s[16:19], s42 offen lds
    s_waitcnt vmcnt(8)
    v_mov_b32 v208, 0x3f803f80
    v_mov_b32 v209, 0
    v_mov_b32 v210, 0
    v_dot2_f32_bf16 v209, v0, v208, v209
    v_dot2_f32_bf16 v210, v1, v208, v210
    v_dot2_f32_bf16 v209, v2, v208, v209
    v_dot2_f32_bf16 v210, v3, v208, v210
    v_dot2_f32_bf16 v209, v4, v208, v209
    v_dot2_f32_bf16 v210, v5, v208, v210
    v_dot2_f32_bf16 v209, v6, v208, v209
    v_dot2_f32_bf16 v210, v7, v208, v210
    v_dot2_f32_bf16 v209, v8, v208, v209
    v_dot2_f32_bf16 v210, v9, v208, v210
    v_dot2_f32_bf16 v209, v10, v208, v209
    v_dot2_f32_bf16 v210, v11, v208, v210
    v_dot2_f32_bf16 v209, v12, v208, v209
    v_dot2_f32_bf16 v210, v13, v208, v210
    v_dot2_f32_bf16 v209, v14, v208, v209
    v_dot2_f32_bf16 v210, v15, v208, v210
    v_dot2_f32_bf16 v209, v16, v208, v209
    v_dot2_f32_bf16 v210, v17, v208, v210
    v_dot2_f32_bf16 v209, v18, v208, v209
    v_dot2_f32_bf16 v210, v19, v208, v210
    v_dot2_f32_bf16 v209, v20, v208, v209
    v_dot2_f32_bf16 v210, v21, v208, v210
    v_dot2_f32_bf16 v209, v22, v208, v209
    v_dot2_f32_bf16 v210, v23, v208, v210
    v_dot2_f32_bf16 v209, v24, v208, v209
    v_dot2_f32_bf16 v210, v25, v208, v210
    v_dot2_f32_bf16 v209, v26, v208, v209
    v_dot2_f32_bf16 v210, v27, v208, v210
    v_dot2_f32_bf16 v209, v28, v208, v209
    v_dot2_f32_bf16 v210, v29, v208, v210
    v_dot2_f32_bf16 v209, v30, v208, v209
    v_dot2_f32_bf16 v210, v31, v208, v210
    v_dot2_f32_bf16 v209, v32, v208, v209
    v_dot2_f32_bf16 v210, v33, v208, v210
    v_dot2_f32_bf16 v209, v34, v208, v209
    v_dot2_f32_bf16 v210, v35, v208, v210
    v_dot2_f32_bf16 v209, v36, v208, v209
    v_dot2_f32_bf16 v210, v37, v208, v210
    v_dot2_f32_bf16 v209, v38, v208, v209
    v_dot2_f32_bf16 v210, v39, v208, v210
    v_dot2_f32_bf16 v209, v40, v208, v209
    v_dot2_f32_bf16 v210, v41, v208, v210
    v_dot2_f32_bf16 v209, v42, v208, v209
    v_dot2_f32_bf16 v210, v43, v208, v210
    v_dot2_f32_bf16 v209, v44, v208, v209
    v_dot2_f32_bf16 v210, v45, v208, v210
    v_dot2_f32_bf16 v209, v46, v208, v209
    v_dot2_f32_bf16 v210, v47, v208, v210
    v_dot2_f32_bf16 v209, v48, v208, v209
    v_dot2_f32_bf16 v210, v49, v208, v210
    v_dot2_f32_bf16 v209, v50, v208, v209
    v_dot2_f32_bf16 v210, v51, v208, v210
    v_dot2_f32_bf16 v209, v52, v208, v209
    v_dot2_f32_bf16 v210, v53, v208, v210
    v_dot2_f32_bf16 v209, v54, v208, v209
    v_dot2_f32_bf16 v210, v55, v208, v210
    v_dot2_f32_bf16 v209, v56, v208, v209
    v_dot2_f32_bf16 v210, v57, v208, v210
    v_dot2_f32_bf16 v209, v58, v208, v209
    v_dot2_f32_bf16 v210, v59, v208, v210
    v_dot2_f32_bf16 v209, v60, v208, v209
    v_dot2_f32_bf16 v210, v61, v208, v210
    v_dot2_f32_bf16 v209, v62, v208, v209
    v_dot2_f32_bf16 v210, v63, v208, v210
    v_dot2_f32_bf16 v209, v64, v208, v209
    v_dot2_f32_bf16 v210, v65, v208, v210
    v_dot2_f32_bf16 v209, v66, v208, v209
    v_dot2_f32_bf16 v210, v67, v208, v210
    v_dot2_f32_bf16 v209, v68, v208, v209
    v_dot2_f32_bf16 v210, v69, v208, v210
    v_dot2_f32_bf16 v209, v70, v208, v209
    v_dot2_f32_bf16 v210, v71, v208, v210
    v_dot2_f32_bf16 v209, v72, v208, v209
    v_dot2_f32_bf16 v210, v73, v208, v210
    v_dot2_f32_bf16 v209, v74, v208, v209
    v_dot2_f32_bf16 v210, v75, v208, v210
    v_dot2_f32_bf16 v209, v76, v208, v209
    v_dot2_f32_bf16 v210, v77, v208, v210
    v_dot2_f32_bf16 v209, v78, v208, v209
    v_dot2_f32_bf16 v210, v79, v208, v210
    v_dot2_f32_bf16 v209, v80, v208, v209
    v_dot2_f32_bf16 v210, v81, v208, v210
    v_dot2_f32_bf16 v209, v82, v208, v209
    v_dot2_f32_bf16 v210, v83, v208, v210
    v_dot2_f32_bf16 v209, v84, v208, v209
    v_dot2_f32_bf16 v210, v85, v208, v210
    v_dot2_f32_bf16 v209, v86, v208, v209
    v_dot2_f32_bf16 v210, v87, v208, v210
    v_dot2_f32_bf16 v209, v88, v208, v209
    v_dot2_f32_bf16 v210, v89, v208, v210
    v_dot2_f32_bf16 v209, v90, v208, v209
    v_dot2_f32_bf16 v210, v91, v208, v210
    v_dot2_f32_bf16 v209, v92, v208, v209
    v_dot2_f32_bf16 v210, v93, v208, v210
    v_dot2_f32_bf16 v209, v94, v208, v209
    v_dot2_f32_bf16 v210, v95, v208, v210
    v_dot2_f32_bf16 v209, v96, v208, v209
    v_dot2_f32_bf16 v210, v97, v208, v210
    v_dot2_f32_bf16 v209, v98, v208, v209
    v_dot2_f32_bf16 v210, v99, v208, v210
    v_dot2_f32_bf16 v209, v100, v208, v209
    v_dot2_f32_bf16 v210, v101, v208, v210
    v_dot2_f32_bf16 v209, v102, v208, v209
    v_dot2_f32_bf16 v210, v103, v208, v210
    v_dot2_f32_bf16 v209, v104, v208, v209
    v_dot2_f32_bf16 v210, v105, v208, v210
    v_dot2_f32_bf16 v209, v106, v208, v209
    v_dot2_f32_bf16 v210, v107, v208, v210
    v_dot2_f32_bf16 v209, v108, v208, v209
    v_dot2_f32_bf16 v210, v109, v208, v210
    v_dot2_f32_bf16 v209, v110, v208, v209
    v_dot2_f32_bf16 v210, v111, v208, v210
    s_nop 3
    v_add_f32 v209, v209, v210
    v_mov_b32 v211, v209
    s_nop 1
    v_permlane32_swap_b32 v211, v209
    s_nop 1
    v_add_f32 v209, v209, v211
    v_mul_f32 v212, 0x3b124925, v209
    v_cvt_pk_bf16_f32 v213, v212, v212
    v_lshlrev_b32 v213, 16, v213
    v_sub_f32 v214, 0, v213
    v_mov_b32 v215, v214
    v_mov_b32 v216, 0
    v_mov_b32 v217, 0
    v_lshlrev_b32 v218, 16, v0
    v_and_b32 v219, 0xffff0000, v0
    v_pk_add_f32 v[218:219], v[218:219], v[214:215]
    v_pk_fma_f32 v[216:217], v[218:219], v[218:219], v[216:217]
    v_cvt_pk_bf16_f32 v0, v218, v219
    v_lshlrev_b32 v218, 16, v1
    v_and_b32 v219, 0xffff0000, v1
    v_pk_add_f32 v[218:219], v[218:219], v[214:215]
    v_pk_fma_f32 v[216:217], v[218:219], v[218:219], v[216:217]
    v_cvt_pk_bf16_f32 v1, v218, v219
    v_lshlrev_b32 v218, 16, v2
    v_and_b32 v219, 0xffff0000, v2
    v_pk_add_f32 v[218:219], v[218:219], v[214:215]
    v_pk_fma_f32 v[216:217], v[218:219], v[218:219], v[216:217]
    v_cvt_pk_bf16_f32 v2, v218, v219
    v_lshlrev_b32 v218, 16, v3
    v_and_b32 v219, 0xffff0000, v3
    v_pk_add_f32 v[218:219], v[218:219], v[214:215]
    v_pk_fma_f32 v[216:217], v[218:219], v[218:219], v[216:217]
    v_cvt_pk_bf16_f32 v3, v218, v219
    v_lshlrev_b32 v218, 16, v4
    v_and_b32 v219, 0xffff0000, v4
    v_pk_add_f32 v[218:219], v[218:219], v[214:215]
    v_pk_fma_f32 v[216:217], v[218:219], v[218:219], v[216:217]
    v_cvt_pk_bf16_f32 v4, v218, v219
    v_lshlrev_b32 v218, 16, v5
    v_and_b32 v219, 0xffff0000, v5
    v_pk_add_f32 v[218:219], v[218:219], v[214:215]
    v_pk_fma_f32 v[216:217], v[218:219], v[218:219], v[216:217]
    v_cvt_pk_bf16_f32 v5, v218, v219
    v_lshlrev_b32 v218, 16, v6
    v_and_b32 v219, 0xffff0000, v6
    v_pk_add_f32 v[218:219], v[218:219], v[214:215]
    v_pk_fma_f32 v[216:217], v[218:219], v[218:219], v[216:217]
    v_cvt_pk_bf16_f32 v6, v218, v219
    v_lshlrev_b32 v218, 16, v7
    v_and_b32 v219, 0xffff0000, v7
    v_pk_add_f32 v[218:219], v[218:219], v[214:215]
    v_pk_fma_f32 v[216:217], v[218:219], v[218:219], v[216:217]
    v_cvt_pk_bf16_f32 v7, v218, v219
    v_lshlrev_b32 v218, 16, v8
    v_and_b32 v219, 0xffff0000, v8
    v_pk_add_f32 v[218:219], v[218:219], v[214:215]
    v_pk_fma_f32 v[216:217], v[218:219], v[218:219], v[216:217]
    v_cvt_pk_bf16_f32 v8, v218, v219
    v_lshlrev_b32 v218, 16, v9
    v_and_b32 v219, 0xffff0000, v9
    v_pk_add_f32 v[218:219], v[218:219], v[214:215]
    v_pk_fma_f32 v[216:217], v[218:219], v[218:219], v[216:217]
    v_cvt_pk_bf16_f32 v9, v218, v219
    v_lshlrev_b32 v218, 16, v10
    v_and_b32 v219, 0xffff0000, v10
    v_pk_add_f32 v[218:219], v[218:219], v[214:215]
    v_pk_fma_f32 v[216:217], v[218:219], v[218:219], v[216:217]
    v_cvt_pk_bf16_f32 v10, v218, v219
    v_lshlrev_b32 v218, 16, v11
    v_and_b32 v219, 0xffff0000, v11
    v_pk_add_f32 v[218:219], v[218:219], v[214:215]
    v_pk_fma_f32 v[216:217], v[218:219], v[218:219], v[216:217]
    v_cvt_pk_bf16_f32 v11, v218, v219
    v_lshlrev_b32 v218, 16, v12
    v_and_b32 v219, 0xffff0000, v12
    v_pk_add_f32 v[218:219], v[218:219], v[214:215]
    v_pk_fma_f32 v[216:217], v[218:219], v[218:219], v[216:217]
    v_cvt_pk_bf16_f32 v12, v218, v219
    v_lshlrev_b32 v218, 16, v13
    v_and_b32 v219, 0xffff0000, v13
    v_pk_add_f32 v[218:219], v[218:219], v[214:215]
    v_pk_fma_f32 v[216:217], v[218:219], v[218:219], v[216:217]
    v_cvt_pk_bf16_f32 v13, v218, v219
    v_lshlrev_b32 v218, 16, v14
    v_and_b32 v219, 0xffff0000, v14
    v_pk_add_f32 v[218:219], v[218:219], v[214:215]
    v_pk_fma_f32 v[216:217], v[218:219], v[218:219], v[216:217]
    v_cvt_pk_bf16_f32 v14, v218, v219
    v_lshlrev_b32 v218, 16, v15
    v_and_b32 v219, 0xffff0000, v15
    v_pk_add_f32 v[218:219], v[218:219], v[214:215]
    v_pk_fma_f32 v[216:217], v[218:219], v[218:219], v[216:217]
    v_cvt_pk_bf16_f32 v15, v218, v219
    v_lshlrev_b32 v218, 16, v16
    v_and_b32 v219, 0xffff0000, v16
    v_pk_add_f32 v[218:219], v[218:219], v[214:215]
    v_pk_fma_f32 v[216:217], v[218:219], v[218:219], v[216:217]
    v_cvt_pk_bf16_f32 v16, v218, v219
    v_lshlrev_b32 v218, 16, v17
    v_and_b32 v219, 0xffff0000, v17
    v_pk_add_f32 v[218:219], v[218:219], v[214:215]
    v_pk_fma_f32 v[216:217], v[218:219], v[218:219], v[216:217]
    v_cvt_pk_bf16_f32 v17, v218, v219
    v_lshlrev_b32 v218, 16, v18
    v_and_b32 v219, 0xffff0000, v18
    v_pk_add_f32 v[218:219], v[218:219], v[214:215]
    v_pk_fma_f32 v[216:217], v[218:219], v[218:219], v[216:217]
    v_cvt_pk_bf16_f32 v18, v218, v219
    v_lshlrev_b32 v218, 16, v19
    v_and_b32 v219, 0xffff0000, v19
    v_pk_add_f32 v[218:219], v[218:219], v[214:215]
    v_pk_fma_f32 v[216:217], v[218:219], v[218:219], v[216:217]
    v_cvt_pk_bf16_f32 v19, v218, v219
    v_lshlrev_b32 v218, 16, v20
    v_and_b32 v219, 0xffff0000, v20
    v_pk_add_f32 v[218:219], v[218:219], v[214:215]
    v_pk_fma_f32 v[216:217], v[218:219], v[218:219], v[216:217]
    v_cvt_pk_bf16_f32 v20, v218, v219
    v_lshlrev_b32 v218, 16, v21
    v_and_b32 v219, 0xffff0000, v21
    v_pk_add_f32 v[218:219], v[218:219], v[214:215]
    v_pk_fma_f32 v[216:217], v[218:219], v[218:219], v[216:217]
    v_cvt_pk_bf16_f32 v21, v218, v219
    v_lshlrev_b32 v218, 16, v22
    v_and_b32 v219, 0xffff0000, v22
    v_pk_add_f32 v[218:219], v[218:219], v[214:215]
    v_pk_fma_f32 v[216:217], v[218:219], v[218:219], v[216:217]
    v_cvt_pk_bf16_f32 v22, v218, v219
    v_lshlrev_b32 v218, 16, v23
    v_and_b32 v219, 0xffff0000, v23
    v_pk_add_f32 v[218:219], v[218:219], v[214:215]
    v_pk_fma_f32 v[216:217], v[218:219], v[218:219], v[216:217]
    v_cvt_pk_bf16_f32 v23, v218, v219
    v_lshlrev_b32 v218, 16, v24
    v_and_b32 v219, 0xffff0000, v24
    v_pk_add_f32 v[218:219], v[218:219], v[214:215]
    v_pk_fma_f32 v[216:217], v[218:219], v[218:219], v[216:217]
    v_cvt_pk_bf16_f32 v24, v218, v219
    v_lshlrev_b32 v218, 16, v25
    v_and_b32 v219, 0xffff0000, v25
    v_pk_add_f32 v[218:219], v[218:219], v[214:215]
    v_pk_fma_f32 v[216:217], v[218:219], v[218:219], v[216:217]
    v_cvt_pk_bf16_f32 v25, v218, v219
    v_lshlrev_b32 v218, 16, v26
    v_and_b32 v219, 0xffff0000, v26
    v_pk_add_f32 v[218:219], v[218:219], v[214:215]
    v_pk_fma_f32 v[216:217], v[218:219], v[218:219], v[216:217]
    v_cvt_pk_bf16_f32 v26, v218, v219
    v_lshlrev_b32 v218, 16, v27
    v_and_b32 v219, 0xffff0000, v27
    v_pk_add_f32 v[218:219], v[218:219], v[214:215]
    v_pk_fma_f32 v[216:217], v[218:219], v[218:219], v[216:217]
    v_cvt_pk_bf16_f32 v27, v218, v219
    v_lshlrev_b32 v218, 16, v28
    v_and_b32 v219, 0xffff0000, v28
    v_pk_add_f32 v[218:219], v[218:219], v[214:215]
    v_pk_fma_f32 v[216:217], v[218:219], v[218:219], v[216:217]
    v_cvt_pk_bf16_f32 v28, v218, v219
    v_lshlrev_b32 v218, 16, v29
    v_and_b32 v219, 0xffff0000, v29
    v_pk_add_f32 v[218:219], v[218:219], v[214:215]
    v_pk_fma_f32 v[216:217], v[218:219], v[218:219], v[216:217]
    v_cvt_pk_bf16_f32 v29, v218, v219
    v_lshlrev_b32 v218, 16, v30
    v_and_b32 v219, 0xffff0000, v30
    v_pk_add_f32 v[218:219], v[218:219], v[214:215]
    v_pk_fma_f32 v[216:217], v[218:219], v[218:219], v[216:217]
    v_cvt_pk_bf16_f32 v30, v218, v219
    v_lshlrev_b32 v218, 16, v31
    v_and_b32 v219, 0xffff0000, v31
    v_pk_add_f32 v[218:219], v[218:219], v[214:215]
    v_pk_fma_f32 v[216:217], v[218:219], v[218:219], v[216:217]
    v_cvt_pk_bf16_f32 v31, v218, v219
    v_lshlrev_b32 v218, 16, v32
    v_and_b32 v219, 0xffff0000, v32
    v_pk_add_f32 v[218:219], v[218:219], v[214:215]
    v_pk_fma_f32 v[216:217], v[218:219], v[218:219], v[216:217]
    v_cvt_pk_bf16_f32 v32, v218, v219
    v_lshlrev_b32 v218, 16, v33
    v_and_b32 v219, 0xffff0000, v33
    v_pk_add_f32 v[218:219], v[218:219], v[214:215]
    v_pk_fma_f32 v[216:217], v[218:219], v[218:219], v[216:217]
    v_cvt_pk_bf16_f32 v33, v218, v219
    v_lshlrev_b32 v218, 16, v34
    v_and_b32 v219, 0xffff0000, v34
    v_pk_add_f32 v[218:219], v[218:219], v[214:215]
    v_pk_fma_f32 v[216:217], v[218:219], v[218:219], v[216:217]
    v_cvt_pk_bf16_f32 v34, v218, v219
    v_lshlrev_b32 v218, 16, v35
    v_and_b32 v219, 0xffff0000, v35
    v_pk_add_f32 v[218:219], v[218:219], v[214:215]
    v_pk_fma_f32 v[216:217], v[218:219], v[218:219], v[216:217]
    v_cvt_pk_bf16_f32 v35, v218, v219
    v_lshlrev_b32 v218, 16, v36
    v_and_b32 v219, 0xffff0000, v36
    v_pk_add_f32 v[218:219], v[218:219], v[214:215]
    v_pk_fma_f32 v[216:217], v[218:219], v[218:219], v[216:217]
    v_cvt_pk_bf16_f32 v36, v218, v219
    v_lshlrev_b32 v218, 16, v37
    v_and_b32 v219, 0xffff0000, v37
    v_pk_add_f32 v[218:219], v[218:219], v[214:215]
    v_pk_fma_f32 v[216:217], v[218:219], v[218:219], v[216:217]
    v_cvt_pk_bf16_f32 v37, v218, v219
    v_lshlrev_b32 v218, 16, v38
    v_and_b32 v219, 0xffff0000, v38
    v_pk_add_f32 v[218:219], v[218:219], v[214:215]
    v_pk_fma_f32 v[216:217], v[218:219], v[218:219], v[216:217]
    v_cvt_pk_bf16_f32 v38, v218, v219
    v_lshlrev_b32 v218, 16, v39
    v_and_b32 v219, 0xffff0000, v39
    v_pk_add_f32 v[218:219], v[218:219], v[214:215]
    v_pk_fma_f32 v[216:217], v[218:219], v[218:219], v[216:217]
    v_cvt_pk_bf16_f32 v39, v218, v219
    v_lshlrev_b32 v218, 16, v40
    v_and_b32 v219, 0xffff0000, v40
    v_pk_add_f32 v[218:219], v[218:219], v[214:215]
    v_pk_fma_f32 v[216:217], v[218:219], v[218:219], v[216:217]
    v_cvt_pk_bf16_f32 v40, v218, v219
    v_lshlrev_b32 v218, 16, v41
    v_and_b32 v219, 0xffff0000, v41
    v_pk_add_f32 v[218:219], v[218:219], v[214:215]
    v_pk_fma_f32 v[216:217], v[218:219], v[218:219], v[216:217]
    v_cvt_pk_bf16_f32 v41, v218, v219
    v_lshlrev_b32 v218, 16, v42
    v_and_b32 v219, 0xffff0000, v42
    v_pk_add_f32 v[218:219], v[218:219], v[214:215]
    v_pk_fma_f32 v[216:217], v[218:219], v[218:219], v[216:217]
    v_cvt_pk_bf16_f32 v42, v218, v219
    v_lshlrev_b32 v218, 16, v43
    v_and_b32 v219, 0xffff0000, v43
    v_pk_add_f32 v[218:219], v[218:219], v[214:215]
    v_pk_fma_f32 v[216:217], v[218:219], v[218:219], v[216:217]
    v_cvt_pk_bf16_f32 v43, v218, v219
    v_lshlrev_b32 v218, 16, v44
    v_and_b32 v219, 0xffff0000, v44
    v_pk_add_f32 v[218:219], v[218:219], v[214:215]
    v_pk_fma_f32 v[216:217], v[218:219], v[218:219], v[216:217]
    v_cvt_pk_bf16_f32 v44, v218, v219
    v_lshlrev_b32 v218, 16, v45
    v_and_b32 v219, 0xffff0000, v45
    v_pk_add_f32 v[218:219], v[218:219], v[214:215]
    v_pk_fma_f32 v[216:217], v[218:219], v[218:219], v[216:217]
    v_cvt_pk_bf16_f32 v45, v218, v219
    v_lshlrev_b32 v218, 16, v46
    v_and_b32 v219, 0xffff0000, v46
    v_pk_add_f32 v[218:219], v[218:219], v[214:215]
    v_pk_fma_f32 v[216:217], v[218:219], v[218:219], v[216:217]
    v_cvt_pk_bf16_f32 v46, v218, v219
    v_lshlrev_b32 v218, 16, v47
    v_and_b32 v219, 0xffff0000, v47
    v_pk_add_f32 v[218:219], v[218:219], v[214:215]
    v_pk_fma_f32 v[216:217], v[218:219], v[218:219], v[216:217]
    v_cvt_pk_bf16_f32 v47, v218, v219
    v_lshlrev_b32 v218, 16, v48
    v_and_b32 v219, 0xffff0000, v48
    v_pk_add_f32 v[218:219], v[218:219], v[214:215]
    v_pk_fma_f32 v[216:217], v[218:219], v[218:219], v[216:217]
    v_cvt_pk_bf16_f32 v48, v218, v219
    v_lshlrev_b32 v218, 16, v49
    v_and_b32 v219, 0xffff0000, v49
    v_pk_add_f32 v[218:219], v[218:219], v[214:215]
    v_pk_fma_f32 v[216:217], v[218:219], v[218:219], v[216:217]
    v_cvt_pk_bf16_f32 v49, v218, v219
    v_lshlrev_b32 v218, 16, v50
    v_and_b32 v219, 0xffff0000, v50
    v_pk_add_f32 v[218:219], v[218:219], v[214:215]
    v_pk_fma_f32 v[216:217], v[218:219], v[218:219], v[216:217]
    v_cvt_pk_bf16_f32 v50, v218, v219
    v_lshlrev_b32 v218, 16, v51
    v_and_b32 v219, 0xffff0000, v51
    v_pk_add_f32 v[218:219], v[218:219], v[214:215]
    v_pk_fma_f32 v[216:217], v[218:219], v[218:219], v[216:217]
    v_cvt_pk_bf16_f32 v51, v218, v219
    v_lshlrev_b32 v218, 16, v52
    v_and_b32 v219, 0xffff0000, v52
    v_pk_add_f32 v[218:219], v[218:219], v[214:215]
    v_pk_fma_f32 v[216:217], v[218:219], v[218:219], v[216:217]
    v_cvt_pk_bf16_f32 v52, v218, v219
    v_lshlrev_b32 v218, 16, v53
    v_and_b32 v219, 0xffff0000, v53
    v_pk_add_f32 v[218:219], v[218:219], v[214:215]
    v_pk_fma_f32 v[216:217], v[218:219], v[218:219], v[216:217]
    v_cvt_pk_bf16_f32 v53, v218, v219
    v_lshlrev_b32 v218, 16, v54
    v_and_b32 v219, 0xffff0000, v54
    v_pk_add_f32 v[218:219], v[218:219], v[214:215]
    v_pk_fma_f32 v[216:217], v[218:219], v[218:219], v[216:217]
    v_cvt_pk_bf16_f32 v54, v218, v219
    v_lshlrev_b32 v218, 16, v55
    v_and_b32 v219, 0xffff0000, v55
    v_pk_add_f32 v[218:219], v[218:219], v[214:215]
    v_pk_fma_f32 v[216:217], v[218:219], v[218:219], v[216:217]
    v_cvt_pk_bf16_f32 v55, v218, v219
    v_lshlrev_b32 v218, 16, v56
    v_and_b32 v219, 0xffff0000, v56
    v_pk_add_f32 v[218:219], v[218:219], v[214:215]
    v_pk_fma_f32 v[216:217], v[218:219], v[218:219], v[216:217]
    v_cvt_pk_bf16_f32 v56, v218, v219
    v_lshlrev_b32 v218, 16, v57
    v_and_b32 v219, 0xffff0000, v57
    v_pk_add_f32 v[218:219], v[218:219], v[214:215]
    v_pk_fma_f32 v[216:217], v[218:219], v[218:219], v[216:217]
    v_cvt_pk_bf16_f32 v57, v218, v219
    v_lshlrev_b32 v218, 16, v58
    v_and_b32 v219, 0xffff0000, v58
    v_pk_add_f32 v[218:219], v[218:219], v[214:215]
    v_pk_fma_f32 v[216:217], v[218:219], v[218:219], v[216:217]
    v_cvt_pk_bf16_f32 v58, v218, v219
    v_lshlrev_b32 v218, 16, v59
    v_and_b32 v219, 0xffff0000, v59
    v_pk_add_f32 v[218:219], v[218:219], v[214:215]
    v_pk_fma_f32 v[216:217], v[218:219], v[218:219], v[216:217]
    v_cvt_pk_bf16_f32 v59, v218, v219
    v_lshlrev_b32 v218, 16, v60
    v_and_b32 v219, 0xffff0000, v60
    v_pk_add_f32 v[218:219], v[218:219], v[214:215]
    v_pk_fma_f32 v[216:217], v[218:219], v[218:219], v[216:217]
    v_cvt_pk_bf16_f32 v60, v218, v219
    v_lshlrev_b32 v218, 16, v61
    v_and_b32 v219, 0xffff0000, v61
    v_pk_add_f32 v[218:219], v[218:219], v[214:215]
    v_pk_fma_f32 v[216:217], v[218:219], v[218:219], v[216:217]
    v_cvt_pk_bf16_f32 v61, v218, v219
    v_lshlrev_b32 v218, 16, v62
    v_and_b32 v219, 0xffff0000, v62
    v_pk_add_f32 v[218:219], v[218:219], v[214:215]
    v_pk_fma_f32 v[216:217], v[218:219], v[218:219], v[216:217]
    v_cvt_pk_bf16_f32 v62, v218, v219
    v_lshlrev_b32 v218, 16, v63
    v_and_b32 v219, 0xffff0000, v63
    v_pk_add_f32 v[218:219], v[218:219], v[214:215]
    v_pk_fma_f32 v[216:217], v[218:219], v[218:219], v[216:217]
    v_cvt_pk_bf16_f32 v63, v218, v219
    v_lshlrev_b32 v218, 16, v64
    v_and_b32 v219, 0xffff0000, v64
    v_pk_add_f32 v[218:219], v[218:219], v[214:215]
    v_pk_fma_f32 v[216:217], v[218:219], v[218:219], v[216:217]
    v_cvt_pk_bf16_f32 v64, v218, v219
    v_lshlrev_b32 v218, 16, v65
    v_and_b32 v219, 0xffff0000, v65
    v_pk_add_f32 v[218:219], v[218:219], v[214:215]
    v_pk_fma_f32 v[216:217], v[218:219], v[218:219], v[216:217]
    v_cvt_pk_bf16_f32 v65, v218, v219
    v_lshlrev_b32 v218, 16, v66
    v_and_b32 v219, 0xffff0000, v66
    v_pk_add_f32 v[218:219], v[218:219], v[214:215]
    v_pk_fma_f32 v[216:217], v[218:219], v[218:219], v[216:217]
    v_cvt_pk_bf16_f32 v66, v218, v219
    v_lshlrev_b32 v218, 16, v67
    v_and_b32 v219, 0xffff0000, v67
    v_pk_add_f32 v[218:219], v[218:219], v[214:215]
    v_pk_fma_f32 v[216:217], v[218:219], v[218:219], v[216:217]
    v_cvt_pk_bf16_f32 v67, v218, v219
    v_lshlrev_b32 v218, 16, v68
    v_and_b32 v219, 0xffff0000, v68
    v_pk_add_f32 v[218:219], v[218:219], v[214:215]
    v_pk_fma_f32 v[216:217], v[218:219], v[218:219], v[216:217]
    v_cvt_pk_bf16_f32 v68, v218, v219
    v_lshlrev_b32 v218, 16, v69
    v_and_b32 v219, 0xffff0000, v69
    v_pk_add_f32 v[218:219], v[218:219], v[214:215]
    v_pk_fma_f32 v[216:217], v[218:219], v[218:219], v[216:217]
    v_cvt_pk_bf16_f32 v69, v218, v219
    v_lshlrev_b32 v218, 16, v70
    v_and_b32 v219, 0xffff0000, v70
    v_pk_add_f32 v[218:219], v[218:219], v[214:215]
    v_pk_fma_f32 v[216:217], v[218:219], v[218:219], v[216:217]
    v_cvt_pk_bf16_f32 v70, v218, v219
    v_lshlrev_b32 v218, 16, v71
    v_and_b32 v219, 0xffff0000, v71
    v_pk_add_f32 v[218:219], v[218:219], v[214:215]
    v_pk_fma_f32 v[216:217], v[218:219], v[218:219], v[216:217]
    v_cvt_pk_bf16_f32 v71, v218, v219
    v_lshlrev_b32 v218, 16, v72
    v_and_b32 v219, 0xffff0000, v72
    v_pk_add_f32 v[218:219], v[218:219], v[214:215]
    v_pk_fma_f32 v[216:217], v[218:219], v[218:219], v[216:217]
    v_cvt_pk_bf16_f32 v72, v218, v219
    v_lshlrev_b32 v218, 16, v73
    v_and_b32 v219, 0xffff0000, v73
    v_pk_add_f32 v[218:219], v[218:219], v[214:215]
    v_pk_fma_f32 v[216:217], v[218:219], v[218:219], v[216:217]
    v_cvt_pk_bf16_f32 v73, v218, v219
    v_lshlrev_b32 v218, 16, v74
    v_and_b32 v219, 0xffff0000, v74
    v_pk_add_f32 v[218:219], v[218:219], v[214:215]
    v_pk_fma_f32 v[216:217], v[218:219], v[218:219], v[216:217]
    v_cvt_pk_bf16_f32 v74, v218, v219
    v_lshlrev_b32 v218, 16, v75
    v_and_b32 v219, 0xffff0000, v75
    v_pk_add_f32 v[218:219], v[218:219], v[214:215]
    v_pk_fma_f32 v[216:217], v[218:219], v[218:219], v[216:217]
    v_cvt_pk_bf16_f32 v75, v218, v219
    v_lshlrev_b32 v218, 16, v76
    v_and_b32 v219, 0xffff0000, v76
    v_pk_add_f32 v[218:219], v[218:219], v[214:215]
    v_pk_fma_f32 v[216:217], v[218:219], v[218:219], v[216:217]
    v_cvt_pk_bf16_f32 v76, v218, v219
    v_lshlrev_b32 v218, 16, v77
    v_and_b32 v219, 0xffff0000, v77
    v_pk_add_f32 v[218:219], v[218:219], v[214:215]
    v_pk_fma_f32 v[216:217], v[218:219], v[218:219], v[216:217]
    v_cvt_pk_bf16_f32 v77, v218, v219
    v_lshlrev_b32 v218, 16, v78
    v_and_b32 v219, 0xffff0000, v78
    v_pk_add_f32 v[218:219], v[218:219], v[214:215]
    v_pk_fma_f32 v[216:217], v[218:219], v[218:219], v[216:217]
    v_cvt_pk_bf16_f32 v78, v218, v219
    v_lshlrev_b32 v218, 16, v79
    v_and_b32 v219, 0xffff0000, v79
    v_pk_add_f32 v[218:219], v[218:219], v[214:215]
    v_pk_fma_f32 v[216:217], v[218:219], v[218:219], v[216:217]
    v_cvt_pk_bf16_f32 v79, v218, v219
    v_lshlrev_b32 v218, 16, v80
    v_and_b32 v219, 0xffff0000, v80
    v_pk_add_f32 v[218:219], v[218:219], v[214:215]
    v_pk_fma_f32 v[216:217], v[218:219], v[218:219], v[216:217]
    v_cvt_pk_bf16_f32 v80, v218, v219
    v_lshlrev_b32 v218, 16, v81
    v_and_b32 v219, 0xffff0000, v81
    v_pk_add_f32 v[218:219], v[218:219], v[214:215]
    v_pk_fma_f32 v[216:217], v[218:219], v[218:219], v[216:217]
    v_cvt_pk_bf16_f32 v81, v218, v219
    v_lshlrev_b32 v218, 16, v82
    v_and_b32 v219, 0xffff0000, v82
    v_pk_add_f32 v[218:219], v[218:219], v[214:215]
    v_pk_fma_f32 v[216:217], v[218:219], v[218:219], v[216:217]
    v_cvt_pk_bf16_f32 v82, v218, v219
    v_lshlrev_b32 v218, 16, v83
    v_and_b32 v219, 0xffff0000, v83
    v_pk_add_f32 v[218:219], v[218:219], v[214:215]
    v_pk_fma_f32 v[216:217], v[218:219], v[218:219], v[216:217]
    v_cvt_pk_bf16_f32 v83, v218, v219
    v_lshlrev_b32 v218, 16, v84
    v_and_b32 v219, 0xffff0000, v84
    v_pk_add_f32 v[218:219], v[218:219], v[214:215]
    v_pk_fma_f32 v[216:217], v[218:219], v[218:219], v[216:217]
    v_cvt_pk_bf16_f32 v84, v218, v219
    v_lshlrev_b32 v218, 16, v85
    v_and_b32 v219, 0xffff0000, v85
    v_pk_add_f32 v[218:219], v[218:219], v[214:215]
    v_pk_fma_f32 v[216:217], v[218:219], v[218:219], v[216:217]
    v_cvt_pk_bf16_f32 v85, v218, v219
    v_lshlrev_b32 v218, 16, v86
    v_and_b32 v219, 0xffff0000, v86
    v_pk_add_f32 v[218:219], v[218:219], v[214:215]
    v_pk_fma_f32 v[216:217], v[218:219], v[218:219], v[216:217]
    v_cvt_pk_bf16_f32 v86, v218, v219
    v_lshlrev_b32 v218, 16, v87
    v_and_b32 v219, 0xffff0000, v87
    v_pk_add_f32 v[218:219], v[218:219], v[214:215]
    v_pk_fma_f32 v[216:217], v[218:219], v[218:219], v[216:217]
    v_cvt_pk_bf16_f32 v87, v218, v219
    v_lshlrev_b32 v218, 16, v88
    v_and_b32 v219, 0xffff0000, v88
    v_pk_add_f32 v[218:219], v[218:219], v[214:215]
    v_pk_fma_f32 v[216:217], v[218:219], v[218:219], v[216:217]
    v_cvt_pk_bf16_f32 v88, v218, v219
    v_lshlrev_b32 v218, 16, v89
    v_and_b32 v219, 0xffff0000, v89
    v_pk_add_f32 v[218:219], v[218:219], v[214:215]
    v_pk_fma_f32 v[216:217], v[218:219], v[218:219], v[216:217]
    v_cvt_pk_bf16_f32 v89, v218, v219
    v_lshlrev_b32 v218, 16, v90
    v_and_b32 v219, 0xffff0000, v90
    v_pk_add_f32 v[218:219], v[218:219], v[214:215]
    v_pk_fma_f32 v[216:217], v[218:219], v[218:219], v[216:217]
    v_cvt_pk_bf16_f32 v90, v218, v219
    v_lshlrev_b32 v218, 16, v91
    v_and_b32 v219, 0xffff0000, v91
    v_pk_add_f32 v[218:219], v[218:219], v[214:215]
    v_pk_fma_f32 v[216:217], v[218:219], v[218:219], v[216:217]
    v_cvt_pk_bf16_f32 v91, v218, v219
    v_lshlrev_b32 v218, 16, v92
    v_and_b32 v219, 0xffff0000, v92
    v_pk_add_f32 v[218:219], v[218:219], v[214:215]
    v_pk_fma_f32 v[216:217], v[218:219], v[218:219], v[216:217]
    v_cvt_pk_bf16_f32 v92, v218, v219
    v_lshlrev_b32 v218, 16, v93
    v_and_b32 v219, 0xffff0000, v93
    v_pk_add_f32 v[218:219], v[218:219], v[214:215]
    v_pk_fma_f32 v[216:217], v[218:219], v[218:219], v[216:217]
    v_cvt_pk_bf16_f32 v93, v218, v219
    v_lshlrev_b32 v218, 16, v94
    v_and_b32 v219, 0xffff0000, v94
    v_pk_add_f32 v[218:219], v[218:219], v[214:215]
    v_pk_fma_f32 v[216:217], v[218:219], v[218:219], v[216:217]
    v_cvt_pk_bf16_f32 v94, v218, v219
    v_lshlrev_b32 v218, 16, v95
    v_and_b32 v219, 0xffff0000, v95
    v_pk_add_f32 v[218:219], v[218:219], v[214:215]
    v_pk_fma_f32 v[216:217], v[218:219], v[218:219], v[216:217]
    v_cvt_pk_bf16_f32 v95, v218, v219
    v_lshlrev_b32 v218, 16, v96
    v_and_b32 v219, 0xffff0000, v96
    v_pk_add_f32 v[218:219], v[218:219], v[214:215]
    v_pk_fma_f32 v[216:217], v[218:219], v[218:219], v[216:217]
    v_cvt_pk_bf16_f32 v96, v218, v219
    v_lshlrev_b32 v218, 16, v97
    v_and_b32 v219, 0xffff0000, v97
    v_pk_add_f32 v[218:219], v[218:219], v[214:215]
    v_pk_fma_f32 v[216:217], v[218:219], v[218:219], v[216:217]
    v_cvt_pk_bf16_f32 v97, v218, v219
    v_lshlrev_b32 v218, 16, v98
    v_and_b32 v219, 0xffff0000, v98
    v_pk_add_f32 v[218:219], v[218:219], v[214:215]
    v_pk_fma_f32 v[216:217], v[218:219], v[218:219], v[216:217]
    v_cvt_pk_bf16_f32 v98, v218, v219
    v_lshlrev_b32 v218, 16, v99
    v_and_b32 v219, 0xffff0000, v99
    v_pk_add_f32 v[218:219], v[218:219], v[214:215]
    v_pk_fma_f32 v[216:217], v[218:219], v[218:219], v[216:217]
    v_cvt_pk_bf16_f32 v99, v218, v219
    v_lshlrev_b32 v218, 16, v100
    v_and_b32 v219, 0xffff0000, v100
    v_pk_add_f32 v[218:219], v[218:219], v[214:215]
    v_pk_fma_f32 v[216:217], v[218:219], v[218:219], v[216:217]
    v_cvt_pk_bf16_f32 v100, v218, v219
    v_lshlrev_b32 v218, 16, v101
    v_and_b32 v219, 0xffff0000, v101
    v_pk_add_f32 v[218:219], v[218:219], v[214:215]
    v_pk_fma_f32 v[216:217], v[218:219], v[218:219], v[216:217]
    v_cvt_pk_bf16_f32 v101, v218, v219
    v_lshlrev_b32 v218, 16, v102
    v_and_b32 v219, 0xffff0000, v102
    v_pk_add_f32 v[218:219], v[218:219], v[214:215]
    v_pk_fma_f32 v[216:217], v[218:219], v[218:219], v[216:217]
    v_cvt_pk_bf16_f32 v102, v218, v219
    v_lshlrev_b32 v218, 16, v103
    v_and_b32 v219, 0xffff0000, v103
    v_pk_add_f32 v[218:219], v[218:219], v[214:215]
    v_pk_fma_f32 v[216:217], v[218:219], v[218:219], v[216:217]
    v_cvt_pk_bf16_f32 v103, v218, v219
    v_lshlrev_b32 v218, 16, v104
    v_and_b32 v219, 0xffff0000, v104
    v_pk_add_f32 v[218:219], v[218:219], v[214:215]
    v_pk_fma_f32 v[216:217], v[218:219], v[218:219], v[216:217]
    v_cvt_pk_bf16_f32 v104, v218, v219
    v_lshlrev_b32 v218, 16, v105
    v_and_b32 v219, 0xffff0000, v105
    v_pk_add_f32 v[218:219], v[218:219], v[214:215]
    v_pk_fma_f32 v[216:217], v[218:219], v[218:219], v[216:217]
    v_cvt_pk_bf16_f32 v105, v218, v219
    v_lshlrev_b32 v218, 16, v106
    v_and_b32 v219, 0xffff0000, v106
    v_pk_add_f32 v[218:219], v[218:219], v[214:215]
    v_pk_fma_f32 v[216:217], v[218:219], v[218:219], v[216:217]
    v_cvt_pk_bf16_f32 v106, v218, v219
    v_lshlrev_b32 v218, 16, v107
    v_and_b32 v219, 0xffff0000, v107
    v_pk_add_f32 v[218:219], v[218:219], v[214:215]
    v_pk_fma_f32 v[216:217], v[218:219], v[218:219], v[216:217]
    v_cvt_pk_bf16_f32 v107, v218, v219
    v_lshlrev_b32 v218, 16, v108
    v_and_b32 v219, 0xffff0000, v108
    v_pk_add_f32 v[218:219], v[218:219], v[214:215]
    v_pk_fma_f32 v[216:217], v[218:219], v[218:219], v[216:217]
    v_cvt_pk_bf16_f32 v108, v218, v219
    v_lshlrev_b32 v218, 16, v109
    v_and_b32 v219, 0xffff0000, v109
    v_pk_add_f32 v[218:219], v[218:219], v[214:215]
    v_pk_fma_f32 v[216:217], v[218:219], v[218:219], v[216:217]
    v_cvt_pk_bf16_f32 v109, v218, v219
    v_lshlrev_b32 v218, 16, v110
    v_and_b32 v219, 0xffff0000, v110
    v_pk_add_f32 v[218:219], v[218:219], v[214:215]
    v_pk_fma_f32 v[216:217], v[218:219], v[218:219], v[216:217]
    v_cvt_pk_bf16_f32 v110, v218, v219
    v_lshlrev_b32 v218, 16, v111
    v_and_b32 v219, 0xffff0000, v111
    v_pk_add_f32 v[218:219], v[218:219], v[214:215]
    v_pk_fma_f32 v[216:217], v[218:219], v[218:219], v[216:217]
    v_cvt_pk_bf16_f32 v111, v218, v219
    v_add_f32 v216, v216, v217
    v_mov_b32 v211, v216
    s_nop 1
    v_permlane32_swap_b32 v211, v216
    s_nop 1
    v_add_f32 v216, v216, v211
    v_sub_f32 v211, v212, v213
    v_mul_f32 v211, v211, v211
    v_mul_f32 v216, 0x3b124925, v216
    v_sub_f32 v216, v216, v211
    v_cvt_pk_bf16_f32 v216, v216, v216
    v_lshlrev_b32 v216, 16, v216
    v_add_f32 v216, 0x3727c5ac, v216
    v_cvt_pk_bf16_f32 v216, v216, v216
    v_lshlrev_b32 v216, 16, v216
    v_sqrt_f32 v216, v216
    s_nop 0
    v_cvt_pk_bf16_f32 v216, v216, v216
    v_lshlrev_b32 v216, 16, v216
    v_rcp_f32 v232, v216
    s_nop 0
    s_waitcnt vmcnt(4)
    s_barrier
    s_add_u32 s42, s40, 0x70000
    s_add_u32 m0, s39, 32768
    buffer_load_dwordx4 v227, s[12:15], s42 offen lds
    s_add_u32 s42, s40, 0x70000
    s_add_u32 m0, s39, 36864
    buffer_load_dwordx4 v228, s[12:15], s42 offen lds
    s_add_u32 s42, s40, 0x70000
    s_add_u32 m0, s39, 40960
    buffer_load_dwordx4 v229, s[16:19], s42 offen lds
    s_add_u32 s42, s40, 0x70000
    s_add_u32 m0, s39, 45056
    buffer_load_dwordx4 v230, s[16:19], s42 offen lds
    ds_read_b64_tr_b16 v[176:177], v226 offset:0
    ds_read_b64_tr_b16 v[178:179], v226 offset:512
    ds_read_b64_tr_b16 v[180:181], v225 offset:64
    ds_read_b64_tr_b16 v[182:183], v225 offset:576
    ds_read_b64_tr_b16 v[184:185], v226 offset:8192
    ds_read_b64_tr_b16 v[186:187], v226 offset:8704
    ds_read_b64_tr_b16 v[188:189], v225 offset:8256
    ds_read_b64_tr_b16 v[190:191], v225 offset:8768
    ds_read_b64_tr_b16 v[192:193], v226 offset:2048
    ds_read_b64_tr_b16 v[194:195], v226 offset:2560
    ds_read_b64_tr_b16 v[196:197], v225 offset:2112
    ds_read_b64_tr_b16 v[198:199], v225 offset:2624
    ds_read_b64_tr_b16 v[200:201], v226 offset:10240
    ds_read_b64_tr_b16 v[202:203], v226 offset:10752
    ds_read_b64_tr_b16 v[204:205], v225 offset:10304
    ds_read_b64_tr_b16 v[206:207], v225 offset:10816
    s_waitcnt lgkmcnt(8)
    v_mfma_f32_32x32x16_bf16 v[112:127], v[176:179], v[0:3], 0
    v_mfma_f32_32x32x16_bf16 v[128:143], v[180:183], v[0:3], 0
    v_mfma_f32_32x32x16_bf16 v[144:159], v[184:187], v[0:3], 0
    v_mfma_f32_32x32x16_bf16 v[160:175], v[188:191], v[0:3], 0
    ds_read_b64_tr_b16 v[176:177], v226 offset:4096
    ds_read_b64_tr_b16 v[178:179], v226 offset:4608
    ds_read_b64_tr_b16 v[180:181], v225 offset:4160
    ds_read_b64_tr_b16 v[182:183], v225 offset:4672
    ds_read_b64_tr_b16 v[184:185], v226 offset:12288
    ds_read_b64_tr_b16 v[186:187], v226 offset:12800
    ds_read_b64_tr_b16 v[188:189], v225 offset:12352
    ds_read_b64_tr_b16 v[190:191], v225 offset:12864
    s_waitcnt lgkmcnt(8)
    v_mfma_f32_32x32x16_bf16 v[112:127], v[192:195], v[4:7], v[112:127]
    v_mfma_f32_32x32x16_bf16 v[128:143], v[196:199], v[4:7], v[128:143]
    v_mfma_f32_32x32x16_bf16 v[144:159], v[200:203], v[4:7], v[144:159]
    v_mfma_f32_32x32x16_bf16 v[160:175], v[204:207], v[4:7], v[160:175]
    ds_read_b64_tr_b16 v[192:193], v226 offset:6144
    ds_read_b64_tr_b16 v[194:195], v226 offset:6656
    ds_read_b64_tr_b16 v[196:197], v225 offset:6208
    ds_read_b64_tr_b16 v[198:199], v225 offset:6720
    ds_read_b64_tr_b16 v[200:201], v226 offset:14336
    ds_read_b64_tr_b16 v[202:203], v226 offset:14848
    ds_read_b64_tr_b16 v[204:205], v225 offset:14400
    ds_read_b64_tr_b16 v[206:207], v225 offset:14912
    s_waitcnt lgkmcnt(8)
    v_mfma_f32_32x32x16_bf16 v[112:127], v[176:179], v[8:11], v[112:127]
    v_mfma_f32_32x32x16_bf16 v[128:143], v[180:183], v[8:11], v[128:143]
    v_mfma_f32_32x32x16_bf16 v[144:159], v[184:187], v[8:11], v[144:159]
    v_mfma_f32_32x32x16_bf16 v[160:175], v[188:191], v[8:11], v[160:175]
    s_waitcnt vmcnt(4)
    s_barrier
    s_add_u32 s42, s40, 0xa8000
    s_add_u32 m0, s39, 49152
    buffer_load_dwordx4 v227, s[12:15], s42 offen lds
    s_add_u32 s42, s40, 0xa8000
    s_add_u32 m0, s39, 53248
    buffer_load_dwordx4 v228, s[12:15], s42 offen lds
    s_add_u32 s42, s40, 0xa8000
    s_add_u32 m0, s39, 57344
    buffer_load_dwordx4 v229, s[16:19], s42 offen lds
    s_add_u32 s42, s40, 0xa8000
    s_add_u32 m0, s39, 61440
    buffer_load_dwordx4 v230, s[16:19], s42 offen lds
    ds_read_b64_tr_b16 v[176:177], v226 offset:16384
    ds_read_b64_tr_b16 v[178:179], v226 offset:16896
    ds_read_b64_tr_b16 v[180:181], v225 offset:16448
    ds_read_b64_tr_b16 v[182:183], v225 offset:16960
    ds_read_b64_tr_b16 v[184:185], v226 offset:24576
    ds_read_b64_tr_b16 v[186:187], v226 offset:25088
    ds_read_b64_tr_b16 v[188:189], v225 offset:24640
    ds_read_b64_tr_b16 v[190:191], v225 offset:25152
    s_waitcnt lgkmcnt(8)
    v_mfma_f32_32x32x16_bf16 v[112:127], v[192:195], v[12:15], v[112:127]
    v_mfma_f32_32x32x16_bf16 v[128:143], v[196:199], v[12:15], v[128:143]
    v_mfma_f32_32x32x16_bf16 v[144:159], v[200:203], v[12:15], v[144:159]
    v_mfma_f32_32x32x16_bf16 v[160:175], v[204:207], v[12:15], v[160:175]
    ds_read_b64_tr_b16 v[192:193], v226 offset:18432
    ds_read_b64_tr_b16 v[194:195], v226 offset:18944
    ds_read_b64_tr_b16 v[196:197], v225 offset:18496
    ds_read_b64_tr_b16 v[198:199], v225 offset:19008
    ds_read_b64_tr_b16 v[200:201], v226 offset:26624
    ds_read_b64_tr_b16 v[202:203], v226 offset:27136
    ds_read_b64_tr_b16 v[204:205], v225 offset:26688
    ds_read_b64_tr_b16 v[206:207], v225 offset:27200
    s_waitcnt lgkmcnt(8)
    v_mfma_f32_32x32x16_bf16 v[112:127], v[176:179], v[16:19], v[112:127]
    v_mfma_f32_32x32x16_bf16 v[128:143], v[180:183], v[16:19], v[128:143]
    v_mfma_f32_32x32x16_bf16 v[144:159], v[184:187], v[16:19], v[144:159]
    v_mfma_f32_32x32x16_bf16 v[160:175], v[188:191], v[16:19], v[160:175]
    ds_read_b64_tr_b16 v[176:177], v226 offset:20480
    ds_read_b64_tr_b16 v[178:179], v226 offset:20992
    ds_read_b64_tr_b16 v[180:181], v225 offset:20544
    ds_read_b64_tr_b16 v[182:183], v225 offset:21056
    ds_read_b64_tr_b16 v[184:185], v226 offset:28672
    ds_read_b64_tr_b16 v[186:187], v226 offset:29184
    ds_read_b64_tr_b16 v[188:189], v225 offset:28736
    ds_read_b64_tr_b16 v[190:191], v225 offset:29248
    s_waitcnt lgkmcnt(8)
    v_mfma_f32_32x32x16_bf16 v[112:127], v[192:195], v[20:23], v[112:127]
    v_mfma_f32_32x32x16_bf16 v[128:143], v[196:199], v[20:23], v[128:143]
    v_mfma_f32_32x32x16_bf16 v[144:159], v[200:203], v[20:23], v[144:159]
    v_mfma_f32_32x32x16_bf16 v[160:175], v[204:207], v[20:23], v[160:175]
    ds_read_b64_tr_b16 v[192:193], v226 offset:22528
    ds_read_b64_tr_b16 v[194:195], v226 offset:23040
    ds_read_b64_tr_b16 v[196:197], v225 offset:22592
    ds_read_b64_tr_b16 v[198:199], v225 offset:23104
    ds_read_b64_tr_b16 v[200:201], v226 offset:30720
    ds_read_b64_tr_b16 v[202:203], v226 offset:31232
    ds_read_b64_tr_b16 v[204:205], v225 offset:30784
    ds_read_b64_tr_b16 v[206:207], v225 offset:31296
    s_waitcnt lgkmcnt(8)
    v_mfma_f32_32x32x16_bf16 v[112:127], v[176:179], v[24:27], v[112:127]
    v_mfma_f32_32x32x16_bf16 v[128:143], v[180:183], v[24:27], v[128:143]
    v_mfma_f32_32x32x16_bf16 v[144:159], v[184:187], v[24:27], v[144:159]
    v_mfma_f32_32x32x16_bf16 v[160:175], v[188:191], v[24:27], v[160:175]
    s_waitcnt vmcnt(4)
    s_barrier
    s_add_u32 s42, s40, 0xe0000
    s_add_u32 m0, s39, 0
    buffer_load_dwordx4 v227, s[12:15], s42 offen lds
    s_add_u32 s42, s40, 0xe0000
    s_add_u32 m0, s39, 4096
    buffer_load_dwordx4 v228, s[12:15], s42 offen lds
    s_add_u32 s42, s40, 0xe0000
    s_add_u32 m0, s39, 8192
    buffer_load_dwordx4 v229, s[16:19], s42 offen lds
    s_add_u32 s42, s40, 0xe0000
    s_add_u32 m0, s39, 12288
    buffer_load_dwordx4 v230, s[16:19], s42 offen lds
    ds_read_b64_tr_b16 v[176:177], v226 offset:32768
    ds_read_b64_tr_b16 v[178:179], v226 offset:33280
    ds_read_b64_tr_b16 v[180:181], v225 offset:32832
    ds_read_b64_tr_b16 v[182:183], v225 offset:33344
    ds_read_b64_tr_b16 v[184:185], v226 offset:40960
    ds_read_b64_tr_b16 v[186:187], v226 offset:41472
    ds_read_b64_tr_b16 v[188:189], v225 offset:41024
    ds_read_b64_tr_b16 v[190:191], v225 offset:41536
    s_waitcnt lgkmcnt(8)
    v_mfma_f32_32x32x16_bf16 v[112:127], v[192:195], v[28:31], v[112:127]
    v_mfma_f32_32x32x16_bf16 v[128:143], v[196:199], v[28:31], v[128:143]
    v_mfma_f32_32x32x16_bf16 v[144:159], v[200:203], v[28:31], v[144:159]
    v_mfma_f32_32x32x16_bf16 v[160:175], v[204:207], v[28:31], v[160:175]
    ds_read_b64_tr_b16 v[192:193], v226 offset:34816
    ds_read_b64_tr_b16 v[194:195], v226 offset:35328
    ds_read_b64_tr_b16 v[196:197], v225 offset:34880
    ds_read_b64_tr_b16 v[198:199], v225 offset:35392
    ds_read_b64_tr_b16 v[200:201], v226 offset:43008
    ds_read_b64_tr_b16 v[202:203], v226 offset:43520
    ds_read_b64_tr_b16 v[204:205], v225 offset:43072
    ds_read_b64_tr_b16 v[206:207], v225 offset:43584
    s_waitcnt lgkmcnt(8)
    v_mfma_f32_32x32x16_bf16 v[112:127], v[176:179], v[32:35], v[112:127]
    v_mfma_f32_32x32x16_bf16 v[128:143], v[180:183], v[32:35], v[128:143]
    v_mfma_f32_32x32x16_bf16 v[144:159], v[184:187], v[32:35], v[144:159]
    v_mfma_f32_32x32x16_bf16 v[160:175], v[188:191], v[32:35], v[160:175]
    ds_read_b64_tr_b16 v[176:177], v226 offset:36864
    ds_read_b64_tr_b16 v[178:179], v226 offset:37376
    ds_read_b64_tr_b16 v[180:181], v225 offset:36928
    ds_read_b64_tr_b16 v[182:183], v225 offset:37440
    ds_read_b64_tr_b16 v[184:185], v226 offset:45056
    ds_read_b64_tr_b16 v[186:187], v226 offset:45568
    ds_read_b64_tr_b16 v[188:189], v225 offset:45120
    ds_read_b64_tr_b16 v[190:191], v225 offset:45632
    s_waitcnt lgkmcnt(8)
    v_mfma_f32_32x32x16_bf16 v[112:127], v[192:195], v[36:39], v[112:127]
    v_mfma_f32_32x32x16_bf16 v[128:143], v[196:199], v[36:39], v[128:143]
    v_mfma_f32_32x32x16_bf16 v[144:159], v[200:203], v[36:39], v[144:159]
    v_mfma_f32_32x32x16_bf16 v[160:175], v[204:207], v[36:39], v[160:175]
    ds_read_b64_tr_b16 v[192:193], v226 offset:38912
    ds_read_b64_tr_b16 v[194:195], v226 offset:39424
    ds_read_b64_tr_b16 v[196:197], v225 offset:38976
    ds_read_b64_tr_b16 v[198:199], v225 offset:39488
    ds_read_b64_tr_b16 v[200:201], v226 offset:47104
    ds_read_b64_tr_b16 v[202:203], v226 offset:47616
    ds_read_b64_tr_b16 v[204:205], v225 offset:47168
    ds_read_b64_tr_b16 v[206:207], v225 offset:47680
    s_waitcnt lgkmcnt(8)
    v_mfma_f32_32x32x16_bf16 v[112:127], v[176:179], v[40:43], v[112:127]
    v_mfma_f32_32x32x16_bf16 v[128:143], v[180:183], v[40:43], v[128:143]
    v_mfma_f32_32x32x16_bf16 v[144:159], v[184:187], v[40:43], v[144:159]
    v_mfma_f32_32x32x16_bf16 v[160:175], v[188:191], v[40:43], v[160:175]
    s_waitcnt vmcnt(4)
    s_barrier
    s_add_u32 s42, s40, 0x118000
    s_add_u32 m0, s39, 16384
    buffer_load_dwordx4 v227, s[12:15], s42 offen lds
    s_add_u32 s42, s40, 0x118000
    s_add_u32 m0, s39, 20480
    buffer_load_dwordx4 v228, s[12:15], s42 offen lds
    s_add_u32 s42, s40, 0x118000
    s_add_u32 m0, s39, 24576
    buffer_load_dwordx4 v229, s[16:19], s42 offen lds
    s_add_u32 s42, s40, 0x118000
    s_add_u32 m0, s39, 28672
    buffer_load_dwordx4 v230, s[16:19], s42 offen lds
    ds_read_b64_tr_b16 v[176:177], v226 offset:49152
    ds_read_b64_tr_b16 v[178:179], v226 offset:49664
    ds_read_b64_tr_b16 v[180:181], v225 offset:49216
    ds_read_b64_tr_b16 v[182:183], v225 offset:49728
    ds_read_b64_tr_b16 v[184:185], v226 offset:57344
    ds_read_b64_tr_b16 v[186:187], v226 offset:57856
    ds_read_b64_tr_b16 v[188:189], v225 offset:57408
    ds_read_b64_tr_b16 v[190:191], v225 offset:57920
    s_waitcnt lgkmcnt(8)
    v_mfma_f32_32x32x16_bf16 v[112:127], v[192:195], v[44:47], v[112:127]
    v_mfma_f32_32x32x16_bf16 v[128:143], v[196:199], v[44:47], v[128:143]
    v_mfma_f32_32x32x16_bf16 v[144:159], v[200:203], v[44:47], v[144:159]
    v_mfma_f32_32x32x16_bf16 v[160:175], v[204:207], v[44:47], v[160:175]
    ds_read_b64_tr_b16 v[192:193], v226 offset:51200
    ds_read_b64_tr_b16 v[194:195], v226 offset:51712
    ds_read_b64_tr_b16 v[196:197], v225 offset:51264
    ds_read_b64_tr_b16 v[198:199], v225 offset:51776
    ds_read_b64_tr_b16 v[200:201], v226 offset:59392
    ds_read_b64_tr_b16 v[202:203], v226 offset:59904
    ds_read_b64_tr_b16 v[204:205], v225 offset:59456
    ds_read_b64_tr_b16 v[206:207], v225 offset:59968
    s_waitcnt lgkmcnt(8)
    v_mfma_f32_32x32x16_bf16 v[112:127], v[176:179], v[48:51], v[112:127]
    v_mfma_f32_32x32x16_bf16 v[128:143], v[180:183], v[48:51], v[128:143]
    v_mfma_f32_32x32x16_bf16 v[144:159], v[184:187], v[48:51], v[144:159]
    v_mfma_f32_32x32x16_bf16 v[160:175], v[188:191], v[48:51], v[160:175]
    ds_read_b64_tr_b16 v[176:177], v226 offset:53248
    ds_read_b64_tr_b16 v[178:179], v226 offset:53760
    ds_read_b64_tr_b16 v[180:181], v225 offset:53312
    ds_read_b64_tr_b16 v[182:183], v225 offset:53824
    ds_read_b64_tr_b16 v[184:185], v226 offset:61440
    ds_read_b64_tr_b16 v[186:187], v226 offset:61952
    ds_read_b64_tr_b16 v[188:189], v225 offset:61504
    ds_read_b64_tr_b16 v[190:191], v225 offset:62016
    s_waitcnt lgkmcnt(8)
    v_mfma_f32_32x32x16_bf16 v[112:127], v[192:195], v[52:55], v[112:127]
    v_mfma_f32_32x32x16_bf16 v[128:143], v[196:199], v[52:55], v[128:143]
    v_mfma_f32_32x32x16_bf16 v[144:159], v[200:203], v[52:55], v[144:159]
    v_mfma_f32_32x32x16_bf16 v[160:175], v[204:207], v[52:55], v[160:175]
    ds_read_b64_tr_b16 v[192:193], v226 offset:55296
    ds_read_b64_tr_b16 v[194:195], v226 offset:55808
    ds_read_b64_tr_b16 v[196:197], v225 offset:55360
    ds_read_b64_tr_b16 v[198:199], v225 offset:55872
    ds_read_b64_tr_b16 v[200:201], v226 offset:63488
    ds_read_b64_tr_b16 v[202:203], v226 offset:64000
    ds_read_b64_tr_b16 v[204:205], v225 offset:63552
    ds_read_b64_tr_b16 v[206:207], v225 offset:64064
    s_waitcnt lgkmcnt(8)
    v_mfma_f32_32x32x16_bf16 v[112:127], v[176:179], v[56:59], v[112:127]
    v_mfma_f32_32x32x16_bf16 v[128:143], v[180:183], v[56:59], v[128:143]
    v_mfma_f32_32x32x16_bf16 v[144:159], v[184:187], v[56:59], v[144:159]
    v_mfma_f32_32x32x16_bf16 v[160:175], v[188:191], v[56:59], v[160:175]
    s_waitcnt vmcnt(4)
    s_barrier
    s_add_u32 s42, s40, 0x150000
    s_add_u32 m0, s39, 32768
    buffer_load_dwordx4 v227, s[12:15], s42 offen lds
    s_add_u32 s42, s40, 0x150000
    s_add_u32 m0, s39, 36864
    buffer_load_dwordx4 v228, s[12:15], s42 offen lds
    s_add_u32 s42, s40, 0x150000
    s_add_u32 m0, s39, 40960
    buffer_load_dwordx4 v229, s[16:19], s42 offen lds
    s_add_u32 s42, s40, 0x150000
    s_add_u32 m0, s39, 45056
    buffer_load_dwordx4 v230, s[16:19], s42 offen lds
    ds_read_b64_tr_b16 v[176:177], v226 offset:0
    ds_read_b64_tr_b16 v[178:179], v226 offset:512
    ds_read_b64_tr_b16 v[180:181], v225 offset:64
    ds_read_b64_tr_b16 v[182:183], v225 offset:576
    ds_read_b64_tr_b16 v[184:185], v226 offset:8192
    ds_read_b64_tr_b16 v[186:187], v226 offset:8704
    ds_read_b64_tr_b16 v[188:189], v225 offset:8256
    ds_read_b64_tr_b16 v[190:191], v225 offset:8768
    s_waitcnt lgkmcnt(8)
    v_mfma_f32_32x32x16_bf16 v[112:127], v[192:195], v[60:63], v[112:127]
    v_mfma_f32_32x32x16_bf16 v[128:143], v[196:199], v[60:63], v[128:143]
    v_mfma_f32_32x32x16_bf16 v[144:159], v[200:203], v[60:63], v[144:159]
    v_mfma_f32_32x32x16_bf16 v[160:175], v[204:207], v[60:63], v[160:175]
    ds_read_b64_tr_b16 v[192:193], v226 offset:2048
    ds_read_b64_tr_b16 v[194:195], v226 offset:2560
    ds_read_b64_tr_b16 v[196:197], v225 offset:2112
    ds_read_b64_tr_b16 v[198:199], v225 offset:2624
    ds_read_b64_tr_b16 v[200:201], v226 offset:10240
    ds_read_b64_tr_b16 v[202:203], v226 offset:10752
    ds_read_b64_tr_b16 v[204:205], v225 offset:10304
    ds_read_b64_tr_b16 v[206:207], v225 offset:10816
    s_waitcnt lgkmcnt(8)
    v_mfma_f32_32x32x16_bf16 v[112:127], v[176:179], v[64:67], v[112:127]
    v_mfma_f32_32x32x16_bf16 v[128:143], v[180:183], v[64:67], v[128:143]
    v_mfma_f32_32x32x16_bf16 v[144:159], v[184:187], v[64:67], v[144:159]
    v_mfma_f32_32x32x16_bf16 v[160:175], v[188:191], v[64:67], v[160:175]
    ds_read_b64_tr_b16 v[176:177], v226 offset:4096
    ds_read_b64_tr_b16 v[178:179], v226 offset:4608
    ds_read_b64_tr_b16 v[180:181], v225 offset:4160
    ds_read_b64_tr_b16 v[182:183], v225 offset:4672
    ds_read_b64_tr_b16 v[184:185], v226 offset:12288
    ds_read_b64_tr_b16 v[186:187], v226 offset:12800
    ds_read_b64_tr_b16 v[188:189], v225 offset:12352
    ds_read_b64_tr_b16 v[190:191], v225 offset:12864
    s_waitcnt lgkmcnt(8)
    v_mfma_f32_32x32x16_bf16 v[112:127], v[192:195], v[68:71], v[112:127]
    v_mfma_f32_32x32x16_bf16 v[128:143], v[196:199], v[68:71], v[128:143]
    v_mfma_f32_32x32x16_bf16 v[144:159], v[200:203], v[68:71], v[144:159]
    v_mfma_f32_32x32x16_bf16 v[160:175], v[204:207], v[68:71], v[160:175]
    ds_read_b64_tr_b16 v[192:193], v226 offset:6144
    ds_read_b64_tr_b16 v[194:195], v226 offset:6656
    ds_read_b64_tr_b16 v[196:197], v225 offset:6208
    ds_read_b64_tr_b16 v[198:199], v225 offset:6720
    ds_read_b64_tr_b16 v[200:201], v226 offset:14336
    ds_read_b64_tr_b16 v[202:203], v226 offset:14848
    ds_read_b64_tr_b16 v[204:205], v225 offset:14400
    ds_read_b64_tr_b16 v[206:207], v225 offset:14912
    s_waitcnt lgkmcnt(8)
    v_mfma_f32_32x32x16_bf16 v[112:127], v[176:179], v[72:75], v[112:127]
    v_mfma_f32_32x32x16_bf16 v[128:143], v[180:183], v[72:75], v[128:143]
    v_mfma_f32_32x32x16_bf16 v[144:159], v[184:187], v[72:75], v[144:159]
    v_mfma_f32_32x32x16_bf16 v[160:175], v[188:191], v[72:75], v[160:175]
    s_waitcnt vmcnt(4)
    s_barrier
    s_add_u32 s42, s40, 0x80
    s_add_u32 m0, s39, 49152
    buffer_load_dwordx4 v227, s[12:15], s42 offen lds
    s_add_u32 s42, s40, 0x80
    s_add_u32 m0, s39, 53248
    buffer_load_dwordx4 v228, s[12:15], s42 offen lds
    s_add_u32 s42, s40, 0x80
    s_add_u32 m0, s39, 57344
    buffer_load_dwordx4 v229, s[16:19], s42 offen lds
    s_add_u32 s42, s40, 0x80
    s_add_u32 m0, s39, 61440
    buffer_load_dwordx4 v230, s[16:19], s42 offen lds
    ds_read_b64_tr_b16 v[176:177], v226 offset:16384
    ds_read_b64_tr_b16 v[178:179], v226 offset:16896
    ds_read_b64_tr_b16 v[180:181], v225 offset:16448
    ds_read_b64_tr_b16 v[182:183], v225 offset:16960
    ds_read_b64_tr_b16 v[184:185], v226 offset:24576
    ds_read_b64_tr_b16 v[186:187], v226 offset:25088
    ds_read_b64_tr_b16 v[188:189], v225 offset:24640
    ds_read_b64_tr_b16 v[190:191], v225 offset:25152
    s_waitcnt lgkmcnt(8)
    v_mfma_f32_32x32x16_bf16 v[112:127], v[192:195], v[76:79], v[112:127]
    v_mfma_f32_32x32x16_bf16 v[128:143], v[196:199], v[76:79], v[128:143]
    v_mfma_f32_32x32x16_bf16 v[144:159], v[200:203], v[76:79], v[144:159]
    v_mfma_f32_32x32x16_bf16 v[160:175], v[204:207], v[76:79], v[160:175]
    ds_read_b64_tr_b16 v[192:193], v226 offset:18432
    ds_read_b64_tr_b16 v[194:195], v226 offset:18944
    ds_read_b64_tr_b16 v[196:197], v225 offset:18496
    ds_read_b64_tr_b16 v[198:199], v225 offset:19008
    ds_read_b64_tr_b16 v[200:201], v226 offset:26624
    ds_read_b64_tr_b16 v[202:203], v226 offset:27136
    ds_read_b64_tr_b16 v[204:205], v225 offset:26688
    ds_read_b64_tr_b16 v[206:207], v225 offset:27200
    s_waitcnt lgkmcnt(8)
    v_mfma_f32_32x32x16_bf16 v[112:127], v[176:179], v[80:83], v[112:127]
    v_mfma_f32_32x32x16_bf16 v[128:143], v[180:183], v[80:83], v[128:143]
    v_mfma_f32_32x32x16_bf16 v[144:159], v[184:187], v[80:83], v[144:159]
    v_mfma_f32_32x32x16_bf16 v[160:175], v[188:191], v[80:83], v[160:175]
    ds_read_b64_tr_b16 v[176:177], v226 offset:20480
    ds_read_b64_tr_b16 v[178:179], v226 offset:20992
    ds_read_b64_tr_b16 v[180:181], v225 offset:20544
    ds_read_b64_tr_b16 v[182:183], v225 offset:21056
    ds_read_b64_tr_b16 v[184:185], v226 offset:28672
    ds_read_b64_tr_b16 v[186:187], v226 offset:29184
    ds_read_b64_tr_b16 v[188:189], v225 offset:28736
    ds_read_b64_tr_b16 v[190:191], v225 offset:29248
    s_waitcnt lgkmcnt(8)
    v_mfma_f32_32x32x16_bf16 v[112:127], v[192:195], v[84:87], v[112:127]
    v_mfma_f32_32x32x16_bf16 v[128:143], v[196:199], v[84:87], v[128:143]
    v_mfma_f32_32x32x16_bf16 v[144:159], v[200:203], v[84:87], v[144:159]
    v_mfma_f32_32x32x16_bf16 v[160:175], v[204:207], v[84:87], v[160:175]
    ds_read_b64_tr_b16 v[192:193], v226 offset:22528
    ds_read_b64_tr_b16 v[194:195], v226 offset:23040
    ds_read_b64_tr_b16 v[196:197], v225 offset:22592
    ds_read_b64_tr_b16 v[198:199], v225 offset:23104
    ds_read_b64_tr_b16 v[200:201], v226 offset:30720
    ds_read_b64_tr_b16 v[202:203], v226 offset:31232
    ds_read_b64_tr_b16 v[204:205], v225 offset:30784
    ds_read_b64_tr_b16 v[206:207], v225 offset:31296
    s_waitcnt lgkmcnt(8)
    v_mfma_f32_32x32x16_bf16 v[112:127], v[176:179], v[88:91], v[112:127]
    v_mfma_f32_32x32x16_bf16 v[128:143], v[180:183], v[88:91], v[128:143]
    v_mfma_f32_32x32x16_bf16 v[144:159], v[184:187], v[88:91], v[144:159]
    v_mfma_f32_32x32x16_bf16 v[160:175], v[188:191], v[88:91], v[160:175]
    s_waitcnt vmcnt(4)
    s_barrier
    s_add_u32 s42, s40, 0x38080
    s_add_u32 m0, s39, 0
    buffer_load_dwordx4 v227, s[12:15], s42 offen lds
    s_add_u32 s42, s40, 0x38080
    s_add_u32 m0, s39, 4096
    buffer_load_dwordx4 v228, s[12:15], s42 offen lds
    s_add_u32 s42, s40, 0x38080
    s_add_u32 m0, s39, 8192
    buffer_load_dwordx4 v229, s[16:19], s42 offen lds
    s_add_u32 s42, s40, 0x38080
    s_add_u32 m0, s39, 12288
    buffer_load_dwordx4 v230, s[16:19], s42 offen lds
    ds_read_b64_tr_b16 v[176:177], v226 offset:32768
    ds_read_b64_tr_b16 v[178:179], v226 offset:33280
    ds_read_b64_tr_b16 v[180:181], v225 offset:32832
    ds_read_b64_tr_b16 v[182:183], v225 offset:33344
    ds_read_b64_tr_b16 v[184:185], v226 offset:40960
    ds_read_b64_tr_b16 v[186:187], v226 offset:41472
    ds_read_b64_tr_b16 v[188:189], v225 offset:41024
    ds_read_b64_tr_b16 v[190:191], v225 offset:41536
    s_waitcnt lgkmcnt(8)
    v_mfma_f32_32x32x16_bf16 v[112:127], v[192:195], v[92:95], v[112:127]
    v_mfma_f32_32x32x16_bf16 v[128:143], v[196:199], v[92:95], v[128:143]
    v_mfma_f32_32x32x16_bf16 v[144:159], v[200:203], v[92:95], v[144:159]
    v_mfma_f32_32x32x16_bf16 v[160:175], v[204:207], v[92:95], v[160:175]
    ds_read_b64_tr_b16 v[192:193], v226 offset:34816
    ds_read_b64_tr_b16 v[194:195], v226 offset:35328
    ds_read_b64_tr_b16 v[196:197], v225 offset:34880
    ds_read_b64_tr_b16 v[198:199], v225 offset:35392
    ds_read_b64_tr_b16 v[200:201], v226 offset:43008
    ds_read_b64_tr_b16 v[202:203], v226 offset:43520
    ds_read_b64_tr_b16 v[204:205], v225 offset:43072
    ds_read_b64_tr_b16 v[206:207], v225 offset:43584
    s_waitcnt lgkmcnt(8)
    v_mfma_f32_32x32x16_bf16 v[112:127], v[176:179], v[96:99], v[112:127]
    v_mfma_f32_32x32x16_bf16 v[128:143], v[180:183], v[96:99], v[128:143]
    v_mfma_f32_32x32x16_bf16 v[144:159], v[184:187], v[96:99], v[144:159]
    v_mfma_f32_32x32x16_bf16 v[160:175], v[188:191], v[96:99], v[160:175]
    ds_read_b64_tr_b16 v[176:177], v226 offset:36864
    ds_read_b64_tr_b16 v[178:179], v226 offset:37376
    ds_read_b64_tr_b16 v[180:181], v225 offset:36928
    ds_read_b64_tr_b16 v[182:183], v225 offset:37440
    ds_read_b64_tr_b16 v[184:185], v226 offset:45056
    ds_read_b64_tr_b16 v[186:187], v226 offset:45568
    ds_read_b64_tr_b16 v[188:189], v225 offset:45120
    ds_read_b64_tr_b16 v[190:191], v225 offset:45632
    s_waitcnt lgkmcnt(8)
    v_mfma_f32_32x32x16_bf16 v[112:127], v[192:195], v[100:103], v[112:127]
    v_mfma_f32_32x32x16_bf16 v[128:143], v[196:199], v[100:103], v[128:143]
    v_mfma_f32_32x32x16_bf16 v[144:159], v[200:203], v[100:103], v[144:159]
    v_mfma_f32_32x32x16_bf16 v[160:175], v[204:207], v[100:103], v[160:175]
    ds_read_b64_tr_b16 v[192:193], v226 offset:38912
    ds_read_b64_tr_b16 v[194:195], v226 offset:39424
    ds_read_b64_tr_b16 v[196:197], v225 offset:38976
    ds_read_b64_tr_b16 v[198:199], v225 offset:39488
    ds_read_b64_tr_b16 v[200:201], v226 offset:47104
    ds_read_b64_tr_b16 v[202:203], v226 offset:47616
    ds_read_b64_tr_b16 v[204:205], v225 offset:47168
    ds_read_b64_tr_b16 v[206:207], v225 offset:47680
    s_waitcnt lgkmcnt(8)
    v_mfma_f32_32x32x16_bf16 v[112:127], v[176:179], v[104:107], v[112:127]
    v_mfma_f32_32x32x16_bf16 v[128:143], v[180:183], v[104:107], v[128:143]
    v_mfma_f32_32x32x16_bf16 v[144:159], v[184:187], v[104:107], v[144:159]
    v_mfma_f32_32x32x16_bf16 v[160:175], v[188:191], v[104:107], v[160:175]
    s_waitcnt vmcnt(4)
    s_barrier
    s_add_u32 s42, s40, 0x70080
    s_add_u32 m0, s39, 16384
    buffer_load_dwordx4 v227, s[12:15], s42 offen lds
    s_add_u32 s42, s40, 0x70080
    s_add_u32 m0, s39, 20480
    buffer_load_dwordx4 v228, s[12:15], s42 offen lds
    s_add_u32 s42, s40, 0x70080
    s_add_u32 m0, s39, 24576
    buffer_load_dwordx4 v229, s[16:19], s42 offen lds
    s_add_u32 s42, s40, 0x70080
    s_add_u32 m0, s39, 28672
    buffer_load_dwordx4 v230, s[16:19], s42 offen lds
    ds_read_b64_tr_b16 v[176:177], v226 offset:49152
    ds_read_b64_tr_b16 v[178:179], v226 offset:49664
    ds_read_b64_tr_b16 v[180:181], v225 offset:49216
    ds_read_b64_tr_b16 v[182:183], v225 offset:49728
    ds_read_b64_tr_b16 v[184:185], v226 offset:57344
    ds_read_b64_tr_b16 v[186:187], v226 offset:57856
    ds_read_b64_tr_b16 v[188:189], v225 offset:57408
    ds_read_b64_tr_b16 v[190:191], v225 offset:57920
    s_waitcnt lgkmcnt(8)
    v_mfma_f32_32x32x16_bf16 v[112:127], v[192:195], v[108:111], v[112:127]
    v_mfma_f32_32x32x16_bf16 v[128:143], v[196:199], v[108:111], v[128:143]
    v_mfma_f32_32x32x16_bf16 v[144:159], v[200:203], v[108:111], v[144:159]
    v_mfma_f32_32x32x16_bf16 v[160:175], v[204:207], v[108:111], v[160:175]
    s_nop 15
    s_nop 3
    s_mul_i32 s41, s48, 112
    s_lshr_b32 s49, s43, 4
    s_add_u32 s41, s41, s49
    s_lshl_b32 s41, s41, 10
    v_lshlrev_b32 v216, 4, v224
    v_add_u32 v216, s41, v216
    v_mul_f32 v236, v112, v232
    v_mul_f32 v240, v144, v232
    v_mul_f32 v237, v113, v232
    v_mul_f32 v241, v145, v232
    v_mul_f32 v238, v114, v232
    v_mul_f32 v242, v146, v232
    v_mul_f32 v239, v115, v232
    v_mul_f32 v243, v147, v232
    v_cvt_pk_bf16_f32 v244, v236, v237
    v_cvt_pk_bf16_f32 v245, v238, v239
    v_lshlrev_b32 v236, 16, v244
    v_and_b32 v237, 0xffff0000, v244
    v_lshlrev_b32 v238, 16, v245
    v_and_b32 v239, 0xffff0000, v245
    v_cvt_pk_bf16_f32 v244, v240, v241
    v_cvt_pk_bf16_f32 v245, v242, v243
    v_lshlrev_b32 v240, 16, v244
    v_and_b32 v241, 0xffff0000, v244
    v_lshlrev_b32 v242, 16, v245
    v_and_b32 v243, 0xffff0000, v245
    v_mul_f32 v236, 0xbfb8aa3b, v236
    v_mul_f32 v237, 0xbfb8aa3b, v237
    v_mul_f32 v238, 0xbfb8aa3b, v238
    v_mul_f32 v239, 0xbfb8aa3b, v239
    v_exp_f32 v236, v236
    v_exp_f32 v237, v237
    v_exp_f32 v238, v238
    v_exp_f32 v239, v239
    s_nop 0
    v_add_f32 v236, 1.0, v236
    v_add_f32 v237, 1.0, v237
    v_add_f32 v238, 1.0, v238
    v_add_f32 v239, 1.0, v239
    v_rcp_f32 v236, v236
    v_rcp_f32 v237, v237
    v_rcp_f32 v238, v238
    v_rcp_f32 v239, v239
    s_nop 0
    v_cvt_pk_bf16_f32 v244, v236, v237
    v_cvt_pk_bf16_f32 v245, v238, v239
    v_lshlrev_b32 v236, 16, v244
    v_and_b32 v237, 0xffff0000, v244
    v_lshlrev_b32 v238, 16, v245
    v_and_b32 v239, 0xffff0000, v245
    v_mul_f32 v236, v236, v240
    v_mul_f32 v237, v237, v241
    v_mul_f32 v238, v238, v242
    v_mul_f32 v239, v239, v243
    v_cvt_pk_bf16_f32 v208, v236, v237
    v_cvt_pk_bf16_f32 v209, v238, v239
    v_mul_f32 v236, v116, v232
    v_mul_f32 v240, v148, v232
    v_mul_f32 v237, v117, v232
    v_mul_f32 v241, v149, v232
    v_mul_f32 v238, v118, v232
    v_mul_f32 v242, v150, v232
    v_mul_f32 v239, v119, v232
    v_mul_f32 v243, v151, v232
    v_cvt_pk_bf16_f32 v244, v236, v237
    v_cvt_pk_bf16_f32 v245, v238, v239
    v_lshlrev_b32 v236, 16, v244
    v_and_b32 v237, 0xffff0000, v244
    v_lshlrev_b32 v238, 16, v245
    v_and_b32 v239, 0xffff0000, v245
    v_cvt_pk_bf16_f32 v244, v240, v241
    v_cvt_pk_bf16_f32 v245, v242, v243
    v_lshlrev_b32 v240, 16, v244
    v_and_b32 v241, 0xffff0000, v244
    v_lshlrev_b32 v242, 16, v245
    v_and_b32 v243, 0xffff0000, v245
    v_mul_f32 v236, 0xbfb8aa3b, v236
    v_mul_f32 v237, 0xbfb8aa3b, v237
    v_mul_f32 v238, 0xbfb8aa3b, v238
    v_mul_f32 v239, 0xbfb8aa3b, v239
    v_exp_f32 v236, v236
    v_exp_f32 v237, v237
    v_exp_f32 v238, v238
    v_exp_f32 v239, v239
    s_nop 0
    v_add_f32 v236, 1.0, v236
    v_add_f32 v237, 1.0, v237
    v_add_f32 v238, 1.0, v238
    v_add_f32 v239, 1.0, v239
    v_rcp_f32 v236, v236
    v_rcp_f32 v237, v237
    v_rcp_f32 v238, v238
    v_rcp_f32 v239, v239
    s_nop 0
    v_cvt_pk_bf16_f32 v244, v236, v237
    v_cvt_pk_bf16_f32 v245, v238, v239
    v_lshlrev_b32 v236, 16, v244
    v_and_b32 v237, 0xffff0000, v244
    v_lshlrev_b32 v238, 16, v245
    v_and_b32 v239, 0xffff0000, v245
    v_mul_f32 v236, v236, v240
    v_mul_f32 v237, v237, v241
    v_mul_f32 v238, v238, v242
    v_mul_f32 v239, v239, v243
    v_cvt_pk_bf16_f32 v210, v236, v237
    v_cvt_pk_bf16_f32 v211, v238, v239
    v_mul_f32 v236, v120, v232
    v_mul_f32 v240, v152, v232
    v_mul_f32 v237, v121, v232
    v_mul_f32 v241, v153, v232
    v_mul_f32 v238, v122, v232
    v_mul_f32 v242, v154, v232
    v_mul_f32 v239, v123, v232
    v_mul_f32 v243, v155, v232
    v_cvt_pk_bf16_f32 v244, v236, v237
    v_cvt_pk_bf16_f32 v245, v238, v239
    v_lshlrev_b32 v236, 16, v244
    v_and_b32 v237, 0xffff0000, v244
    v_lshlrev_b32 v238, 16, v245
    v_and_b32 v239, 0xffff0000, v245
    v_cvt_pk_bf16_f32 v244, v240, v241
    v_cvt_pk_bf16_f32 v245, v242, v243
    v_lshlrev_b32 v240, 16, v244
    v_and_b32 v241, 0xffff0000, v244
    v_lshlrev_b32 v242, 16, v245
    v_and_b32 v243, 0xffff0000, v245
    v_mul_f32 v236, 0xbfb8aa3b, v236
    v_mul_f32 v237, 0xbfb8aa3b, v237
    v_mul_f32 v238, 0xbfb8aa3b, v238
    v_mul_f32 v239, 0xbfb8aa3b, v239
    v_exp_f32 v236, v236
    v_exp_f32 v237, v237
    v_exp_f32 v238, v238
    v_exp_f32 v239, v239
    s_nop 0
    v_add_f32 v236, 1.0, v236
    v_add_f32 v237, 1.0, v237
    v_add_f32 v238, 1.0, v238
    v_add_f32 v239, 1.0, v239
    v_rcp_f32 v236, v236
    v_rcp_f32 v237, v237
    v_rcp_f32 v238, v238
    v_rcp_f32 v239, v239
    s_nop 0
    v_cvt_pk_bf16_f32 v244, v236, v237
    v_cvt_pk_bf16_f32 v245, v238, v239
    v_lshlrev_b32 v236, 16, v244
    v_and_b32 v237, 0xffff0000, v244
    v_lshlrev_b32 v238, 16, v245
    v_and_b32 v239, 0xffff0000, v245
    v_mul_f32 v236, v236, v240
    v_mul_f32 v237, v237, v241
    v_mul_f32 v238, v238, v242
    v_mul_f32 v239, v239, v243
    v_cvt_pk_bf16_f32 v212, v236, v237
    v_cvt_pk_bf16_f32 v213, v238, v239
    v_mul_f32 v236, v124, v232
    v_mul_f32 v240, v156, v232
    v_mul_f32 v237, v125, v232
    v_mul_f32 v241, v157, v232
    v_mul_f32 v238, v126, v232
    v_mul_f32 v242, v158, v232
    v_mul_f32 v239, v127, v232
    v_mul_f32 v243, v159, v232
    v_cvt_pk_bf16_f32 v244, v236, v237
    v_cvt_pk_bf16_f32 v245, v238, v239
    v_lshlrev_b32 v236, 16, v244
    v_and_b32 v237, 0xffff0000, v244
    v_lshlrev_b32 v238, 16, v245
    v_and_b32 v239, 0xffff0000, v245
    v_cvt_pk_bf16_f32 v244, v240, v241
    v_cvt_pk_bf16_f32 v245, v242, v243
    v_lshlrev_b32 v240, 16, v244
    v_and_b32 v241, 0xffff0000, v244
    v_lshlrev_b32 v242, 16, v245
    v_and_b32 v243, 0xffff0000, v245
    v_mul_f32 v236, 0xbfb8aa3b, v236
    v_mul_f32 v237, 0xbfb8aa3b, v237
    v_mul_f32 v238, 0xbfb8aa3b, v238
    v_mul_f32 v239, 0xbfb8aa3b, v239
    v_exp_f32 v236, v236
    v_exp_f32 v237, v237
    v_exp_f32 v238, v238
    v_exp_f32 v239, v239
    s_nop 0
    v_add_f32 v236, 1.0, v236
    v_add_f32 v237, 1.0, v237
    v_add_f32 v238, 1.0, v238
    v_add_f32 v239, 1.0, v239
    v_rcp_f32 v236, v236
    v_rcp_f32 v237, v237
    v_rcp_f32 v238, v238
    v_rcp_f32 v239, v239
    s_nop 0
    v_cvt_pk_bf16_f32 v244, v236, v237
    v_cvt_pk_bf16_f32 v245, v238, v239
    v_lshlrev_b32 v236, 16, v244
    v_and_b32 v237, 0xffff0000, v244
    v_lshlrev_b32 v238, 16, v245
    v_and_b32 v239, 0xffff0000, v245
    v_mul_f32 v236, v236, v240
    v_mul_f32 v237, v237, v241
    v_mul_f32 v238, v238, v242
    v_mul_f32 v239, v239, v243
    v_cvt_pk_bf16_f32 v214, v236, v237
    v_cvt_pk_bf16_f32 v215, v238, v239
    s_nop 1
    v_permlane32_swap_b32 v208, v210
    v_permlane32_swap_b32 v209, v211
    v_permlane32_swap_b32 v212, v214
    v_permlane32_swap_b32 v213, v215
    s_nop 1
    buffer_store_dwordx4 v[208:211], v216, s[20:23], 0 offen offset:0
    buffer_store_dwordx4 v[212:215], v216, s[20:23], 0 offen offset:1024
    s_nop 1
    v_mul_f32 v236, v128, v232
    v_mul_f32 v240, v160, v232
    v_mul_f32 v237, v129, v232
    v_mul_f32 v241, v161, v232
    v_mul_f32 v238, v130, v232
    v_mul_f32 v242, v162, v232
    v_mul_f32 v239, v131, v232
    v_mul_f32 v243, v163, v232
    v_cvt_pk_bf16_f32 v244, v236, v237
    v_cvt_pk_bf16_f32 v245, v238, v239
    v_lshlrev_b32 v236, 16, v244
    v_and_b32 v237, 0xffff0000, v244
    v_lshlrev_b32 v238, 16, v245
    v_and_b32 v239, 0xffff0000, v245
    v_cvt_pk_bf16_f32 v244, v240, v241
    v_cvt_pk_bf16_f32 v245, v242, v243
    v_lshlrev_b32 v240, 16, v244
    v_and_b32 v241, 0xffff0000, v244
    v_lshlrev_b32 v242, 16, v245
    v_and_b32 v243, 0xffff0000, v245
    v_mul_f32 v236, 0xbfb8aa3b, v236
    v_mul_f32 v237, 0xbfb8aa3b, v237
    v_mul_f32 v238, 0xbfb8aa3b, v238
    v_mul_f32 v239, 0xbfb8aa3b, v239
    v_exp_f32 v236, v236
    v_exp_f32 v237, v237
    v_exp_f32 v238, v238
    v_exp_f32 v239, v239
    s_nop 0
    v_add_f32 v236, 1.0, v236
    v_add_f32 v237, 1.0, v237
    v_add_f32 v238, 1.0, v238
    v_add_f32 v239, 1.0, v239
    v_rcp_f32 v236, v236
    v_rcp_f32 v237, v237
    v_rcp_f32 v238, v238
    v_rcp_f32 v239, v239
    s_nop 0
    v_cvt_pk_bf16_f32 v244, v236, v237
    v_cvt_pk_bf16_f32 v245, v238, v239
    v_lshlrev_b32 v236, 16, v244
    v_and_b32 v237, 0xffff0000, v244
    v_lshlrev_b32 v238, 16, v245
    v_and_b32 v239, 0xffff0000, v245
    v_mul_f32 v236, v236, v240
    v_mul_f32 v237, v237, v241
    v_mul_f32 v238, v238, v242
    v_mul_f32 v239, v239, v243
    v_cvt_pk_bf16_f32 v208, v236, v237
    v_cvt_pk_bf16_f32 v209, v238, v239
    v_mul_f32 v236, v132, v232
    v_mul_f32 v240, v164, v232
    v_mul_f32 v237, v133, v232
    v_mul_f32 v241, v165, v232
    v_mul_f32 v238, v134, v232
    v_mul_f32 v242, v166, v232
    v_mul_f32 v239, v135, v232
    v_mul_f32 v243, v167, v232
    v_cvt_pk_bf16_f32 v244, v236, v237
    v_cvt_pk_bf16_f32 v245, v238, v239
    v_lshlrev_b32 v236, 16, v244
    v_and_b32 v237, 0xffff0000, v244
    v_lshlrev_b32 v238, 16, v245
    v_and_b32 v239, 0xffff0000, v245
    v_cvt_pk_bf16_f32 v244, v240, v241
    v_cvt_pk_bf16_f32 v245, v242, v243
    v_lshlrev_b32 v240, 16, v244
    v_and_b32 v241, 0xffff0000, v244
    v_lshlrev_b32 v242, 16, v245
    v_and_b32 v243, 0xffff0000, v245
    v_mul_f32 v236, 0xbfb8aa3b, v236
    v_mul_f32 v237, 0xbfb8aa3b, v237
    v_mul_f32 v238, 0xbfb8aa3b, v238
    v_mul_f32 v239, 0xbfb8aa3b, v239
    v_exp_f32 v236, v236
    v_exp_f32 v237, v237
    v_exp_f32 v238, v238
    v_exp_f32 v239, v239
    s_nop 0
    v_add_f32 v236, 1.0, v236
    v_add_f32 v237, 1.0, v237
    v_add_f32 v238, 1.0, v238
    v_add_f32 v239, 1.0, v239
    v_rcp_f32 v236, v236
    v_rcp_f32 v237, v237
    v_rcp_f32 v238, v238
    v_rcp_f32 v239, v239
    s_nop 0
    v_cvt_pk_bf16_f32 v244, v236, v237
    v_cvt_pk_bf16_f32 v245, v238, v239
    v_lshlrev_b32 v236, 16, v244
    v_and_b32 v237, 0xffff0000, v244
    v_lshlrev_b32 v238, 16, v245
    v_and_b32 v239, 0xffff0000, v245
    v_mul_f32 v236, v236, v240
    v_mul_f32 v237, v237, v241
    v_mul_f32 v238, v238, v242
    v_mul_f32 v239, v239, v243
    v_cvt_pk_bf16_f32 v210, v236, v237
    v_cvt_pk_bf16_f32 v211, v238, v239
    v_mul_f32 v236, v136, v232
    v_mul_f32 v240, v168, v232
    v_mul_f32 v237, v137, v232
    v_mul_f32 v241, v169, v232
    v_mul_f32 v238, v138, v232
    v_mul_f32 v242, v170, v232
    v_mul_f32 v239, v139, v232
    v_mul_f32 v243, v171, v232
    v_cvt_pk_bf16_f32 v244, v236, v237
    v_cvt_pk_bf16_f32 v245, v238, v239
    v_lshlrev_b32 v236, 16, v244
    v_and_b32 v237, 0xffff0000, v244
    v_lshlrev_b32 v238, 16, v245
    v_and_b32 v239, 0xffff0000, v245
    v_cvt_pk_bf16_f32 v244, v240, v241
    v_cvt_pk_bf16_f32 v245, v242, v243
    v_lshlrev_b32 v240, 16, v244
    v_and_b32 v241, 0xffff0000, v244
    v_lshlrev_b32 v242, 16, v245
    v_and_b32 v243, 0xffff0000, v245
    v_mul_f32 v236, 0xbfb8aa3b, v236
    v_mul_f32 v237, 0xbfb8aa3b, v237
    v_mul_f32 v238, 0xbfb8aa3b, v238
    v_mul_f32 v239, 0xbfb8aa3b, v239
    v_exp_f32 v236, v236
    v_exp_f32 v237, v237
    v_exp_f32 v238, v238
    v_exp_f32 v239, v239
    s_nop 0
    v_add_f32 v236, 1.0, v236
    v_add_f32 v237, 1.0, v237
    v_add_f32 v238, 1.0, v238
    v_add_f32 v239, 1.0, v239
    v_rcp_f32 v236, v236
    v_rcp_f32 v237, v237
    v_rcp_f32 v238, v238
    v_rcp_f32 v239, v239
    s_nop 0
    v_cvt_pk_bf16_f32 v244, v236, v237
    v_cvt_pk_bf16_f32 v245, v238, v239
    v_lshlrev_b32 v236, 16, v244
    v_and_b32 v237, 0xffff0000, v244
    v_lshlrev_b32 v238, 16, v245
    v_and_b32 v239, 0xffff0000, v245
    v_mul_f32 v236, v236, v240
    v_mul_f32 v237, v237, v241
    v_mul_f32 v238, v238, v242
    v_mul_f32 v239, v239, v243
    v_cvt_pk_bf16_f32 v212, v236, v237
    v_cvt_pk_bf16_f32 v213, v238, v239
    v_mul_f32 v236, v140, v232
    v_mul_f32 v240, v172, v232
    v_mul_f32 v237, v141, v232
    v_mul_f32 v241, v173, v232
    v_mul_f32 v238, v142, v232
    v_mul_f32 v242, v174, v232
    v_mul_f32 v239, v143, v232
    v_mul_f32 v243, v175, v232
    v_cvt_pk_bf16_f32 v244, v236, v237
    v_cvt_pk_bf16_f32 v245, v238, v239
    v_lshlrev_b32 v236, 16, v244
    v_and_b32 v237, 0xffff0000, v244
    v_lshlrev_b32 v238, 16, v245
    v_and_b32 v239, 0xffff0000, v245
    v_cvt_pk_bf16_f32 v244, v240, v241
    v_cvt_pk_bf16_f32 v245, v242, v243
    v_lshlrev_b32 v240, 16, v244
    v_and_b32 v241, 0xffff0000, v244
    v_lshlrev_b32 v242, 16, v245
    v_and_b32 v243, 0xffff0000, v245
    v_mul_f32 v236, 0xbfb8aa3b, v236
    v_mul_f32 v237, 0xbfb8aa3b, v237
    v_mul_f32 v238, 0xbfb8aa3b, v238
    v_mul_f32 v239, 0xbfb8aa3b, v239
    v_exp_f32 v236, v236
    v_exp_f32 v237, v237
    v_exp_f32 v238, v238
    v_exp_f32 v239, v239
    s_nop 0
    v_add_f32 v236, 1.0, v236
    v_add_f32 v237, 1.0, v237
    v_add_f32 v238, 1.0, v238
    v_add_f32 v239, 1.0, v239
    v_rcp_f32 v236, v236
    v_rcp_f32 v237, v237
    v_rcp_f32 v238, v238
    v_rcp_f32 v239, v239
    s_nop 0
    v_cvt_pk_bf16_f32 v244, v236, v237
    v_cvt_pk_bf16_f32 v245, v238, v239
    v_lshlrev_b32 v236, 16, v244
    v_and_b32 v237, 0xffff0000, v244
    v_lshlrev_b32 v238, 16, v245
    v_and_b32 v239, 0xffff0000, v245
    v_mul_f32 v236, v236, v240
    v_mul_f32 v237, v237, v241
    v_mul_f32 v238, v238, v242
    v_mul_f32 v239, v239, v243
    v_cvt_pk_bf16_f32 v214, v236, v237
    v_cvt_pk_bf16_f32 v215, v238, v239
    s_nop 1
    v_permlane32_swap_b32 v208, v210
    v_permlane32_swap_b32 v209, v211
    v_permlane32_swap_b32 v212, v214
    v_permlane32_swap_b32 v213, v215
    s_nop 1
    buffer_store_dwordx4 v[208:211], v216, s[20:23], 0 offen offset:2048
    buffer_store_dwordx4 v[212:215], v216, s[20:23], 0 offen offset:3072
    s_nop 1
    ds_read_b64_tr_b16 v[192:193], v226 offset:51200
    ds_read_b64_tr_b16 v[194:195], v226 offset:51712
    ds_read_b64_tr_b16 v[196:197], v225 offset:51264
    ds_read_b64_tr_b16 v[198:199], v225 offset:51776
    ds_read_b64_tr_b16 v[200:201], v226 offset:59392
    ds_read_b64_tr_b16 v[202:203], v226 offset:59904
    ds_read_b64_tr_b16 v[204:205], v225 offset:59456
    ds_read_b64_tr_b16 v[206:207], v225 offset:59968
    s_waitcnt lgkmcnt(8)
    v_mfma_f32_32x32x16_bf16 v[112:127], v[176:179], v[0:3], 0
    v_mfma_f32_32x32x16_bf16 v[128:143], v[180:183], v[0:3], 0
    v_mfma_f32_32x32x16_bf16 v[144:159], v[184:187], v[0:3], 0
    v_mfma_f32_32x32x16_bf16 v[160:175], v[188:191], v[0:3], 0
    ds_read_b64_tr_b16 v[176:177], v226 offset:53248
    ds_read_b64_tr_b16 v[178:179], v226 offset:53760
    ds_read_b64_tr_b16 v[180:181], v225 offset:53312
    ds_read_b64_tr_b16 v[182:183], v225 offset:53824
    ds_read_b64_tr_b16 v[184:185], v226 offset:61440
    ds_read_b64_tr_b16 v[186:187], v226 offset:61952
    ds_read_b64_tr_b16 v[188:189], v225 offset:61504
    ds_read_b64_tr_b16 v[190:191], v225 offset:62016
    s_waitcnt lgkmcnt(8)
    v_mfma_f32_32x32x16_bf16 v[112:127], v[192:195], v[4:7], v[112:127]
    v_mfma_f32_32x32x16_bf16 v[128:143], v[196:199], v[4:7], v[128:143]
    v_mfma_f32_32x32x16_bf16 v[144:159], v[200:203], v[4:7], v[144:159]
    v_mfma_f32_32x32x16_bf16 v[160:175], v[204:207], v[4:7], v[160:175]
    ds_read_b64_tr_b16 v[192:193], v226 offset:55296
    ds_read_b64_tr_b16 v[194:195], v226 offset:55808
    ds_read_b64_tr_b16 v[196:197], v225 offset:55360
    ds_read_b64_tr_b16 v[198:199], v225 offset:55872
    ds_read_b64_tr_b16 v[200:201], v226 offset:63488
    ds_read_b64_tr_b16 v[202:203], v226 offset:64000
    ds_read_b64_tr_b16 v[204:205], v225 offset:63552
    ds_read_b64_tr_b16 v[206:207], v225 offset:64064
    s_waitcnt lgkmcnt(8)
    v_mfma_f32_32x32x16_bf16 v[112:127], v[176:179], v[8:11], v[112:127]
    v_mfma_f32_32x32x16_bf16 v[128:143], v[180:183], v[8:11], v[128:143]
    v_mfma_f32_32x32x16_bf16 v[144:159], v[184:187], v[8:11], v[144:159]
    v_mfma_f32_32x32x16_bf16 v[160:175], v[188:191], v[8:11], v[160:175]
    s_waitcnt vmcnt(8)
    s_barrier
    s_add_u32 s42, s40, 0xa8080
    s_add_u32 m0, s39, 32768
    buffer_load_dwordx4 v227, s[12:15], s42 offen lds
    s_add_u32 s42, s40, 0xa8080
    s_add_u32 m0, s39, 36864
    buffer_load_dwordx4 v228, s[12:15], s42 offen lds
    s_add_u32 s42, s40, 0xa8080
    s_add_u32 m0, s39, 40960
    buffer_load_dwordx4 v229, s[16:19], s42 offen lds
    s_add_u32 s42, s40, 0xa8080
    s_add_u32 m0, s39, 45056
    buffer_load_dwordx4 v230, s[16:19], s42 offen lds
    ds_read_b64_tr_b16 v[176:177], v226 offset:0
    ds_read_b64_tr_b16 v[178:179], v226 offset:512
    ds_read_b64_tr_b16 v[180:181], v225 offset:64
    ds_read_b64_tr_b16 v[182:183], v225 offset:576
    ds_read_b64_tr_b16 v[184:185], v226 offset:8192
    ds_read_b64_tr_b16 v[186:187], v226 offset:8704
    ds_read_b64_tr_b16 v[188:189], v225 offset:8256
    ds_read_b64_tr_b16 v[190:191], v225 offset:8768
    s_waitcnt lgkmcnt(8)
    v_mfma_f32_32x32x16_bf16 v[112:127], v[192:195], v[12:15], v[112:127]
    v_mfma_f32_32x32x16_bf16 v[128:143], v[196:199], v[12:15], v[128:143]
    v_mfma_f32_32x32x16_bf16 v[144:159], v[200:203], v[12:15], v[144:159]
    v_mfma_f32_32x32x16_bf16 v[160:175], v[204:207], v[12:15], v[160:175]
    ds_read_b64_tr_b16 v[192:193], v226 offset:2048
    ds_read_b64_tr_b16 v[194:195], v226 offset:2560
    ds_read_b64_tr_b16 v[196:197], v225 offset:2112
    ds_read_b64_tr_b16 v[198:199], v225 offset:2624
    ds_read_b64_tr_b16 v[200:201], v226 offset:10240
    ds_read_b64_tr_b16 v[202:203], v226 offset:10752
    ds_read_b64_tr_b16 v[204:205], v225 offset:10304
    ds_read_b64_tr_b16 v[206:207], v225 offset:10816
    s_waitcnt lgkmcnt(8)
    v_mfma_f32_32x32x16_bf16 v[112:127], v[176:179], v[16:19], v[112:127]
    v_mfma_f32_32x32x16_bf16 v[128:143], v[180:183], v[16:19], v[128:143]
    v_mfma_f32_32x32x16_bf16 v[144:159], v[184:187], v[16:19], v[144:159]
    v_mfma_f32_32x32x16_bf16 v[160:175], v[188:191], v[16:19], v[160:175]
    ds_read_b64_tr_b16 v[176:177], v226 offset:4096
    ds_read_b64_tr_b16 v[178:179], v226 offset:4608
    ds_read_b64_tr_b16 v[180:181], v225 offset:4160
    ds_read_b64_tr_b16 v[182:183], v225 offset:4672
    ds_read_b64_tr_b16 v[184:185], v226 offset:12288
    ds_read_b64_tr_b16 v[186:187], v226 offset:12800
    ds_read_b64_tr_b16 v[188:189], v225 offset:12352
    ds_read_b64_tr_b16 v[190:191], v225 offset:12864
    s_waitcnt lgkmcnt(8)
    v_mfma_f32_32x32x16_bf16 v[112:127], v[192:195], v[20:23], v[112:127]
    v_mfma_f32_32x32x16_bf16 v[128:143], v[196:199], v[20:23], v[128:143]
    v_mfma_f32_32x32x16_bf16 v[144:159], v[200:203], v[20:23], v[144:159]
    v_mfma_f32_32x32x16_bf16 v[160:175], v[204:207], v[20:23], v[160:175]
    ds_read_b64_tr_b16 v[192:193], v226 offset:6144
    ds_read_b64_tr_b16 v[194:195], v226 offset:6656
    ds_read_b64_tr_b16 v[196:197], v225 offset:6208
    ds_read_b64_tr_b16 v[198:199], v225 offset:6720
    ds_read_b64_tr_b16 v[200:201], v226 offset:14336
    ds_read_b64_tr_b16 v[202:203], v226 offset:14848
    ds_read_b64_tr_b16 v[204:205], v225 offset:14400
    ds_read_b64_tr_b16 v[206:207], v225 offset:14912
    s_waitcnt lgkmcnt(8)
    v_mfma_f32_32x32x16_bf16 v[112:127], v[176:179], v[24:27], v[112:127]
    v_mfma_f32_32x32x16_bf16 v[128:143], v[180:183], v[24:27], v[128:143]
    v_mfma_f32_32x32x16_bf16 v[144:159], v[184:187], v[24:27], v[144:159]
    v_mfma_f32_32x32x16_bf16 v[160:175], v[188:191], v[24:27], v[160:175]
    s_waitcnt vmcnt(8)
    s_barrier
    s_add_u32 s42, s40, 0xe0080
    s_add_u32 m0, s39, 49152
    buffer_load_dwordx4 v227, s[12:15], s42 offen lds
    s_add_u32 s42, s40, 0xe0080
    s_add_u32 m0, s39, 53248
    buffer_load_dwordx4 v228, s[12:15], s42 offen lds
    s_add_u32 s42, s40, 0xe0080
    s_add_u32 m0, s39, 57344
    buffer_load_dwordx4 v229, s[16:19], s42 offen lds
    s_add_u32 s42, s40, 0xe0080
    s_add_u32 m0, s39, 61440
    buffer_load_dwordx4 v230, s[16:19], s42 offen lds
    ds_read_b64_tr_b16 v[176:177], v226 offset:16384
    ds_read_b64_tr_b16 v[178:179], v226 offset:16896
    ds_read_b64_tr_b16 v[180:181], v225 offset:16448
    ds_read_b64_tr_b16 v[182:183], v225 offset:16960
    ds_read_b64_tr_b16 v[184:185], v226 offset:24576
    ds_read_b64_tr_b16 v[186:187], v226 offset:25088
    ds_read_b64_tr_b16 v[188:189], v225 offset:24640
    ds_read_b64_tr_b16 v[190:191], v225 offset:25152
    s_waitcnt lgkmcnt(8)
    v_mfma_f32_32x32x16_bf16 v[112:127], v[192:195], v[28:31], v[112:127]
    v_mfma_f32_32x32x16_bf16 v[128:143], v[196:199], v[28:31], v[128:143]
    v_mfma_f32_32x32x16_bf16 v[144:159], v[200:203], v[28:31], v[144:159]
    v_mfma_f32_32x32x16_bf16 v[160:175], v[204:207], v[28:31], v[160:175]
    ds_read_b64_tr_b16 v[192:193], v226 offset:18432
    ds_read_b64_tr_b16 v[194:195], v226 offset:18944
    ds_read_b64_tr_b16 v[196:197], v225 offset:18496
    ds_read_b64_tr_b16 v[198:199], v225 offset:19008
    ds_read_b64_tr_b16 v[200:201], v226 offset:26624
    ds_read_b64_tr_b16 v[202:203], v226 offset:27136
    ds_read_b64_tr_b16 v[204:205], v225 offset:26688
    ds_read_b64_tr_b16 v[206:207], v225 offset:27200
    s_waitcnt lgkmcnt(8)
    v_mfma_f32_32x32x16_bf16 v[112:127], v[176:179], v[32:35], v[112:127]
    v_mfma_f32_32x32x16_bf16 v[128:143], v[180:183], v[32:35], v[128:143]
    v_mfma_f32_32x32x16_bf16 v[144:159], v[184:187], v[32:35], v[144:159]
    v_mfma_f32_32x32x16_bf16 v[160:175], v[188:191], v[32:35], v[160:175]
    ds_read_b64_tr_b16 v[176:177], v226 offset:20480
    ds_read_b64_tr_b16 v[178:179], v226 offset:20992
    ds_read_b64_tr_b16 v[180:181], v225 offset:20544
    ds_read_b64_tr_b16 v[182:183], v225 offset:21056
    ds_read_b64_tr_b16 v[184:185], v226 offset:28672
    ds_read_b64_tr_b16 v[186:187], v226 offset:29184
    ds_read_b64_tr_b16 v[188:189], v225 offset:28736
    ds_read_b64_tr_b16 v[190:191], v225 offset:29248
    s_waitcnt lgkmcnt(8)
    v_mfma_f32_32x32x16_bf16 v[112:127], v[192:195], v[36:39], v[112:127]
    v_mfma_f32_32x32x16_bf16 v[128:143], v[196:199], v[36:39], v[128:143]
    v_mfma_f32_32x32x16_bf16 v[144:159], v[200:203], v[36:39], v[144:159]
    v_mfma_f32_32x32x16_bf16 v[160:175], v[204:207], v[36:39], v[160:175]
    ds_read_b64_tr_b16 v[192:193], v226 offset:22528
    ds_read_b64_tr_b16 v[194:195], v226 offset:23040
    ds_read_b64_tr_b16 v[196:197], v225 offset:22592
    ds_read_b64_tr_b16 v[198:199], v225 offset:23104
    ds_read_b64_tr_b16 v[200:201], v226 offset:30720
    ds_read_b64_tr_b16 v[202:203], v226 offset:31232
    ds_read_b64_tr_b16 v[204:205], v225 offset:30784
    ds_read_b64_tr_b16 v[206:207], v225 offset:31296
    s_waitcnt lgkmcnt(8)
    v_mfma_f32_32x32x16_bf16 v[112:127], v[176:179], v[40:43], v[112:127]
    v_mfma_f32_32x32x16_bf16 v[128:143], v[180:183], v[40:43], v[128:143]
    v_mfma_f32_32x32x16_bf16 v[144:159], v[184:187], v[40:43], v[144:159]
    v_mfma_f32_32x32x16_bf16 v[160:175], v[188:191], v[40:43], v[160:175]
    s_waitcnt vmcnt(4)
    s_barrier
    s_add_u32 s42, s40, 0x118080
    s_add_u32 m0, s39, 0
    buffer_load_dwordx4 v227, s[12:15], s42 offen lds
    s_add_u32 s42, s40, 0x118080
    s_add_u32 m0, s39, 4096
    buffer_load_dwordx4 v228, s[12:15], s42 offen lds
    s_add_u32 s42, s40, 0x118080
    s_add_u32 m0, s39, 8192
    buffer_load_dwordx4 v229, s[16:19], s42 offen lds
    s_add_u32 s42, s40, 0x118080
    s_add_u32 m0, s39, 12288
    buffer_load_dwordx4 v230, s[16:19], s42 offen lds
    ds_read_b64_tr_b16 v[176:177], v226 offset:32768
    ds_read_b64_tr_b16 v[178:179], v226 offset:33280
    ds_read_b64_tr_b16 v[180:181], v225 offset:32832
    ds_read_b64_tr_b16 v[182:183], v225 offset:33344
    ds_read_b64_tr_b16 v[184:185], v226 offset:40960
    ds_read_b64_tr_b16 v[186:187], v226 offset:41472
    ds_read_b64_tr_b16 v[188:189], v225 offset:41024
    ds_read_b64_tr_b16 v[190:191], v225 offset:41536
    s_waitcnt lgkmcnt(8)
    v_mfma_f32_32x32x16_bf16 v[112:127], v[192:195], v[44:47], v[112:127]
    v_mfma_f32_32x32x16_bf16 v[128:143], v[196:199], v[44:47], v[128:143]
    v_mfma_f32_32x32x16_bf16 v[144:159], v[200:203], v[44:47], v[144:159]
    v_mfma_f32_32x32x16_bf16 v[160:175], v[204:207], v[44:47], v[160:175]
    ds_read_b64_tr_b16 v[192:193], v226 offset:34816
    ds_read_b64_tr_b16 v[194:195], v226 offset:35328
    ds_read_b64_tr_b16 v[196:197], v225 offset:34880
    ds_read_b64_tr_b16 v[198:199], v225 offset:35392
    ds_read_b64_tr_b16 v[200:201], v226 offset:43008
    ds_read_b64_tr_b16 v[202:203], v226 offset:43520
    ds_read_b64_tr_b16 v[204:205], v225 offset:43072
    ds_read_b64_tr_b16 v[206:207], v225 offset:43584
    s_waitcnt lgkmcnt(8)
    v_mfma_f32_32x32x16_bf16 v[112:127], v[176:179], v[48:51], v[112:127]
    v_mfma_f32_32x32x16_bf16 v[128:143], v[180:183], v[48:51], v[128:143]
    v_mfma_f32_32x32x16_bf16 v[144:159], v[184:187], v[48:51], v[144:159]
    v_mfma_f32_32x32x16_bf16 v[160:175], v[188:191], v[48:51], v[160:175]
    ds_read_b64_tr_b16 v[176:177], v226 offset:36864
    ds_read_b64_tr_b16 v[178:179], v226 offset:37376
    ds_read_b64_tr_b16 v[180:181], v225 offset:36928
    ds_read_b64_tr_b16 v[182:183], v225 offset:37440
    ds_read_b64_tr_b16 v[184:185], v226 offset:45056
    ds_read_b64_tr_b16 v[186:187], v226 offset:45568
    ds_read_b64_tr_b16 v[188:189], v225 offset:45120
    ds_read_b64_tr_b16 v[190:191], v225 offset:45632
    s_waitcnt lgkmcnt(8)
    v_mfma_f32_32x32x16_bf16 v[112:127], v[192:195], v[52:55], v[112:127]
    v_mfma_f32_32x32x16_bf16 v[128:143], v[196:199], v[52:55], v[128:143]
    v_mfma_f32_32x32x16_bf16 v[144:159], v[200:203], v[52:55], v[144:159]
    v_mfma_f32_32x32x16_bf16 v[160:175], v[204:207], v[52:55], v[160:175]
    ds_read_b64_tr_b16 v[192:193], v226 offset:38912
    ds_read_b64_tr_b16 v[194:195], v226 offset:39424
    ds_read_b64_tr_b16 v[196:197], v225 offset:38976
    ds_read_b64_tr_b16 v[198:199], v225 offset:39488
    ds_read_b64_tr_b16 v[200:201], v226 offset:47104
    ds_read_b64_tr_b16 v[202:203], v226 offset:47616
    ds_read_b64_tr_b16 v[204:205], v225 offset:47168
    ds_read_b64_tr_b16 v[206:207], v225 offset:47680
    s_waitcnt lgkmcnt(8)
    v_mfma_f32_32x32x16_bf16 v[112:127], v[176:179], v[56:59], v[112:127]
    v_mfma_f32_32x32x16_bf16 v[128:143], v[180:183], v[56:59], v[128:143]
    v_mfma_f32_32x32x16_bf16 v[144:159], v[184:187], v[56:59], v[144:159]
    v_mfma_f32_32x32x16_bf16 v[160:175], v[188:191], v[56:59], v[160:175]
    s_waitcnt vmcnt(4)
    s_barrier
    s_add_u32 s42, s40, 0x150080
    s_add_u32 m0, s39, 16384
    buffer_load_dwordx4 v227, s[12:15], s42 offen lds
    s_add_u32 s42, s40, 0x150080
    s_add_u32 m0, s39, 20480
    buffer_load_dwordx4 v228, s[12:15], s42 offen lds
    s_add_u32 s42, s40, 0x150080
    s_add_u32 m0, s39, 24576
    buffer_load_dwordx4 v229, s[16:19], s42 offen lds
    s_add_u32 s42, s40, 0x150080
    s_add_u32 m0, s39, 28672
    buffer_load_dwordx4 v230, s[16:19], s42 offen lds
    ds_read_b64_tr_b16 v[176:177], v226 offset:49152
    ds_read_b64_tr_b16 v[178:179], v226 offset:49664
    ds_read_b64_tr_b16 v[180:181], v225 offset:49216
    ds_read_b64_tr_b16 v[182:183], v225 offset:49728
    ds_read_b64_tr_b16 v[184:185], v226 offset:57344
    ds_read_b64_tr_b16 v[186:187], v226 offset:57856
    ds_read_b64_tr_b16 v[188:189], v225 offset:57408
    ds_read_b64_tr_b16 v[190:191], v225 offset:57920
    s_waitcnt lgkmcnt(8)
    v_mfma_f32_32x32x16_bf16 v[112:127], v[192:195], v[60:63], v[112:127]
    v_mfma_f32_32x32x16_bf16 v[128:143], v[196:199], v[60:63], v[128:143]
    v_mfma_f32_32x32x16_bf16 v[144:159], v[200:203], v[60:63], v[144:159]
    v_mfma_f32_32x32x16_bf16 v[160:175], v[204:207], v[60:63], v[160:175]
    ds_read_b64_tr_b16 v[192:193], v226 offset:51200
    ds_read_b64_tr_b16 v[194:195], v226 offset:51712
    ds_read_b64_tr_b16 v[196:197], v225 offset:51264
    ds_read_b64_tr_b16 v[198:199], v225 offset:51776
    ds_read_b64_tr_b16 v[200:201], v226 offset:59392
    ds_read_b64_tr_b16 v[202:203], v226 offset:59904
    ds_read_b64_tr_b16 v[204:205], v225 offset:59456
    ds_read_b64_tr_b16 v[206:207], v225 offset:59968
    s_waitcnt lgkmcnt(8)
    v_mfma_f32_32x32x16_bf16 v[112:127], v[176:179], v[64:67], v[112:127]
    v_mfma_f32_32x32x16_bf16 v[128:143], v[180:183], v[64:67], v[128:143]
    v_mfma_f32_32x32x16_bf16 v[144:159], v[184:187], v[64:67], v[144:159]
    v_mfma_f32_32x32x16_bf16 v[160:175], v[188:191], v[64:67], v[160:175]
    ds_read_b64_tr_b16 v[176:177], v226 offset:53248
    ds_read_b64_tr_b16 v[178:179], v226 offset:53760
    ds_read_b64_tr_b16 v[180:181], v225 offset:53312
    ds_read_b64_tr_b16 v[182:183], v225 offset:53824
    ds_read_b64_tr_b16 v[184:185], v226 offset:61440
    ds_read_b64_tr_b16 v[186:187], v226 offset:61952
    ds_read_b64_tr_b16 v[188:189], v225 offset:61504
    ds_read_b64_tr_b16 v[190:191], v225 offset:62016
    s_waitcnt lgkmcnt(8)
    v_mfma_f32_32x32x16_bf16 v[112:127], v[192:195], v[68:71], v[112:127]
    v_mfma_f32_32x32x16_bf16 v[128:143], v[196:199], v[68:71], v[128:143]
    v_mfma_f32_32x32x16_bf16 v[144:159], v[200:203], v[68:71], v[144:159]
    v_mfma_f32_32x32x16_bf16 v[160:175], v[204:207], v[68:71], v[160:175]
    ds_read_b64_tr_b16 v[192:193], v226 offset:55296
    ds_read_b64_tr_b16 v[194:195], v226 offset:55808
    ds_read_b64_tr_b16 v[196:197], v225 offset:55360
    ds_read_b64_tr_b16 v[198:199], v225 offset:55872
    ds_read_b64_tr_b16 v[200:201], v226 offset:63488
    ds_read_b64_tr_b16 v[202:203], v226 offset:64000
    ds_read_b64_tr_b16 v[204:205], v225 offset:63552
    ds_read_b64_tr_b16 v[206:207], v225 offset:64064
    s_waitcnt lgkmcnt(8)
    v_mfma_f32_32x32x16_bf16 v[112:127], v[176:179], v[72:75], v[112:127]
    v_mfma_f32_32x32x16_bf16 v[128:143], v[180:183], v[72:75], v[128:143]
    v_mfma_f32_32x32x16_bf16 v[144:159], v[184:187], v[72:75], v[144:159]
    v_mfma_f32_32x32x16_bf16 v[160:175], v[188:191], v[72:75], v[160:175]
    s_waitcnt vmcnt(4)
    s_barrier
    ds_read_b64_tr_b16 v[176:177], v226 offset:0
    ds_read_b64_tr_b16 v[178:179], v226 offset:512
    ds_read_b64_tr_b16 v[180:181], v225 offset:64
    ds_read_b64_tr_b16 v[182:183], v225 offset:576
    ds_read_b64_tr_b16 v[184:185], v226 offset:8192
    ds_read_b64_tr_b16 v[186:187], v226 offset:8704
    ds_read_b64_tr_b16 v[188:189], v225 offset:8256
    ds_read_b64_tr_b16 v[190:191], v225 offset:8768
    s_waitcnt lgkmcnt(8)
    v_mfma_f32_32x32x16_bf16 v[112:127], v[192:195], v[76:79], v[112:127]
    v_mfma_f32_32x32x16_bf16 v[128:143], v[196:199], v[76:79], v[128:143]
    v_mfma_f32_32x32x16_bf16 v[144:159], v[200:203], v[76:79], v[144:159]
    v_mfma_f32_32x32x16_bf16 v[160:175], v[204:207], v[76:79], v[160:175]
    ds_read_b64_tr_b16 v[192:193], v226 offset:2048
    ds_read_b64_tr_b16 v[194:195], v226 offset:2560
    ds_read_b64_tr_b16 v[196:197], v225 offset:2112
    ds_read_b64_tr_b16 v[198:199], v225 offset:2624
    ds_read_b64_tr_b16 v[200:201], v226 offset:10240
    ds_read_b64_tr_b16 v[202:203], v226 offset:10752
    ds_read_b64_tr_b16 v[204:205], v225 offset:10304
    ds_read_b64_tr_b16 v[206:207], v225 offset:10816
    s_waitcnt lgkmcnt(8)
    v_mfma_f32_32x32x16_bf16 v[112:127], v[176:179], v[80:83], v[112:127]
    v_mfma_f32_32x32x16_bf16 v[128:143], v[180:183], v[80:83], v[128:143]
    v_mfma_f32_32x32x16_bf16 v[144:159], v[184:187], v[80:83], v[144:159]
    v_mfma_f32_32x32x16_bf16 v[160:175], v[188:191], v[80:83], v[160:175]
    ds_read_b64_tr_b16 v[176:177], v226 offset:4096
    ds_read_b64_tr_b16 v[178:179], v226 offset:4608
    ds_read_b64_tr_b16 v[180:181], v225 offset:4160
    ds_read_b64_tr_b16 v[182:183], v225 offset:4672
    ds_read_b64_tr_b16 v[184:185], v226 offset:12288
    ds_read_b64_tr_b16 v[186:187], v226 offset:12800
    ds_read_b64_tr_b16 v[188:189], v225 offset:12352
    ds_read_b64_tr_b16 v[190:191], v225 offset:12864
    s_waitcnt lgkmcnt(8)
    v_mfma_f32_32x32x16_bf16 v[112:127], v[192:195], v[84:87], v[112:127]
    v_mfma_f32_32x32x16_bf16 v[128:143], v[196:199], v[84:87], v[128:143]
    v_mfma_f32_32x32x16_bf16 v[144:159], v[200:203], v[84:87], v[144:159]
    v_mfma_f32_32x32x16_bf16 v[160:175], v[204:207], v[84:87], v[160:175]
    ds_read_b64_tr_b16 v[192:193], v226 offset:6144
    ds_read_b64_tr_b16 v[194:195], v226 offset:6656
    ds_read_b64_tr_b16 v[196:197], v225 offset:6208
    ds_read_b64_tr_b16 v[198:199], v225 offset:6720
    ds_read_b64_tr_b16 v[200:201], v226 offset:14336
    ds_read_b64_tr_b16 v[202:203], v226 offset:14848
    ds_read_b64_tr_b16 v[204:205], v225 offset:14400
    ds_read_b64_tr_b16 v[206:207], v225 offset:14912
    s_waitcnt lgkmcnt(8)
    v_mfma_f32_32x32x16_bf16 v[112:127], v[176:179], v[88:91], v[112:127]
    v_mfma_f32_32x32x16_bf16 v[128:143], v[180:183], v[88:91], v[128:143]
    v_mfma_f32_32x32x16_bf16 v[144:159], v[184:187], v[88:91], v[144:159]
    v_mfma_f32_32x32x16_bf16 v[160:175], v[188:191], v[88:91], v[160:175]
    s_waitcnt vmcnt(0)
    s_barrier
    ds_read_b64_tr_b16 v[176:177], v226 offset:16384
    ds_read_b64_tr_b16 v[178:179], v226 offset:16896
    ds_read_b64_tr_b16 v[180:181], v225 offset:16448
    ds_read_b64_tr_b16 v[182:183], v225 offset:16960
    ds_read_b64_tr_b16 v[184:185], v226 offset:24576
    ds_read_b64_tr_b16 v[186:187], v226 offset:25088
    ds_read_b64_tr_b16 v[188:189], v225 offset:24640
    ds_read_b64_tr_b16 v[190:191], v225 offset:25152
    s_waitcnt lgkmcnt(8)
    v_mfma_f32_32x32x16_bf16 v[112:127], v[192:195], v[92:95], v[112:127]
    v_mfma_f32_32x32x16_bf16 v[128:143], v[196:199], v[92:95], v[128:143]
    v_mfma_f32_32x32x16_bf16 v[144:159], v[200:203], v[92:95], v[144:159]
    v_mfma_f32_32x32x16_bf16 v[160:175], v[204:207], v[92:95], v[160:175]
    ds_read_b64_tr_b16 v[192:193], v226 offset:18432
    ds_read_b64_tr_b16 v[194:195], v226 offset:18944
    ds_read_b64_tr_b16 v[196:197], v225 offset:18496
    ds_read_b64_tr_b16 v[198:199], v225 offset:19008
    ds_read_b64_tr_b16 v[200:201], v226 offset:26624
    ds_read_b64_tr_b16 v[202:203], v226 offset:27136
    ds_read_b64_tr_b16 v[204:205], v225 offset:26688
    ds_read_b64_tr_b16 v[206:207], v225 offset:27200
    s_waitcnt lgkmcnt(8)
    v_mfma_f32_32x32x16_bf16 v[112:127], v[176:179], v[96:99], v[112:127]
    v_mfma_f32_32x32x16_bf16 v[128:143], v[180:183], v[96:99], v[128:143]
    v_mfma_f32_32x32x16_bf16 v[144:159], v[184:187], v[96:99], v[144:159]
    v_mfma_f32_32x32x16_bf16 v[160:175], v[188:191], v[96:99], v[160:175]
    ds_read_b64_tr_b16 v[176:177], v226 offset:20480
    ds_read_b64_tr_b16 v[178:179], v226 offset:20992
    ds_read_b64_tr_b16 v[180:181], v225 offset:20544
    ds_read_b64_tr_b16 v[182:183], v225 offset:21056
    ds_read_b64_tr_b16 v[184:185], v226 offset:28672
    ds_read_b64_tr_b16 v[186:187], v226 offset:29184
    ds_read_b64_tr_b16 v[188:189], v225 offset:28736
    ds_read_b64_tr_b16 v[190:191], v225 offset:29248
    s_waitcnt lgkmcnt(8)
    v_mfma_f32_32x32x16_bf16 v[112:127], v[192:195], v[100:103], v[112:127]
    v_mfma_f32_32x32x16_bf16 v[128:143], v[196:199], v[100:103], v[128:143]
    v_mfma_f32_32x32x16_bf16 v[144:159], v[200:203], v[100:103], v[144:159]
    v_mfma_f32_32x32x16_bf16 v[160:175], v[204:207], v[100:103], v[160:175]
    ds_read_b64_tr_b16 v[192:193], v226 offset:22528
    ds_read_b64_tr_b16 v[194:195], v226 offset:23040
    ds_read_b64_tr_b16 v[196:197], v225 offset:22592
    ds_read_b64_tr_b16 v[198:199], v225 offset:23104
    ds_read_b64_tr_b16 v[200:201], v226 offset:30720
    ds_read_b64_tr_b16 v[202:203], v226 offset:31232
    ds_read_b64_tr_b16 v[204:205], v225 offset:30784
    ds_read_b64_tr_b16 v[206:207], v225 offset:31296
    s_waitcnt lgkmcnt(8)
    v_mfma_f32_32x32x16_bf16 v[112:127], v[176:179], v[104:107], v[112:127]
    v_mfma_f32_32x32x16_bf16 v[128:143], v[180:183], v[104:107], v[128:143]
    v_mfma_f32_32x32x16_bf16 v[144:159], v[184:187], v[104:107], v[144:159]
    v_mfma_f32_32x32x16_bf16 v[160:175], v[188:191], v[104:107], v[160:175]
    s_waitcnt lgkmcnt(0)
    v_mfma_f32_32x32x16_bf16 v[112:127], v[192:195], v[108:111], v[112:127]
    v_mfma_f32_32x32x16_bf16 v[128:143], v[196:199], v[108:111], v[128:143]
    v_mfma_f32_32x32x16_bf16 v[144:159], v[200:203], v[108:111], v[144:159]
    v_mfma_f32_32x32x16_bf16 v[160:175], v[204:207], v[108:111], v[160:175]
    s_nop 15
    s_nop 3
    s_mul_i32 s41, s48, 112
    s_lshr_b32 s49, s43, 4
    s_add_u32 s41, s41, s49
    s_add_u32 s41, s41, 4
    s_lshl_b32 s41, s41, 10
    v_lshlrev_b32 v216, 4, v224
    v_add_u32 v216, s41, v216
    v_mul_f32 v236, v112, v232
    v_mul_f32 v240, v144, v232
    v_mul_f32 v237, v113, v232
    v_mul_f32 v241, v145, v232
    v_mul_f32 v238, v114, v232
    v_mul_f32 v242, v146, v232
    v_mul_f32 v239, v115, v232
    v_mul_f32 v243, v147, v232
    v_cvt_pk_bf16_f32 v244, v236, v237
    v_cvt_pk_bf16_f32 v245, v238, v239
    v_lshlrev_b32 v236, 16, v244
    v_and_b32 v237, 0xffff0000, v244
    v_lshlrev_b32 v238, 16, v245
    v_and_b32 v239, 0xffff0000, v245
    v_cvt_pk_bf16_f32 v244, v240, v241
    v_cvt_pk_bf16_f32 v245, v242, v243
    v_lshlrev_b32 v240, 16, v244
    v_and_b32 v241, 0xffff0000, v244
    v_lshlrev_b32 v242, 16, v245
    v_and_b32 v243, 0xffff0000, v245
    v_mul_f32 v236, 0xbfb8aa3b, v236
    v_mul_f32 v237, 0xbfb8aa3b, v237
    v_mul_f32 v238, 0xbfb8aa3b, v238
    v_mul_f32 v239, 0xbfb8aa3b, v239
    v_exp_f32 v236, v236
    v_exp_f32 v237, v237
    v_exp_f32 v238, v238
    v_exp_f32 v239, v239
    s_nop 0
    v_add_f32 v236, 1.0, v236
    v_add_f32 v237, 1.0, v237
    v_add_f32 v238, 1.0, v238
    v_add_f32 v239, 1.0, v239
    v_rcp_f32 v236, v236
    v_rcp_f32 v237, v237
    v_rcp_f32 v238, v238
    v_rcp_f32 v239, v239
    s_nop 0
    v_cvt_pk_bf16_f32 v244, v236, v237
    v_cvt_pk_bf16_f32 v245, v238, v239
    v_lshlrev_b32 v236, 16, v244
    v_and_b32 v237, 0xffff0000, v244
    v_lshlrev_b32 v238, 16, v245
    v_and_b32 v239, 0xffff0000, v245
    v_mul_f32 v236, v236, v240
    v_mul_f32 v237, v237, v241
    v_mul_f32 v238, v238, v242
    v_mul_f32 v239, v239, v243
    v_cvt_pk_bf16_f32 v208, v236, v237
    v_cvt_pk_bf16_f32 v209, v238, v239
    v_mul_f32 v236, v116, v232
    v_mul_f32 v240, v148, v232
    v_mul_f32 v237, v117, v232
    v_mul_f32 v241, v149, v232
    v_mul_f32 v238, v118, v232
    v_mul_f32 v242, v150, v232
    v_mul_f32 v239, v119, v232
    v_mul_f32 v243, v151, v232
    v_cvt_pk_bf16_f32 v244, v236, v237
    v_cvt_pk_bf16_f32 v245, v238, v239
    v_lshlrev_b32 v236, 16, v244
    v_and_b32 v237, 0xffff0000, v244
    v_lshlrev_b32 v238, 16, v245
    v_and_b32 v239, 0xffff0000, v245
    v_cvt_pk_bf16_f32 v244, v240, v241
    v_cvt_pk_bf16_f32 v245, v242, v243
    v_lshlrev_b32 v240, 16, v244
    v_and_b32 v241, 0xffff0000, v244
    v_lshlrev_b32 v242, 16, v245
    v_and_b32 v243, 0xffff0000, v245
    v_mul_f32 v236, 0xbfb8aa3b, v236
    v_mul_f32 v237, 0xbfb8aa3b, v237
    v_mul_f32 v238, 0xbfb8aa3b, v238
    v_mul_f32 v239, 0xbfb8aa3b, v239
    v_exp_f32 v236, v236
    v_exp_f32 v237, v237
    v_exp_f32 v238, v238
    v_exp_f32 v239, v239
    s_nop 0
    v_add_f32 v236, 1.0, v236
    v_add_f32 v237, 1.0, v237
    v_add_f32 v238, 1.0, v238
    v_add_f32 v239, 1.0, v239
    v_rcp_f32 v236, v236
    v_rcp_f32 v237, v237
    v_rcp_f32 v238, v238
    v_rcp_f32 v239, v239
    s_nop 0
    v_cvt_pk_bf16_f32 v244, v236, v237
    v_cvt_pk_bf16_f32 v245, v238, v239
    v_lshlrev_b32 v236, 16, v244
    v_and_b32 v237, 0xffff0000, v244
    v_lshlrev_b32 v238, 16, v245
    v_and_b32 v239, 0xffff0000, v245
    v_mul_f32 v236, v236, v240
    v_mul_f32 v237, v237, v241
    v_mul_f32 v238, v238, v242
    v_mul_f32 v239, v239, v243
    v_cvt_pk_bf16_f32 v210, v236, v237
    v_cvt_pk_bf16_f32 v211, v238, v239
    v_mul_f32 v236, v120, v232
    v_mul_f32 v240, v152, v232
    v_mul_f32 v237, v121, v232
    v_mul_f32 v241, v153, v232
    v_mul_f32 v238, v122, v232
    v_mul_f32 v242, v154, v232
    v_mul_f32 v239, v123, v232
    v_mul_f32 v243, v155, v232
    v_cvt_pk_bf16_f32 v244, v236, v237
    v_cvt_pk_bf16_f32 v245, v238, v239
    v_lshlrev_b32 v236, 16, v244
    v_and_b32 v237, 0xffff0000, v244
    v_lshlrev_b32 v238, 16, v245
    v_and_b32 v239, 0xffff0000, v245
    v_cvt_pk_bf16_f32 v244, v240, v241
    v_cvt_pk_bf16_f32 v245, v242, v243
    v_lshlrev_b32 v240, 16, v244
    v_and_b32 v241, 0xffff0000, v244
    v_lshlrev_b32 v242, 16, v245
    v_and_b32 v243, 0xffff0000, v245
    v_mul_f32 v236, 0xbfb8aa3b, v236
    v_mul_f32 v237, 0xbfb8aa3b, v237
    v_mul_f32 v238, 0xbfb8aa3b, v238
    v_mul_f32 v239, 0xbfb8aa3b, v239
    v_exp_f32 v236, v236
    v_exp_f32 v237, v237
    v_exp_f32 v238, v238
    v_exp_f32 v239, v239
    s_nop 0
    v_add_f32 v236, 1.0, v236
    v_add_f32 v237, 1.0, v237
    v_add_f32 v238, 1.0, v238
    v_add_f32 v239, 1.0, v239
    v_rcp_f32 v236, v236
    v_rcp_f32 v237, v237
    v_rcp_f32 v238, v238
    v_rcp_f32 v239, v239
    s_nop 0
    v_cvt_pk_bf16_f32 v244, v236, v237
    v_cvt_pk_bf16_f32 v245, v238, v239
    v_lshlrev_b32 v236, 16, v244
    v_and_b32 v237, 0xffff0000, v244
    v_lshlrev_b32 v238, 16, v245
    v_and_b32 v239, 0xffff0000, v245
    v_mul_f32 v236, v236, v240
    v_mul_f32 v237, v237, v241
    v_mul_f32 v238, v238, v242
    v_mul_f32 v239, v239, v243
    v_cvt_pk_bf16_f32 v212, v236, v237
    v_cvt_pk_bf16_f32 v213, v238, v239
    v_mul_f32 v236, v124, v232
    v_mul_f32 v240, v156, v232
    v_mul_f32 v237, v125, v232
    v_mul_f32 v241, v157, v232
    v_mul_f32 v238, v126, v232
    v_mul_f32 v242, v158, v232
    v_mul_f32 v239, v127, v232
    v_mul_f32 v243, v159, v232
    v_cvt_pk_bf16_f32 v244, v236, v237
    v_cvt_pk_bf16_f32 v245, v238, v239
    v_lshlrev_b32 v236, 16, v244
    v_and_b32 v237, 0xffff0000, v244
    v_lshlrev_b32 v238, 16, v245
    v_and_b32 v239, 0xffff0000, v245
    v_cvt_pk_bf16_f32 v244, v240, v241
    v_cvt_pk_bf16_f32 v245, v242, v243
    v_lshlrev_b32 v240, 16, v244
    v_and_b32 v241, 0xffff0000, v244
    v_lshlrev_b32 v242, 16, v245
    v_and_b32 v243, 0xffff0000, v245
    v_mul_f32 v236, 0xbfb8aa3b, v236
    v_mul_f32 v237, 0xbfb8aa3b, v237
    v_mul_f32 v238, 0xbfb8aa3b, v238
    v_mul_f32 v239, 0xbfb8aa3b, v239
    v_exp_f32 v236, v236
    v_exp_f32 v237, v237
    v_exp_f32 v238, v238
    v_exp_f32 v239, v239
    s_nop 0
    v_add_f32 v236, 1.0, v236
    v_add_f32 v237, 1.0, v237
    v_add_f32 v238, 1.0, v238
    v_add_f32 v239, 1.0, v239
    v_rcp_f32 v236, v236
    v_rcp_f32 v237, v237
    v_rcp_f32 v238, v238
    v_rcp_f32 v239, v239
    s_nop 0
    v_cvt_pk_bf16_f32 v244, v236, v237
    v_cvt_pk_bf16_f32 v245, v238, v239
    v_lshlrev_b32 v236, 16, v244
    v_and_b32 v237, 0xffff0000, v244
    v_lshlrev_b32 v238, 16, v245
    v_and_b32 v239, 0xffff0000, v245
    v_mul_f32 v236, v236, v240
    v_mul_f32 v237, v237, v241
    v_mul_f32 v238, v238, v242
    v_mul_f32 v239, v239, v243
    v_cvt_pk_bf16_f32 v214, v236, v237
    v_cvt_pk_bf16_f32 v215, v238, v239
    s_nop 1
    v_permlane32_swap_b32 v208, v210
    v_permlane32_swap_b32 v209, v211
    v_permlane32_swap_b32 v212, v214
    v_permlane32_swap_b32 v213, v215
    s_nop 1
    buffer_store_dwordx4 v[208:211], v216, s[20:23], 0 offen offset:0
    buffer_store_dwordx4 v[212:215], v216, s[20:23], 0 offen offset:1024
    s_nop 1
    v_mul_f32 v236, v128, v232
    v_mul_f32 v240, v160, v232
    v_mul_f32 v237, v129, v232
    v_mul_f32 v241, v161, v232
    v_mul_f32 v238, v130, v232
    v_mul_f32 v242, v162, v232
    v_mul_f32 v239, v131, v232
    v_mul_f32 v243, v163, v232
    v_cvt_pk_bf16_f32 v244, v236, v237
    v_cvt_pk_bf16_f32 v245, v238, v239
    v_lshlrev_b32 v236, 16, v244
    v_and_b32 v237, 0xffff0000, v244
    v_lshlrev_b32 v238, 16, v245
    v_and_b32 v239, 0xffff0000, v245
    v_cvt_pk_bf16_f32 v244, v240, v241
    v_cvt_pk_bf16_f32 v245, v242, v243
    v_lshlrev_b32 v240, 16, v244
    v_and_b32 v241, 0xffff0000, v244
    v_lshlrev_b32 v242, 16, v245
    v_and_b32 v243, 0xffff0000, v245
    v_mul_f32 v236, 0xbfb8aa3b, v236
    v_mul_f32 v237, 0xbfb8aa3b, v237
    v_mul_f32 v238, 0xbfb8aa3b, v238
    v_mul_f32 v239, 0xbfb8aa3b, v239
    v_exp_f32 v236, v236
    v_exp_f32 v237, v237
    v_exp_f32 v238, v238
    v_exp_f32 v239, v239
    s_nop 0
    v_add_f32 v236, 1.0, v236
    v_add_f32 v237, 1.0, v237
    v_add_f32 v238, 1.0, v238
    v_add_f32 v239, 1.0, v239
    v_rcp_f32 v236, v236
    v_rcp_f32 v237, v237
    v_rcp_f32 v238, v238
    v_rcp_f32 v239, v239
    s_nop 0
    v_cvt_pk_bf16_f32 v244, v236, v237
    v_cvt_pk_bf16_f32 v245, v238, v239
    v_lshlrev_b32 v236, 16, v244
    v_and_b32 v237, 0xffff0000, v244
    v_lshlrev_b32 v238, 16, v245
    v_and_b32 v239, 0xffff0000, v245
    v_mul_f32 v236, v236, v240
    v_mul_f32 v237, v237, v241
    v_mul_f32 v238, v238, v242
    v_mul_f32 v239, v239, v243
    v_cvt_pk_bf16_f32 v208, v236, v237
    v_cvt_pk_bf16_f32 v209, v238, v239
    v_mul_f32 v236, v132, v232
    v_mul_f32 v240, v164, v232
    v_mul_f32 v237, v133, v232
    v_mul_f32 v241, v165, v232
    v_mul_f32 v238, v134, v232
    v_mul_f32 v242, v166, v232
    v_mul_f32 v239, v135, v232
    v_mul_f32 v243, v167, v232
    v_cvt_pk_bf16_f32 v244, v236, v237
    v_cvt_pk_bf16_f32 v245, v238, v239
    v_lshlrev_b32 v236, 16, v244
    v_and_b32 v237, 0xffff0000, v244
    v_lshlrev_b32 v238, 16, v245
    v_and_b32 v239, 0xffff0000, v245
    v_cvt_pk_bf16_f32 v244, v240, v241
    v_cvt_pk_bf16_f32 v245, v242, v243
    v_lshlrev_b32 v240, 16, v244
    v_and_b32 v241, 0xffff0000, v244
    v_lshlrev_b32 v242, 16, v245
    v_and_b32 v243, 0xffff0000, v245
    v_mul_f32 v236, 0xbfb8aa3b, v236
    v_mul_f32 v237, 0xbfb8aa3b, v237
    v_mul_f32 v238, 0xbfb8aa3b, v238
    v_mul_f32 v239, 0xbfb8aa3b, v239
    v_exp_f32 v236, v236
    v_exp_f32 v237, v237
    v_exp_f32 v238, v238
    v_exp_f32 v239, v239
    s_nop 0
    v_add_f32 v236, 1.0, v236
    v_add_f32 v237, 1.0, v237
    v_add_f32 v238, 1.0, v238
    v_add_f32 v239, 1.0, v239
    v_rcp_f32 v236, v236
    v_rcp_f32 v237, v237
    v_rcp_f32 v238, v238
    v_rcp_f32 v239, v239
    s_nop 0
    v_cvt_pk_bf16_f32 v244, v236, v237
    v_cvt_pk_bf16_f32 v245, v238, v239
    v_lshlrev_b32 v236, 16, v244
    v_and_b32 v237, 0xffff0000, v244
    v_lshlrev_b32 v238, 16, v245
    v_and_b32 v239, 0xffff0000, v245
    v_mul_f32 v236, v236, v240
    v_mul_f32 v237, v237, v241
    v_mul_f32 v238, v238, v242
    v_mul_f32 v239, v239, v243
    v_cvt_pk_bf16_f32 v210, v236, v237
    v_cvt_pk_bf16_f32 v211, v238, v239
    v_mul_f32 v236, v136, v232
    v_mul_f32 v240, v168, v232
    v_mul_f32 v237, v137, v232
    v_mul_f32 v241, v169, v232
    v_mul_f32 v238, v138, v232
    v_mul_f32 v242, v170, v232
    v_mul_f32 v239, v139, v232
    v_mul_f32 v243, v171, v232
    v_cvt_pk_bf16_f32 v244, v236, v237
    v_cvt_pk_bf16_f32 v245, v238, v239
    v_lshlrev_b32 v236, 16, v244
    v_and_b32 v237, 0xffff0000, v244
    v_lshlrev_b32 v238, 16, v245
    v_and_b32 v239, 0xffff0000, v245
    v_cvt_pk_bf16_f32 v244, v240, v241
    v_cvt_pk_bf16_f32 v245, v242, v243
    v_lshlrev_b32 v240, 16, v244
    v_and_b32 v241, 0xffff0000, v244
    v_lshlrev_b32 v242, 16, v245
    v_and_b32 v243, 0xffff0000, v245
    v_mul_f32 v236, 0xbfb8aa3b, v236
    v_mul_f32 v237, 0xbfb8aa3b, v237
    v_mul_f32 v238, 0xbfb8aa3b, v238
    v_mul_f32 v239, 0xbfb8aa3b, v239
    v_exp_f32 v236, v236
    v_exp_f32 v237, v237
    v_exp_f32 v238, v238
    v_exp_f32 v239, v239
    s_nop 0
    v_add_f32 v236, 1.0, v236
    v_add_f32 v237, 1.0, v237
    v_add_f32 v238, 1.0, v238
    v_add_f32 v239, 1.0, v239
    v_rcp_f32 v236, v236
    v_rcp_f32 v237, v237
    v_rcp_f32 v238, v238
    v_rcp_f32 v239, v239
    s_nop 0
    v_cvt_pk_bf16_f32 v244, v236, v237
    v_cvt_pk_bf16_f32 v245, v238, v239
    v_lshlrev_b32 v236, 16, v244
    v_and_b32 v237, 0xffff0000, v244
    v_lshlrev_b32 v238, 16, v245
    v_and_b32 v239, 0xffff0000, v245
    v_mul_f32 v236, v236, v240
    v_mul_f32 v237, v237, v241
    v_mul_f32 v238, v238, v242
    v_mul_f32 v239, v239, v243
    v_cvt_pk_bf16_f32 v212, v236, v237
    v_cvt_pk_bf16_f32 v213, v238, v239
    v_mul_f32 v236, v140, v232
    v_mul_f32 v240, v172, v232
    v_mul_f32 v237, v141, v232
    v_mul_f32 v241, v173, v232
    v_mul_f32 v238, v142, v232
    v_mul_f32 v242, v174, v232
    v_mul_f32 v239, v143, v232
    v_mul_f32 v243, v175, v232
    v_cvt_pk_bf16_f32 v244, v236, v237
    v_cvt_pk_bf16_f32 v245, v238, v239
    v_lshlrev_b32 v236, 16, v244
    v_and_b32 v237, 0xffff0000, v244
    v_lshlrev_b32 v238, 16, v245
    v_and_b32 v239, 0xffff0000, v245
    v_cvt_pk_bf16_f32 v244, v240, v241
    v_cvt_pk_bf16_f32 v245, v242, v243
    v_lshlrev_b32 v240, 16, v244
    v_and_b32 v241, 0xffff0000, v244
    v_lshlrev_b32 v242, 16, v245
    v_and_b32 v243, 0xffff0000, v245
    v_mul_f32 v236, 0xbfb8aa3b, v236
    v_mul_f32 v237, 0xbfb8aa3b, v237
    v_mul_f32 v238, 0xbfb8aa3b, v238
    v_mul_f32 v239, 0xbfb8aa3b, v239
    v_exp_f32 v236, v236
    v_exp_f32 v237, v237
    v_exp_f32 v238, v238
    v_exp_f32 v239, v239
    s_nop 0
    v_add_f32 v236, 1.0, v236
    v_add_f32 v237, 1.0, v237
    v_add_f32 v238, 1.0, v238
    v_add_f32 v239, 1.0, v239
    v_rcp_f32 v236, v236
    v_rcp_f32 v237, v237
    v_rcp_f32 v238, v238
    v_rcp_f32 v239, v239
    s_nop 0
    v_cvt_pk_bf16_f32 v244, v236, v237
    v_cvt_pk_bf16_f32 v245, v238, v239
    v_lshlrev_b32 v236, 16, v244
    v_and_b32 v237, 0xffff0000, v244
    v_lshlrev_b32 v238, 16, v245
    v_and_b32 v239, 0xffff0000, v245
    v_mul_f32 v236, v236, v240
    v_mul_f32 v237, v237, v241
    v_mul_f32 v238, v238, v242
    v_mul_f32 v239, v239, v243
    v_cvt_pk_bf16_f32 v214, v236, v237
    v_cvt_pk_bf16_f32 v215, v238, v239
    s_nop 1
    v_permlane32_swap_b32 v208, v210
    v_permlane32_swap_b32 v209, v211
    v_permlane32_swap_b32 v212, v214
    v_permlane32_swap_b32 v213, v215
    s_nop 1
    buffer_store_dwordx4 v[208:211], v216, s[20:23], 0 offen offset:2048
    buffer_store_dwordx4 v[212:215], v216, s[20:23], 0 offen offset:3072
    s_nop 1
    s_waitcnt vmcnt(0)
k_glu_kernel_end:
    s_endpgm

.globl k_down1_kernel
.p2align 8
.type k_down1_kernel,@function
k_down1_kernel:
    s_cmp_ge_u32 s2, 224
    s_cbranch_scc1 k_down1_kernel_end
    s_load_dwordx2 s[28:29], s[0:1], 48
    s_load_dwordx2 s[30:31], s[0:1], 72
    v_and_b32 v128, 63, v0
    v_lshrrev_b32 v112, 6, v0
    s_and_b32 s37, s2, 7
    s_lshl_b32 s37, s37, 2
    v_readfirstlane_b32 s36, v112
    s_lshr_b32 s38, s2, 3
    s_and_b32 s42, s38, 3
    s_add_u32 s37, s37, s42
    s_lshr_b32 s38, s38, 2
    s_waitcnt lgkmcnt(0)
    s_add_u32 s8, s30, 0xa00000
    s_addc_u32 s9, s31, 0
    s_mov_b32 s10, 0x700000
    s_mov_b32 s11, 0x20000
    s_mov_b32 s12, s28
    s_mov_b32 s13, s29
    s_mov_b32 s14, 0x188000
    s_mov_b32 s15, 0x20000
    s_add_u32 s20, s30, 0x1200000
    s_addc_u32 s21, s31, 0
    s_mov_b32 s22, 0x1c0000
    s_mov_b32 s23, 0x20000
    s_add_u32 s24, s30, 0x800000
    s_addc_u32 s25, s31, 0
    s_mov_b32 s26, 0x1c0000
    s_mov_b32 s27, 0x20000
    s_lshl_b32 s48, s37, 1
    s_and_b32 s42, s36, 1
    s_add_u32 s48, s48, s42
    s_lshl_b32 s42, s48, 5
    v_and_b32 v136, 31, v128
    v_add_u32 v136, s42, v136
    s_mul_i32 s42, s48, 112
    s_lshr_b32 s49, s36, 1
    s_mul_i32 s41, s49, 56
    s_add_u32 s42, s42, s41
    s_lshl_b32 s42, s42, 10
    v_lshlrev_b32 v135, 4, v128
    v_add_u32 v135, s42, v135
    s_lshl_b32 s42, s36, 6
    v_add_u32 v131, s42, v128
    v_lshrrev_b32 v112, 3, v131
    v_and_b32 v113, 7, v131
    v_bfe_u32 v114, v112, 1, 1
    v_lshlrev_b32 v114, 2, v114
    v_xor_b32 v113, v113, v114
    v_mul_u32_u24 v131, 896, v112
    v_lshl_add_u32 v131, v113, 4, v131
    v_add_u32 v132, s42, v128
    v_add_u32 v132, 256, v132
    v_lshrrev_b32 v112, 3, v132
    v_and_b32 v113, 7, v132
    v_bfe_u32 v114, v112, 1, 1
    v_lshlrev_b32 v114, 2, v114
    v_xor_b32 v113, v113, v114
    v_mul_u32_u24 v132, 896, v112
    v_lshl_add_u32 v132, v113, 4, v132
    v_add_u32 v133, s42, v128
    v_lshrrev_b32 v112, 3, v133
    v_and_b32 v113, 7, v133
    v_bfe_u32 v114, v112, 1, 1
    v_lshlrev_b32 v114, 2, v114
    v_xor_b32 v113, v113, v114
    v_mul_u32_u24 v133, 896, v112
    v_lshl_add_u32 v133, v113, 4, v133
    v_add_u32 v133, 0xc4000, v133
    v_add_u32 v134, s42, v128
    v_add_u32 v134, 256, v134
    v_lshrrev_b32 v112, 3, v134
    v_and_b32 v113, 7, v134
    v_bfe_u32 v114, v112, 1, 1
    v_lshlrev_b32 v114, 2, v114
    v_xor_b32 v113, v113, v114
    v_mul_u32_u24 v134, 896, v112
    v_lshl_add_u32 v134, v113, 4, v134
    v_add_u32 v134, 0xc4000, v134
    s_lshl_b32 s43, s38, 6
    s_lshl_b32 s40, s43, 1
    s_lshl_b32 s39, s36, 10
    v_lshrrev_b32 v112, 5, v128
    v_lshlrev_b32 v112, 3, v112
    v_bfe_u32 v113, v128, 2, 2
    v_add_u32 v112, v112, v113
    v_mul_u32_u24 v129, 128, v112
    s_lshl_b32 s49, s49, 13
    v_add_u32 v129, s49, v129
    v_bfe_u32 v114, v128, 4, 1
    v_lshlrev_b32 v114, 5, v114
    v_and_b32 v115, 3, v128
    v_lshl_add_u32 v114, v115, 3, v114
    v_bfe_u32 v115, v128, 3, 1
    v_lshlrev_b32 v115, 6, v115
    v_add3_u32 v130, v129, v114, v115
    v_sub_u32 v115, v114, v115
    v_add_u32 v129, v129, v115
    s_add_u32 s42, s40, 0x0
    s_add_u32 m0, s39, 0
    buffer_load_dwordx4 v131, s[12:15], s42 offen lds
    s_add_u32 s42, s40, 0x0
    s_add_u32 m0, s39, 4096
    buffer_load_dwordx4 v132, s[12:15], s42 offen lds
    s_add_u32 s42, s40, 0x0
    s_add_u32 m0, s39, 8192
    buffer_load_dwordx4 v133, s[12:15], s42 offen lds
    s_add_u32 s42, s40, 0x0
    s_add_u32 m0, s39, 12288
    buffer_load_dwordx4 v134, s[12:15], s42 offen lds
    s_mov_b32 s41, 0x0
    buffer_load_dwordx4 v[32:35], v135, s[8:11], s41 offen offset:0
    s_mov_b32 s41, 0x0
    buffer_load_dwordx4 v[36:39], v135, s[8:11], s41 offen offset:1024
    s_mov_b32 s41, 0x0
    buffer_load_dwordx4 v[40:43], v135, s[8:11], s41 offen offset:2048
    s_mov_b32 s41, 0x0
    buffer_load_dwordx4 v[44:47], v135, s[8:11], s41 offen offset:3072
    s_add_u32 s42, s40, 0xe000
    s_add_u32 m0, s39, 16384
    buffer_load_dwordx4 v131, s[12:15], s42 offen lds
    s_add_u32 s42, s40, 0xe000
    s_add_u32 m0, s39, 20480
    buffer_load_dwordx4 v132, s[12:15], s42 offen lds
    s_add_u32 s42, s40, 0xe000
    s_add_u32 m0, s39, 24576
    buffer_load_dwordx4 v133, s[12:15], s42 offen lds
    s_add_u32 s42, s40, 0xe000
    s_add_u32 m0, s39, 28672
    buffer_load_dwordx4 v134, s[12:15], s42 offen lds
    s_mov_b32 s41, 0x1000
    buffer_load_dwordx4 v[48:51], v135, s[8:11], s41 offen offset:0
    s_mov_b32 s41, 0x1000
    buffer_load_dwordx4 v[52:55], v135, s[8:11], s41 offen offset:1024
    s_mov_b32 s41, 0x1000
    buffer_load_dwordx4 v[56:59], v135, s[8:11], s41 offen offset:2048
    s_mov_b32 s41, 0x1000
    buffer_load_dwordx4 v[60:63], v135, s[8:11], s41 offen offset:3072
    s_waitcnt vmcnt(12)
    s_barrier
    s_add_u32 s42, s40, 0x1c000
    s_add_u32 m0, s39, 32768
    buffer_load_dwordx4 v131, s[12:15], s42 offen lds
    s_add_u32 s42, s40, 0x1c000
    s_add_u32 m0, s39, 36864
    buffer_load_dwordx4 v132, s[12:15], s42 offen lds
    s_add_u32 s42, s40, 0x1c000
    s_add_u32 m0, s39, 40960
    buffer_load_dwordx4 v133, s[12:15], s42 offen lds
    s_add_u32 s42, s40, 0x1c000
    s_add_u32 m0, s39, 45056
    buffer_load_dwordx4 v134, s[12:15], s42 offen lds
    s_mov_b32 s41, 0x2000
    buffer_load_dwordx4 v[64:67], v135, s[8:11], s41 offen offset:0
    s_mov_b32 s41, 0x2000
    buffer_load_dwordx4 v[68:71], v135, s[8:11], s41 offen offset:1024
    s_mov_b32 s41, 0x2000
    buffer_load_dwordx4 v[72:75], v135, s[8:11], s41 offen offset:2048
    s_mov_b32 s41, 0x2000
    buffer_load_dwordx4 v[76:79], v135, s[8:11], s41 offen offset:3072
    ds_read_b64_tr_b16 v[96:97], v130 offset:0
    ds_read_b64_tr_b16 v[98:99], v130 offset:512
    ds_read_b64_tr_b16 v[100:101], v129 offset:64
    ds_read_b64_tr_b16 v[102:103], v129 offset:576
    ds_read_b64_tr_b16 v[104:105], v130 offset:2048
    ds_read_b64_tr_b16 v[106:107], v130 offset:2560
    ds_read_b64_tr_b16 v[108:109], v129 offset:2112
    ds_read_b64_tr_b16 v[110:111], v129 offset:2624
    s_waitcnt vmcnt(16)
    s_waitcnt lgkmcnt(4)
    v_mfma_f32_32x32x16_bf16 v[0:15], v[96:99], v[32:35], 0
    v_mfma_f32_32x32x16_bf16 v[16:31], v[100:103], v[32:35], 0
    ds_read_b64_tr_b16 v[96:97], v130 offset:4096
    ds_read_b64_tr_b16 v[98:99], v130 offset:4608
    ds_read_b64_tr_b16 v[100:101], v129 offset:4160
    ds_read_b64_tr_b16 v[102:103], v129 offset:4672
    s_waitcnt lgkmcnt(4)
    v_mfma_f32_32x32x16_bf16 v[0:15], v[104:107], v[36:39], v[0:15]
    v_mfma_f32_32x32x16_bf16 v[16:31], v[108:111], v[36:39], v[16:31]
    ds_read_b64_tr_b16 v[104:105], v130 offset:6144
    ds_read_b64_tr_b16 v[106:107], v130 offset:6656
    ds_read_b64_tr_b16 v[108:109], v129 offset:6208
    ds_read_b64_tr_b16 v[110:111], v129 offset:6720
    s_waitcnt lgkmcnt(4)
    v_mfma_f32_32x32x16_bf16 v[0:15], v[96:99], v[40:43], v[0:15]
    v_mfma_f32_32x32x16_bf16 v[16:31], v[100:103], v[40:43], v[16:31]
    s_waitcnt vmcnt(12)
    s_barrier
    s_add_u32 s42, s40, 0x2a000
    s_add_u32 m0, s39, 49152
    buffer_load_dwordx4 v131, s[12:15], s42 offen lds
    s_add_u32 s42, s40, 0x2a000
    s_add_u32 m0, s39, 53248
    buffer_load_dwordx4 v132, s[12:15], s42 offen lds
    s_add_u32 s42, s40, 0x2a000
    s_add_u32 m0, s39, 57344
    buffer_load_dwordx4 v133, s[12:15], s42 offen lds
    s_add_u32 s42, s40, 0x2a000
    s_add_u32 m0, s39, 61440
    buffer_load_dwordx4 v134, s[12:15], s42 offen lds
    s_mov_b32 s41, 0x3000
    buffer_load_dwordx4 v[80:83], v135, s[8:11], s41 offen offset:0
    s_mov_b32 s41, 0x3000
    buffer_load_dwordx4 v[84:87], v135, s[8:11], s41 offen offset:1024
    s_mov_b32 s41, 0x3000
    buffer_load_dwordx4 v[88:91], v135, s[8:11], s41 offen offset:2048
    s_mov_b32 s41, 0x3000
    buffer_load_dwordx4 v[92:95], v135, s[8:11], s41 offen offset:3072
    ds_read_b64_tr_b16 v[96:97], v130 offset:16384
    ds_read_b64_tr_b16 v[98:99], v130 offset:16896
    ds_read_b64_tr_b16 v[100:101], v129 offset:16448
    ds_read_b64_tr_b16 v[102:103], v129 offset:16960
    s_waitcnt lgkmcnt(4)
    v_mfma_f32_32x32x16_bf16 v[0:15], v[104:107], v[44:47], v[0:15]
    v_mfma_f32_32x32x16_bf16 v[16:31], v[108:111], v[44:47], v[16:31]
    ds_read_b64_tr_b16 v[104:105], v130 offset:18432
    ds_read_b64_tr_b16 v[106:107], v130 offset:18944
    ds_read_b64_tr_b16 v[108:109], v129 offset:18496
    ds_read_b64_tr_b16 v[110:111], v129 offset:19008
    s_waitcnt vmcnt(16)
    s_waitcnt lgkmcnt(4)
    v_mfma_f32_32x32x16_bf16 v[0:15], v[96:99], v[48:51], v[0:15]
    v_mfma_f32_32x32x16_bf16 v[16:31], v[100:103], v[48:51], v[16:31]
    ds_read_b64_tr_b16 v[96:97], v130 offset:20480
    ds_read_b64_tr_b16 v[98:99], v130 offset:20992
    ds_read_b64_tr_b16 v[100:101], v129 offset:20544
    ds_read_b64_tr_b16 v[102:103], v129 offset:21056
    s_waitcnt lgkmcnt(4)
    v_mfma_f32_32x32x16_bf16 v[0:15], v[104:107], v[52:55], v[0:15]
    v_mfma_f32_32x32x16_bf16 v[16:31], v[108:111], v[52:55], v[16:31]
    ds_read_b64_tr_b16 v[104:105], v130 offset:22528
    ds_read_b64_tr_b16 v[106:107], v130 offset:23040
    ds_read_b64_tr_b16 v[108:109], v129 offset:22592
    ds_read_b64_tr_b16 v[110:111], v129 offset:23104
    s_waitcnt lgkmcnt(4)
    v_mfma_f32_32x32x16_bf16 v[0:15], v[96:99], v[56:59], v[0:15]
    v_mfma_f32_32x32x16_bf16 v[16:31], v[100:103], v[56:59], v[16:31]
    s_waitcnt vmcnt(12)
    s_barrier
    s_add_u32 s42, s40, 0x38000
    s_add_u32 m0, s39, 0
    buffer_load_dwordx4 v131, s[12:15], s42 offen lds
    s_add_u32 s42, s40, 0x38000
    s_add_u32 m0, s39, 4096
    buffer_load_dwordx4 v132, s[12:15], s42 offen lds
    s_add_u32 s42, s40, 0x38000
    s_add_u32 m0, s39, 8192
    buffer_load_dwordx4 v133, s[12:15], s42 offen lds
    s_add_u32 s42, s40, 0x38000
    s_add_u32 m0, s39, 12288
    buffer_load_dwordx4 v134, s[12:15], s42 offen lds
    s_mov_b32 s41, 0x4000
    buffer_load_dwordx4 v[32:35], v135, s[8:11], s41 offen offset:0
    s_mov_b32 s41, 0x4000
    buffer_load_dwordx4 v[36:39], v135, s[8:11], s41 offen offset:1024
    s_mov_b32 s41, 0x4000
    buffer_load_dwordx4 v[40:43], v135, s[8:11], s41 offen offset:2048
    s_mov_b32 s41, 0x4000
    buffer_load_dwordx4 v[44:47], v135, s[8:11], s41 offen offset:3072
    ds_read_b64_tr_b16 v[96:97], v130 offset:32768
    ds_read_b64_tr_b16 v[98:99], v130 offset:33280
    ds_read_b64_tr_b16 v[100:101], v129 offset:32832
    ds_read_b64_tr_b16 v[102:103], v129 offset:33344
    s_waitcnt lgkmcnt(4)
    v_mfma_f32_32x32x16_bf16 v[0:15], v[104:107], v[60:63], v[0:15]
    v_mfma_f32_32x32x16_bf16 v[16:31], v[108:111], v[60:63], v[16:31]
    ds_read_b64_tr_b16 v[104:105], v130 offset:34816
    ds_read_b64_tr_b16 v[106:107], v130 offset:35328
    ds_read_b64_tr_b16 v[108:109], v129 offset:34880
    ds_read_b64_tr_b16 v[110:111], v129 offset:35392
    s_waitcnt vmcnt(16)
    s_waitcnt lgkmcnt(4)
    v_mfma_f32_32x32x16_bf16 v[0:15], v[96:99], v[64:67], v[0:15]
    v_mfma_f32_32x32x16_bf16 v[16:31], v[100:103], v[64:67], v[16:31]
    ds_read_b64_tr_b16 v[96:97], v130 offset:36864
    ds_read_b64_tr_b16 v[98:99], v130 offset:37376
    ds_read_b64_tr_b16 v[100:101], v129 offset:36928
    ds_read_b64_tr_b16 v[102:103], v129 offset:37440
    s_waitcnt lgkmcnt(4)
    v_mfma_f32_32x32x16_bf16 v[0:15], v[104:107], v[68:71], v[0:15]
    v_mfma_f32_32x32x16_bf16 v[16:31], v[108:111], v[68:71], v[16:31]
    ds_read_b64_tr_b16 v[104:105], v130 offset:38912
    ds_read_b64_tr_b16 v[106:107], v130 offset:39424
    ds_read_b64_tr_b16 v[108:109], v129 offset:38976
    ds_read_b64_tr_b16 v[110:111], v129 offset:39488
    s_waitcnt lgkmcnt(4)
    v_mfma_f32_32x32x16_bf16 v[0:15], v[96:99], v[72:75], v[0:15]
    v_mfma_f32_32x32x16_bf16 v[16:31], v[100:103], v[72:75], v[16:31]
    s_waitcnt vmcnt(12)
    s_barrier
    s_add_u32 s42, s40, 0x46000
    s_add_u32 m0, s39, 16384
    buffer_load_dwordx4 v131, s[12:15], s42 offen lds
    s_add_u32 s42, s40, 0x46000
    s_add_u32 m0, s39, 20480
    buffer_load_dwordx4 v132, s[12:15], s42 offen lds
    s_add_u32 s42, s40, 0x46000
    s_add_u32 m0, s39, 24576
    buffer_load_dwordx4 v133, s[12:15], s42 offen lds
    s_add_u32 s42, s40, 0x46000
    s_add_u32 m0, s39, 28672
    buffer_load_dwordx4 v134, s[12:15], s42 offen lds
    s_mov_b32 s41, 0x5000
    buffer_load_dwordx4 v[48:51], v135, s[8:11], s41 offen offset:0
    s_mov_b32 s41, 0x5000
    buffer_load_dwordx4 v[52:55], v135, s[8:11], s41 offen offset:1024
    s_mov_b32 s41, 0x5000
    buffer_load_dwordx4 v[56:59], v135, s[8:11], s41 offen offset:2048
    s_mov_b32 s41, 0x5000
    buffer_load_dwordx4 v[60:63], v135, s[8:11], s41 offen offset:3072
    ds_read_b64_tr_b16 v[96:97], v130 offset:49152
    ds_read_b64_tr_b16 v[98:99], v130 offset:49664
    ds_read_b64_tr_b16 v[100:101], v129 offset:49216
    ds_read_b64_tr_b16 v[102:103], v129 offset:49728
    s_waitcnt lgkmcnt(4)
    v_mfma_f32_32x32x16_bf16 v[0:15], v[104:107], v[76:79], v[0:15]
    v_mfma_f32_32x32x16_bf16 v[16:31], v[108:111], v[76:79], v[16:31]
    ds_read_b64_tr_b16 v[104:105], v130 offset:51200
    ds_read_b64_tr_b16 v[106:107], v130 offset:51712
    ds_read_b64_tr_b16 v[108:109], v129 offset:51264
    ds_read_b64_tr_b16 v[110:111], v129 offset:51776
    s_waitcnt vmcnt(16)
    s_waitcnt lgkmcnt(4)
    v_mfma_f32_32x32x16_bf16 v[0:15], v[96:99], v[80:83], v[0:15]
    v_mfma_f32_32x32x16_bf16 v[16:31], v[100:103], v[80:83], v[16:31]
    ds_read_b64_tr_b16 v[96:97], v130 offset:53248
    ds_read_b64_tr_b16 v[98:99], v130 offset:53760
    ds_read_b64_tr_b16 v[100:101], v129 offset:53312
    ds_read_b64_tr_b16 v[102:103], v129 offset:53824
    s_waitcnt lgkmcnt(4)
    v_mfma_f32_32x32x16_bf16 v[0:15], v[104:107], v[84:87], v[0:15]
    v_mfma_f32_32x32x16_bf16 v[16:31], v[108:111], v[84:87], v[16:31]
    ds_read_b64_tr_b16 v[104:105], v130 offset:55296
    ds_read_b64_tr_b16 v[106:107], v130 offset:55808
    ds_read_b64_tr_b16 v[108:109], v129 offset:55360
    ds_read_b64_tr_b16 v[110:111], v129 offset:55872
    s_waitcnt lgkmcnt(4)
    v_mfma_f32_32x32x16_bf16 v[0:15], v[96:99], v[88:91], v[0:15]
    v_mfma_f32_32x32x16_bf16 v[16:31], v[100:103], v[88:91], v[16:31]
    s_waitcnt vmcnt(12)
    s_barrier
    s_add_u32 s42, s40, 0x54000
    s_add_u32 m0, s39, 32768
    buffer_load_dwordx4 v131, s[12:15], s42 offen lds
    s_add_u32 s42, s40, 0x54000
    s_add_u32 m0, s39, 36864
    buffer_load_dwordx4 v132, s[12:15], s42 offen lds
    s_add_u32 s42, s40, 0x54000
    s_add_u32 m0, s39, 40960
    buffer_load_dwordx4 v133, s[12:15], s42 offen lds
    s_add_u32 s42, s40, 0x54000
    s_add_u32 m0, s39, 45056
    buffer_load_dwordx4 v134, s[12:15], s42 offen lds
    s_mov_b32 s41, 0x6000
    buffer_load_dwordx4 v[64:67], v135, s[8:11], s41 offen offset:0
    s_mov_b32 s41, 0x6000
    buffer_load_dwordx4 v[68:71], v135, s[8:11], s41 offen offset:1024
    s_mov_b32 s41, 0x6000
    buffer_load_dwordx4 v[72:75], v135, s[8:11], s41 offen offset:2048
    s_mov_b32 s41, 0x6000
    buffer_load_dwordx4 v[76:79], v135, s[8:11], s41 offen offset:3072
    ds_read_b64_tr_b16 v[96:97], v130 offset:0
    ds_read_b64_tr_b16 v[98:99], v130 offset:512
    ds_read_b64_tr_b16 v[100:101], v129 offset:64
    ds_read_b64_tr_b16 v[102:103], v129 offset:576
    s_waitcnt lgkmcnt(4)
    v_mfma_f32_32x32x16_bf16 v[0:15], v[104:107], v[92:95], v[0:15]
    v_mfma_f32_32x32x16_bf16 v[16:31], v[108:111], v[92:95], v[16:31]
    ds_read_b64_tr_b16 v[104:105], v130 offset:2048
    ds_read_b64_tr_b16 v[106:107], v130 offset:2560
    ds_read_b64_tr_b16 v[108:109], v129 offset:2112
    ds_read_b64_tr_b16 v[110:111], v129 offset:2624
    s_waitcnt vmcnt(16)
    s_waitcnt lgkmcnt(4)
    v_mfma_f32_32x32x16_bf16 v[0:15], v[96:99], v[32:35], v[0:15]
    v_mfma_f32_32x32x16_bf16 v[16:31], v[100:103], v[32:35], v[16:31]
    ds_read_b64_tr_b16 v[96:97], v130 offset:4096
    ds_read_b64_tr_b16 v[98:99], v130 offset:4608
    ds_read_b64_tr_b16 v[100:101], v129 offset:4160
    ds_read_b64_tr_b16 v[102:103], v129 offset:4672
    s_waitcnt lgkmcnt(4)
    v_mfma_f32_32x32x16_bf16 v[0:15], v[104:107], v[36:39], v[0:15]
    v_mfma_f32_32x32x16_bf16 v[16:31], v[108:111], v[36:39], v[16:31]
    ds_read_b64_tr_b16 v[104:105], v130 offset:6144
    ds_read_b64_tr_b16 v[106:107], v130 offset:6656
    ds_read_b64_tr_b16 v[108:109], v129 offset:6208
    ds_read_b64_tr_b16 v[110:111], v129 offset:6720
    s_waitcnt lgkmcnt(4)
    v_mfma_f32_32x32x16_bf16 v[0:15], v[96:99], v[40:43], v[0:15]
    v_mfma_f32_32x32x16_bf16 v[16:31], v[100:103], v[40:43], v[16:31]
    s_waitcnt vmcnt(12)
    s_barrier
    s_add_u32 s42, s40, 0x62000
    s_add_u32 m0, s39, 49152
    buffer_load_dwordx4 v131, s[12:15], s42 offen lds
    s_add_u32 s42, s40, 0x62000
    s_add_u32 m0, s39, 53248
    buffer_load_dwordx4 v132, s[12:15], s42 offen lds
    s_add_u32 s42, s40, 0x62000
    s_add_u32 m0, s39, 57344
    buffer_load_dwordx4 v133, s[12:15], s42 offen lds
    s_add_u32 s42, s40, 0x62000
    s_add_u32 m0, s39, 61440
    buffer_load_dwordx4 v134, s[12:15], s42 offen lds
    s_mov_b32 s41, 0x7000
    buffer_load_dwordx4 v[80:83], v135, s[8:11], s41 offen offset:0
    s_mov_b32 s41, 0x7000
    buffer_load_dwordx4 v[84:87], v135, s[8:11], s41 offen offset:1024
    s_mov_b32 s41, 0x7000
    buffer_load_dwordx4 v[88:91], v135, s[8:11], s41 offen offset:2048
    s_mov_b32 s41, 0x7000
    buffer_load_dwordx4 v[92:95], v135, s[8:11], s41 offen offset:3072
    ds_read_b64_tr_b16 v[96:97], v130 offset:16384
    ds_read_b64_tr_b16 v[98:99], v130 offset:16896
    ds_read_b64_tr_b16 v[100:101], v129 offset:16448
    ds_read_b64_tr_b16 v[102:103], v129 offset:16960
    s_waitcnt lgkmcnt(4)
    v_mfma_f32_32x32x16_bf16 v[0:15], v[104:107], v[44:47], v[0:15]
    v_mfma_f32_32x32x16_bf16 v[16:31], v[108:111], v[44:47], v[16:31]
    ds_read_b64_tr_b16 v[104:105], v130 offset:18432
    ds_read_b64_tr_b16 v[106:107], v130 offset:18944
    ds_read_b64_tr_b16 v[108:109], v129 offset:18496
    ds_read_b64_tr_b16 v[110:111], v129 offset:19008
    s_waitcnt vmcnt(16)
    s_waitcnt lgkmcnt(4)
    v_mfma_f32_32x32x16_bf16 v[0:15], v[96:99], v[48:51], v[0:15]
    v_mfma_f32_32x32x16_bf16 v[16:31], v[100:103], v[48:51], v[16:31]
    ds_read_b64_tr_b16 v[96:97], v130 offset:20480
    ds_read_b64_tr_b16 v[98:99], v130 offset:20992
    ds_read_b64_tr_b16 v[100:101], v129 offset:20544
    ds_read_b64_tr_b16 v[102:103], v129 offset:21056
    s_waitcnt lgkmcnt(4)
    v_mfma_f32_32x32x16_bf16 v[0:15], v[104:107], v[52:55], v[0:15]
    v_mfma_f32_32x32x16_bf16 v[16:31], v[108:111], v[52:55], v[16:31]
    ds_read_b64_tr_b16 v[104:105], v130 offset:22528
    ds_read_b64_tr_b16 v[106:107], v130 offset:23040
    ds_read_b64_tr_b16 v[108:109], v129 offset:22592
    ds_read_b64_tr_b16 v[110:111], v129 offset:23104
    s_waitcnt lgkmcnt(4)
    v_mfma_f32_32x32x16_bf16 v[0:15], v[96:99], v[56:59], v[0:15]
    v_mfma_f32_32x32x16_bf16 v[16:31], v[100:103], v[56:59], v[16:31]
    s_waitcnt vmcnt(12)
    s_barrier
    s_add_u32 s42, s40, 0x70000
    s_add_u32 m0, s39, 0
    buffer_load_dwordx4 v131, s[12:15], s42 offen lds
    s_add_u32 s42, s40, 0x70000
    s_add_u32 m0, s39, 4096
    buffer_load_dwordx4 v132, s[12:15], s42 offen lds
    s_add_u32 s42, s40, 0x70000
    s_add_u32 m0, s39, 8192
    buffer_load_dwordx4 v133, s[12:15], s42 offen lds
    s_add_u32 s42, s40, 0x70000
    s_add_u32 m0, s39, 12288
    buffer_load_dwordx4 v134, s[12:15], s42 offen lds
    s_mov_b32 s41, 0x8000
    buffer_load_dwordx4 v[32:35], v135, s[8:11], s41 offen offset:0
    s_mov_b32 s41, 0x8000
    buffer_load_dwordx4 v[36:39], v135, s[8:11], s41 offen offset:1024
    s_mov_b32 s41, 0x8000
    buffer_load_dwordx4 v[40:43], v135, s[8:11], s41 offen offset:2048
    s_mov_b32 s41, 0x8000
    buffer_load_dwordx4 v[44:47], v135, s[8:11], s41 offen offset:3072
    ds_read_b64_tr_b16 v[96:97], v130 offset:32768
    ds_read_b64_tr_b16 v[98:99], v130 offset:33280
    ds_read_b64_tr_b16 v[100:101], v129 offset:32832
    ds_read_b64_tr_b16 v[102:103], v129 offset:33344
    s_waitcnt lgkmcnt(4)
    v_mfma_f32_32x32x16_bf16 v[0:15], v[104:107], v[60:63], v[0:15]
    v_mfma_f32_32x32x16_bf16 v[16:31], v[108:111], v[60:63], v[16:31]
    ds_read_b64_tr_b16 v[104:105], v130 offset:34816
    ds_read_b64_tr_b16 v[106:107], v130 offset:35328
    ds_read_b64_tr_b16 v[108:109], v129 offset:34880
    ds_read_b64_tr_b16 v[110:111], v129 offset:35392
    s_waitcnt vmcnt(16)
    s_waitcnt lgkmcnt(4)
    v_mfma_f32_32x32x16_bf16 v[0:15], v[96:99], v[64:67], v[0:15]
    v_mfma_f32_32x32x16_bf16 v[16:31], v[100:103], v[64:67], v[16:31]
    ds_read_b64_tr_b16 v[96:97], v130 offset:36864
    ds_read_b64_tr_b16 v[98:99], v130 offset:37376
    ds_read_b64_tr_b16 v[100:101], v129 offset:36928
    ds_read_b64_tr_b16 v[102:103], v129 offset:37440
    s_waitcnt lgkmcnt(4)
    v_mfma_f32_32x32x16_bf16 v[0:15], v[104:107], v[68:71], v[0:15]
    v_mfma_f32_32x32x16_bf16 v[16:31], v[108:111], v[68:71], v[16:31]
    ds_read_b64_tr_b16 v[104:105], v130 offset:38912
    ds_read_b64_tr_b16 v[106:107], v130 offset:39424
    ds_read_b64_tr_b16 v[108:109], v129 offset:38976
    ds_read_b64_tr_b16 v[110:111], v129 offset:39488
    s_waitcnt lgkmcnt(4)
    v_mfma_f32_32x32x16_bf16 v[0:15], v[96:99], v[72:75], v[0:15]
    v_mfma_f32_32x32x16_bf16 v[16:31], v[100:103], v[72:75], v[16:31]
    s_waitcnt vmcnt(12)
    s_barrier
    s_add_u32 s42, s40, 0x7e000
    s_add_u32 m0, s39, 16384
    buffer_load_dwordx4 v131, s[12:15], s42 offen lds
    s_add_u32 s42, s40, 0x7e000
    s_add_u32 m0, s39, 20480
    buffer_load_dwordx4 v132, s[12:15], s42 offen lds
    s_add_u32 s42, s40, 0x7e000
    s_add_u32 m0, s39, 24576
    buffer_load_dwordx4 v133, s[12:15], s42 offen lds
    s_add_u32 s42, s40, 0x7e000
    s_add_u32 m0, s39, 28672
    buffer_load_dwordx4 v134, s[12:15], s42 offen lds
    s_mov_b32 s41, 0x9000
    buffer_load_dwordx4 v[48:51], v135, s[8:11], s41 offen offset:0
    s_mov_b32 s41, 0x9000
    buffer_load_dwordx4 v[52:55], v135, s[8:11], s41 offen offset:1024
    s_mov_b32 s41, 0x9000
    buffer_load_dwordx4 v[56:59], v135, s[8:11], s41 offen offset:2048
    s_mov_b32 s41, 0x9000
    buffer_load_dwordx4 v[60:63], v135, s[8:11], s41 offen offset:3072
    ds_read_b64_tr_b16 v[96:97], v130 offset:49152
    ds_read_b64_tr_b16 v[98:99], v130 offset:49664
    ds_read_b64_tr_b16 v[100:101], v129 offset:49216
    ds_read_b64_tr_b16 v[102:103], v129 offset:49728
    s_waitcnt lgkmcnt(4)
    v_mfma_f32_32x32x16_bf16 v[0:15], v[104:107], v[76:79], v[0:15]
    v_mfma_f32_32x32x16_bf16 v[16:31], v[108:111], v[76:79], v[16:31]
    ds_read_b64_tr_b16 v[104:105], v130 offset:51200
    ds_read_b64_tr_b16 v[106:107], v130 offset:51712
    ds_read_b64_tr_b16 v[108:109], v129 offset:51264
    ds_read_b64_tr_b16 v[110:111], v129 offset:51776
    s_waitcnt vmcnt(16)
    s_waitcnt lgkmcnt(4)
    v_mfma_f32_32x32x16_bf16 v[0:15], v[96:99], v[80:83], v[0:15]
    v_mfma_f32_32x32x16_bf16 v[16:31], v[100:103], v[80:83], v[16:31]
    ds_read_b64_tr_b16 v[96:97], v130 offset:53248
    ds_read_b64_tr_b16 v[98:99], v130 offset:53760
    ds_read_b64_tr_b16 v[100:101], v129 offset:53312
    ds_read_b64_tr_b16 v[102:103], v129 offset:53824
    s_waitcnt lgkmcnt(4)
    v_mfma_f32_32x32x16_bf16 v[0:15], v[104:107], v[84:87], v[0:15]
    v_mfma_f32_32x32x16_bf16 v[16:31], v[108:111], v[84:87], v[16:31]
    ds_read_b64_tr_b16 v[104:105], v130 offset:55296
    ds_read_b64_tr_b16 v[106:107], v130 offset:55808
    ds_read_b64_tr_b16 v[108:109], v129 offset:55360
    ds_read_b64_tr_b16 v[110:111], v129 offset:55872
    s_waitcnt lgkmcnt(4)
    v_mfma_f32_32x32x16_bf16 v[0:15], v[96:99], v[88:91], v[0:15]
    v_mfma_f32_32x32x16_bf16 v[16:31], v[100:103], v[88:91], v[16:31]
    s_waitcnt vmcnt(12)
    s_barrier
    s_add_u32 s42, s40, 0x8c000
    s_add_u32 m0, s39, 32768
    buffer_load_dwordx4 v131, s[12:15], s42 offen lds
    s_add_u32 s42, s40, 0x8c000
    s_add_u32 m0, s39, 36864
    buffer_load_dwordx4 v132, s[12:15], s42 offen lds
    s_add_u32 s42, s40, 0x8c000
    s_add_u32 m0, s39, 40960
    buffer_load_dwordx4 v133, s[12:15], s42 offen lds
    s_add_u32 s42, s40, 0x8c000
    s_add_u32 m0, s39, 45056
    buffer_load_dwordx4 v134, s[12:15], s42 offen lds
    s_mov_b32 s41, 0xa000
    buffer_load_dwordx4 v[64:67], v135, s[8:11], s41 offen offset:0
    s_mov_b32 s41, 0xa000
    buffer_load_dwordx4 v[68:71], v135, s[8:11], s41 offen offset:1024
    s_mov_b32 s41, 0xa000
    buffer_load_dwordx4 v[72:75], v135, s[8:11], s41 offen offset:2048
    s_mov_b32 s41, 0xa000
    buffer_load_dwordx4 v[76:79], v135, s[8:11], s41 offen offset:3072
    ds_read_b64_tr_b16 v[96:97], v130 offset:0
    ds_read_b64_tr_b16 v[98:99], v130 offset:512
    ds_read_b64_tr_b16 v[100:101], v129 offset:64
    ds_read_b64_tr_b16 v[102:103], v129 offset:576
    s_waitcnt lgkmcnt(4)
    v_mfma_f32_32x32x16_bf16 v[0:15], v[104:107], v[92:95], v[0:15]
    v_mfma_f32_32x32x16_bf16 v[16:31], v[108:111], v[92:95], v[16:31]
    ds_read_b64_tr_b16 v[104:105], v130 offset:2048
    ds_read_b64_tr_b16 v[106:107], v130 offset:2560
    ds_read_b64_tr_b16 v[108:109], v129 offset:2112
    ds_read_b64_tr_b16 v[110:111], v129 offset:2624
    s_waitcnt vmcnt(16)
    s_waitcnt lgkmcnt(4)
    v_mfma_f32_32x32x16_bf16 v[0:15], v[96:99], v[32:35], v[0:15]
    v_mfma_f32_32x32x16_bf16 v[16:31], v[100:103], v[32:35], v[16:31]
    ds_read_b64_tr_b16 v[96:97], v130 offset:4096
    ds_read_b64_tr_b16 v[98:99], v130 offset:4608
    ds_read_b64_tr_b16 v[100:101], v129 offset:4160
    ds_read_b64_tr_b16 v[102:103], v129 offset:4672
    s_waitcnt lgkmcnt(4)
    v_mfma_f32_32x32x16_bf16 v[0:15], v[104:107], v[36:39], v[0:15]
    v_mfma_f32_32x32x16_bf16 v[16:31], v[108:111], v[36:39], v[16:31]
    ds_read_b64_tr_b16 v[104:105], v130 offset:6144
    ds_read_b64_tr_b16 v[106:107], v130 offset:6656
    ds_read_b64_tr_b16 v[108:109], v129 offset:6208
    ds_read_b64_tr_b16 v[110:111], v129 offset:6720
    s_waitcnt lgkmcnt(4)
    v_mfma_f32_32x32x16_bf16 v[0:15], v[96:99], v[40:43], v[0:15]
    v_mfma_f32_32x32x16_bf16 v[16:31], v[100:103], v[40:43], v[16:31]
    s_waitcnt vmcnt(12)
    s_barrier
    s_add_u32 s42, s40, 0x9a000
    s_add_u32 m0, s39, 49152
    buffer_load_dwordx4 v131, s[12:15], s42 offen lds
    s_add_u32 s42, s40, 0x9a000
    s_add_u32 m0, s39, 53248
    buffer_load_dwordx4 v132, s[12:15], s42 offen lds
    s_add_u32 s42, s40, 0x9a000
    s_add_u32 m0, s39, 57344
    buffer_load_dwordx4 v133, s[12:15], s42 offen lds
    s_add_u32 s42, s40, 0x9a000
    s_add_u32 m0, s39, 61440
    buffer_load_dwordx4 v134, s[12:15], s42 offen lds
    s_mov_b32 s41, 0xb000
    buffer_load_dwordx4 v[80:83], v135, s[8:11], s41 offen offset:0
    s_mov_b32 s41, 0xb000
    buffer_load_dwordx4 v[84:87], v135, s[8:11], s41 offen offset:1024
    s_mov_b32 s41, 0xb000
    buffer_load_dwordx4 v[88:91], v135, s[8:11], s41 offen offset:2048
    s_mov_b32 s41, 0xb000
    buffer_load_dwordx4 v[92:95], v135, s[8:11], s41 offen offset:3072
    ds_read_b64_tr_b16 v[96:97], v130 offset:16384
    ds_read_b64_tr_b16 v[98:99], v130 offset:16896
    ds_read_b64_tr_b16 v[100:101], v129 offset:16448
    ds_read_b64_tr_b16 v[102:103], v129 offset:16960
    s_waitcnt lgkmcnt(4)
    v_mfma_f32_32x32x16_bf16 v[0:15], v[104:107], v[44:47], v[0:15]
    v_mfma_f32_32x32x16_bf16 v[16:31], v[108:111], v[44:47], v[16:31]
    ds_read_b64_tr_b16 v[104:105], v130 offset:18432
    ds_read_b64_tr_b16 v[106:107], v130 offset:18944
    ds_read_b64_tr_b16 v[108:109], v129 offset:18496
    ds_read_b64_tr_b16 v[110:111], v129 offset:19008
    s_waitcnt vmcnt(16)
    s_waitcnt lgkmcnt(4)
    v_mfma_f32_32x32x16_bf16 v[0:15], v[96:99], v[48:51], v[0:15]
    v_mfma_f32_32x32x16_bf16 v[16:31], v[100:103], v[48:51], v[16:31]
    ds_read_b64_tr_b16 v[96:97], v130 offset:20480
    ds_read_b64_tr_b16 v[98:99], v130 offset:20992
    ds_read_b64_tr_b16 v[100:101], v129 offset:20544
    ds_read_b64_tr_b16 v[102:103], v129 offset:21056
    s_waitcnt lgkmcnt(4)
    v_mfma_f32_32x32x16_bf16 v[0:15], v[104:107], v[52:55], v[0:15]
    v_mfma_f32_32x32x16_bf16 v[16:31], v[108:111], v[52:55], v[16:31]
    ds_read_b64_tr_b16 v[104:105], v130 offset:22528
    ds_read_b64_tr_b16 v[106:107], v130 offset:23040
    ds_read_b64_tr_b16 v[108:109], v129 offset:22592
    ds_read_b64_tr_b16 v[110:111], v129 offset:23104
    s_waitcnt lgkmcnt(4)
    v_mfma_f32_32x32x16_bf16 v[0:15], v[96:99], v[56:59], v[0:15]
    v_mfma_f32_32x32x16_bf16 v[16:31], v[100:103], v[56:59], v[16:31]
    s_waitcnt vmcnt(12)
    s_barrier
    s_add_u32 s42, s40, 0xa8000
    s_add_u32 m0, s39, 0
    buffer_load_dwordx4 v131, s[12:15], s42 offen lds
    s_add_u32 s42, s40, 0xa8000
    s_add_u32 m0, s39, 4096
    buffer_load_dwordx4 v132, s[12:15], s42 offen lds
    s_add_u32 s42, s40, 0xa8000
    s_add_u32 m0, s39, 8192
    buffer_load_dwordx4 v133, s[12:15], s42 offen lds
    s_add_u32 s42, s40, 0xa8000
    s_add_u32 m0, s39, 12288
    buffer_load_dwordx4 v134, s[12:15], s42 offen lds
    s_mov_b32 s41, 0xc000
    buffer_load_dwordx4 v[32:35], v135, s[8:11], s41 offen offset:0
    s_mov_b32 s41, 0xc000
    buffer_load_dwordx4 v[36:39], v135, s[8:11], s41 offen offset:1024
    s_mov_b32 s41, 0xc000
    buffer_load_dwordx4 v[40:43], v135, s[8:11], s41 offen offset:2048
    s_mov_b32 s41, 0xc000
    buffer_load_dwordx4 v[44:47], v135, s[8:11], s41 offen offset:3072
    ds_read_b64_tr_b16 v[96:97], v130 offset:32768
    ds_read_b64_tr_b16 v[98:99], v130 offset:33280
    ds_read_b64_tr_b16 v[100:101], v129 offset:32832
    ds_read_b64_tr_b16 v[102:103], v129 offset:33344
    s_waitcnt lgkmcnt(4)
    v_mfma_f32_32x32x16_bf16 v[0:15], v[104:107], v[60:63], v[0:15]
    v_mfma_f32_32x32x16_bf16 v[16:31], v[108:111], v[60:63], v[16:31]
    ds_read_b64_tr_b16 v[104:105], v130 offset:34816
    ds_read_b64_tr_b16 v[106:107], v130 offset:35328
    ds_read_b64_tr_b16 v[108:109], v129 offset:34880
    ds_read_b64_tr_b16 v[110:111], v129 offset:35392
    s_waitcnt vmcnt(16)
    s_waitcnt lgkmcnt(4)
    v_mfma_f32_32x32x16_bf16 v[0:15], v[96:99], v[64:67], v[0:15]
    v_mfma_f32_32x32x16_bf16 v[16:31], v[100:103], v[64:67], v[16:31]
    ds_read_b64_tr_b16 v[96:97], v130 offset:36864
    ds_read_b64_tr_b16 v[98:99], v130 offset:37376
    ds_read_b64_tr_b16 v[100:101], v129 offset:36928
    ds_read_b64_tr_b16 v[102:103], v129 offset:37440
    s_waitcnt lgkmcnt(4)
    v_mfma_f32_32x32x16_bf16 v[0:15], v[104:107], v[68:71], v[0:15]
    v_mfma_f32_32x32x16_bf16 v[16:31], v[108:111], v[68:71], v[16:31]
    ds_read_b64_tr_b16 v[104:105], v130 offset:38912
    ds_read_b64_tr_b16 v[106:107], v130 offset:39424
    ds_read_b64_tr_b16 v[108:109], v129 offset:38976
    ds_read_b64_tr_b16 v[110:111], v129 offset:39488
    s_waitcnt lgkmcnt(4)
    v_mfma_f32_32x32x16_bf16 v[0:15], v[96:99], v[72:75], v[0:15]
    v_mfma_f32_32x32x16_bf16 v[16:31], v[100:103], v[72:75], v[16:31]
    s_waitcnt vmcnt(12)
    s_barrier
    s_add_u32 s42, s40, 0xb6000
    s_add_u32 m0, s39, 16384
    buffer_load_dwordx4 v131, s[12:15], s42 offen lds
    s_add_u32 s42, s40, 0xb6000
    s_add_u32 m0, s39, 20480
    buffer_load_dwordx4 v132, s[12:15], s42 offen lds
    s_add_u32 s42, s40, 0xb6000
    s_add_u32 m0, s39, 24576
    buffer_load_dwordx4 v133, s[12:15], s42 offen lds
    s_add_u32 s42, s40, 0xb6000
    s_add_u32 m0, s39, 28672
    buffer_load_dwordx4 v134, s[12:15], s42 offen lds
    s_mov_b32 s41, 0xd000
    buffer_load_dwordx4 v[48:51], v135, s[8:11], s41 offen offset:0
    s_mov_b32 s41, 0xd000
    buffer_load_dwordx4 v[52:55], v135, s[8:11], s41 offen offset:1024
    s_mov_b32 s41, 0xd000
    buffer_load_dwordx4 v[56:59], v135, s[8:11], s41 offen offset:2048
    s_mov_b32 s41, 0xd000
    buffer_load_dwordx4 v[60:63], v135, s[8:11], s41 offen offset:3072
    ds_read_b64_tr_b16 v[96:97], v130 offset:49152
    ds_read_b64_tr_b16 v[98:99], v130 offset:49664
    ds_read_b64_tr_b16 v[100:101], v129 offset:49216
    ds_read_b64_tr_b16 v[102:103], v129 offset:49728
    s_waitcnt lgkmcnt(4)
    v_mfma_f32_32x32x16_bf16 v[0:15], v[104:107], v[76:79], v[0:15]
    v_mfma_f32_32x32x16_bf16 v[16:31], v[108:111], v[76:79], v[16:31]
    ds_read_b64_tr_b16 v[104:105], v130 offset:51200
    ds_read_b64_tr_b16 v[106:107], v130 offset:51712
    ds_read_b64_tr_b16 v[108:109], v129 offset:51264
    ds_read_b64_tr_b16 v[110:111], v129 offset:51776
    s_waitcnt vmcnt(16)
    s_waitcnt lgkmcnt(4)
    v_mfma_f32_32x32x16_bf16 v[0:15], v[96:99], v[80:83], v[0:15]
    v_mfma_f32_32x32x16_bf16 v[16:31], v[100:103], v[80:83], v[16:31]
    ds_read_b64_tr_b16 v[96:97], v130 offset:53248
    ds_read_b64_tr_b16 v[98:99], v130 offset:53760
    ds_read_b64_tr_b16 v[100:101], v129 offset:53312
    ds_read_b64_tr_b16 v[102:103], v129 offset:53824
    s_waitcnt lgkmcnt(4)
    v_mfma_f32_32x32x16_bf16 v[0:15], v[104:107], v[84:87], v[0:15]
    v_mfma_f32_32x32x16_bf16 v[16:31], v[108:111], v[84:87], v[16:31]
    ds_read_b64_tr_b16 v[104:105], v130 offset:55296
    ds_read_b64_tr_b16 v[106:107], v130 offset:55808
    ds_read_b64_tr_b16 v[108:109], v129 offset:55360
    ds_read_b64_tr_b16 v[110:111], v129 offset:55872
    s_waitcnt lgkmcnt(4)
    v_mfma_f32_32x32x16_bf16 v[0:15], v[96:99], v[88:91], v[0:15]
    v_mfma_f32_32x32x16_bf16 v[16:31], v[100:103], v[88:91], v[16:31]
    s_waitcnt vmcnt(12)
    s_barrier
    ds_read_b64_tr_b16 v[96:97], v130 offset:0
    ds_read_b64_tr_b16 v[98:99], v130 offset:512
    ds_read_b64_tr_b16 v[100:101], v129 offset:64
    ds_read_b64_tr_b16 v[102:103], v129 offset:576
    s_waitcnt lgkmcnt(4)
    v_mfma_f32_32x32x16_bf16 v[0:15], v[104:107], v[92:95], v[0:15]
    v_mfma_f32_32x32x16_bf16 v[16:31], v[108:111], v[92:95], v[16:31]
    ds_read_b64_tr_b16 v[104:105], v130 offset:2048
    ds_read_b64_tr_b16 v[106:107], v130 offset:2560
    ds_read_b64_tr_b16 v[108:109], v129 offset:2112
    ds_read_b64_tr_b16 v[110:111], v129 offset:2624
    s_waitcnt vmcnt(8)
    s_waitcnt lgkmcnt(4)
    v_mfma_f32_32x32x16_bf16 v[0:15], v[96:99], v[32:35], v[0:15]
    v_mfma_f32_32x32x16_bf16 v[16:31], v[100:103], v[32:35], v[16:31]
    ds_read_b64_tr_b16 v[96:97], v130 offset:4096
    ds_read_b64_tr_b16 v[98:99], v130 offset:4608
    ds_read_b64_tr_b16 v[100:101], v129 offset:4160
    ds_read_b64_tr_b16 v[102:103], v129 offset:4672
    s_waitcnt lgkmcnt(4)
    v_mfma_f32_32x32x16_bf16 v[0:15], v[104:107], v[36:39], v[0:15]
    v_mfma_f32_32x32x16_bf16 v[16:31], v[108:111], v[36:39], v[16:31]
    ds_read_b64_tr_b16 v[104:105], v130 offset:6144
    ds_read_b64_tr_b16 v[106:107], v130 offset:6656
    ds_read_b64_tr_b16 v[108:109], v129 offset:6208
    ds_read_b64_tr_b16 v[110:111], v129 offset:6720
    s_waitcnt lgkmcnt(4)
    v_mfma_f32_32x32x16_bf16 v[0:15], v[96:99], v[40:43], v[0:15]
    v_mfma_f32_32x32x16_bf16 v[16:31], v[100:103], v[40:43], v[16:31]
    s_waitcnt vmcnt(4)
    s_barrier
    ds_read_b64_tr_b16 v[96:97], v130 offset:16384
    ds_read_b64_tr_b16 v[98:99], v130 offset:16896
    ds_read_b64_tr_b16 v[100:101], v129 offset:16448
    ds_read_b64_tr_b16 v[102:103], v129 offset:16960
    s_waitcnt lgkmcnt(4)
    v_mfma_f32_32x32x16_bf16 v[0:15], v[104:107], v[44:47], v[0:15]
    v_mfma_f32_32x32x16_bf16 v[16:31], v[108:111], v[44:47], v[16:31]
    ds_read_b64_tr_b16 v[104:105], v130 offset:18432
    ds_read_b64_tr_b16 v[106:107], v130 offset:18944
    ds_read_b64_tr_b16 v[108:109], v129 offset:18496
    ds_read_b64_tr_b16 v[110:111], v129 offset:19008
    s_waitcnt vmcnt(0)
    s_waitcnt lgkmcnt(4)
    v_mfma_f32_32x32x16_bf16 v[0:15], v[96:99], v[48:51], v[0:15]
    v_mfma_f32_32x32x16_bf16 v[16:31], v[100:103], v[48:51], v[16:31]
    ds_read_b64_tr_b16 v[96:97], v130 offset:20480
    ds_read_b64_tr_b16 v[98:99], v130 offset:20992
    ds_read_b64_tr_b16 v[100:101], v129 offset:20544
    ds_read_b64_tr_b16 v[102:103], v129 offset:21056
    s_waitcnt lgkmcnt(4)
    v_mfma_f32_32x32x16_bf16 v[0:15], v[104:107], v[52:55], v[0:15]
    v_mfma_f32_32x32x16_bf16 v[16:31], v[108:111], v[52:55], v[16:31]
    ds_read_b64_tr_b16 v[104:105], v130 offset:22528
    ds_read_b64_tr_b16 v[106:107], v130 offset:23040
    ds_read_b64_tr_b16 v[108:109], v129 offset:22592
    ds_read_b64_tr_b16 v[110:111], v129 offset:23104
    s_waitcnt lgkmcnt(4)
    v_mfma_f32_32x32x16_bf16 v[0:15], v[96:99], v[56:59], v[0:15]
    v_mfma_f32_32x32x16_bf16 v[16:31], v[100:103], v[56:59], v[16:31]
    s_waitcnt lgkmcnt(0)
    v_mfma_f32_32x32x16_bf16 v[0:15], v[104:107], v[60:63], v[0:15]
    v_mfma_f32_32x32x16_bf16 v[16:31], v[108:111], v[60:63], v[16:31]
    s_nop 15
    s_nop 3
    s_barrier
    s_and_b32 s42, s36, 1
    s_lshl_b32 s42, s42, 13
    v_lshlrev_b32 v112, 4, v128
    v_add_u32 v112, s42, v112
    s_cmp_lt_u32 s36, 2
    s_cbranch_scc1 k_down1_kernel_lo
    ds_write_b128 v112, v[0:3] offset:0
    ds_write_b128 v112, v[4:7] offset:1024
    ds_write_b128 v112, v[8:11] offset:2048
    ds_write_b128 v112, v[12:15] offset:3072
    ds_write_b128 v112, v[16:19] offset:4096
    ds_write_b128 v112, v[20:23] offset:5120
    ds_write_b128 v112, v[24:27] offset:6144
    ds_write_b128 v112, v[28:31] offset:7168
    s_waitcnt lgkmcnt(0)
    s_barrier
    s_branch k_down1_kernel_end
k_down1_kernel_lo:
    s_barrier
    ds_read_b128 v[32:35], v112 offset:0
    ds_read_b128 v[36:39], v112 offset:1024
    ds_read_b128 v[40:43], v112 offset:2048
    ds_read_b128 v[44:47], v112 offset:3072
    ds_read_b128 v[48:51], v112 offset:4096
    ds_read_b128 v[52:55], v112 offset:5120
    ds_read_b128 v[56:59], v112 offset:6144
    ds_read_b128 v[60:63], v112 offset:7168
    s_waitcnt lgkmcnt(0)
    v_add_f32 v0, v0, v32
    v_add_f32 v1, v1, v33
    v_add_f32 v2, v2, v34
    v_add_f32 v3, v3, v35
    v_add_f32 v4, v4, v36
    v_add_f32 v5, v5, v37
    v_add_f32 v6, v6, v38
    v_add_f32 v7, v7, v39
    v_add_f32 v8, v8, v40
    v_add_f32 v9, v9, v41
    v_add_f32 v10, v10, v42
    v_add_f32 v11, v11, v43
    v_add_f32 v12, v12, v44
    v_add_f32 v13, v13, v45
    v_add_f32 v14, v14, v46
    v_add_f32 v15, v15, v47
    v_add_f32 v16, v16, v48
    v_add_f32 v17, v17, v49
    v_add_f32 v18, v18, v50
    v_add_f32 v19, v19, v51
    v_add_f32 v20, v20, v52
    v_add_f32 v21, v21, v53
    v_add_f32 v22, v22, v54
    v_add_f32 v23, v23, v55
    v_add_f32 v24, v24, v56
    v_add_f32 v25, v25, v57
    v_add_f32 v26, v26, v58
    v_add_f32 v27, v27, v59
    v_add_f32 v28, v28, v60
    v_add_f32 v29, v29, v61
    v_add_f32 v30, v30, v62
    v_add_f32 v31, v31, v63
    s_nop 15
    s_nop 3
    s_mul_i32 s41, s48, 28
    s_lshr_b32 s49, s43, 4
    s_add_u32 s41, s41, s49
    s_lshl_b32 s41, s41, 10
    v_lshlrev_b32 v120, 4, v128
    v_add_u32 v120, s41, v120
    buffer_load_dwordx4 v[140:143], v120, s[24:27], 0 offen offset:0
    buffer_load_dwordx4 v[144:147], v120, s[24:27], 0 offen offset:1024
    v_cvt_pk_bf16_f32 v112, v0, v1
    v_cvt_pk_bf16_f32 v113, v2, v3
    v_cvt_pk_bf16_f32 v114, v4, v5
    v_cvt_pk_bf16_f32 v115, v6, v7
    v_cvt_pk_bf16_f32 v116, v8, v9
    v_cvt_pk_bf16_f32 v117, v10, v11
    v_cvt_pk_bf16_f32 v118, v12, v13
    v_cvt_pk_bf16_f32 v119, v14, v15
    s_nop 1
    v_permlane32_swap_b32 v112, v114
    v_permlane32_swap_b32 v113, v115
    v_permlane32_swap_b32 v116, v118
    v_permlane32_swap_b32 v117, v119
    s_nop 1
    s_waitcnt vmcnt(1)
    v_lshlrev_b32 v0, 16, v112
    v_and_b32 v1, 0xffff0000, v112
    v_lshlrev_b32 v2, 16, v140
    v_and_b32 v3, 0xffff0000, v140
    v_add_f32 v0, v0, v2
    v_add_f32 v1, v1, v3
    v_cvt_pk_bf16_f32 v112, v0, v1
    v_lshlrev_b32 v0, 16, v113
    v_and_b32 v1, 0xffff0000, v113
    v_lshlrev_b32 v2, 16, v141
    v_and_b32 v3, 0xffff0000, v141
    v_add_f32 v0, v0, v2
    v_add_f32 v1, v1, v3
    v_cvt_pk_bf16_f32 v113, v0, v1
    v_lshlrev_b32 v0, 16, v114
    v_and_b32 v1, 0xffff0000, v114
    v_lshlrev_b32 v2, 16, v142
    v_and_b32 v3, 0xffff0000, v142
    v_add_f32 v0, v0, v2
    v_add_f32 v1, v1, v3
    v_cvt_pk_bf16_f32 v114, v0, v1
    v_lshlrev_b32 v0, 16, v115
    v_and_b32 v1, 0xffff0000, v115
    v_lshlrev_b32 v2, 16, v143
    v_and_b32 v3, 0xffff0000, v143
    v_add_f32 v0, v0, v2
    v_add_f32 v1, v1, v3
    v_cvt_pk_bf16_f32 v115, v0, v1
    buffer_store_dwordx4 v[112:115], v120, s[20:23], 0 offen offset:0
    s_waitcnt vmcnt(1)
    v_lshlrev_b32 v0, 16, v116
    v_and_b32 v1, 0xffff0000, v116
    v_lshlrev_b32 v2, 16, v144
    v_and_b32 v3, 0xffff0000, v144
    v_add_f32 v0, v0, v2
    v_add_f32 v1, v1, v3
    v_cvt_pk_bf16_f32 v116, v0, v1
    v_lshlrev_b32 v0, 16, v117
    v_and_b32 v1, 0xffff0000, v117
    v_lshlrev_b32 v2, 16, v145
    v_and_b32 v3, 0xffff0000, v145
    v_add_f32 v0, v0, v2
    v_add_f32 v1, v1, v3
    v_cvt_pk_bf16_f32 v117, v0, v1
    v_lshlrev_b32 v0, 16, v118
    v_and_b32 v1, 0xffff0000, v118
    v_lshlrev_b32 v2, 16, v146
    v_and_b32 v3, 0xffff0000, v146
    v_add_f32 v0, v0, v2
    v_add_f32 v1, v1, v3
    v_cvt_pk_bf16_f32 v118, v0, v1
    v_lshlrev_b32 v0, 16, v119
    v_and_b32 v1, 0xffff0000, v119
    v_lshlrev_b32 v2, 16, v147
    v_and_b32 v3, 0xffff0000, v147
    v_add_f32 v0, v0, v2
    v_add_f32 v1, v1, v3
    v_cvt_pk_bf16_f32 v119, v0, v1
    buffer_store_dwordx4 v[116:119], v120, s[20:23], 0 offen offset:1024
    s_nop 1
    buffer_load_dwordx4 v[140:143], v120, s[24:27], 0 offen offset:2048
    buffer_load_dwordx4 v[144:147], v120, s[24:27], 0 offen offset:3072
    v_cvt_pk_bf16_f32 v112, v16, v17
    v_cvt_pk_bf16_f32 v113, v18, v19
    v_cvt_pk_bf16_f32 v114, v20, v21
    v_cvt_pk_bf16_f32 v115, v22, v23
    v_cvt_pk_bf16_f32 v116, v24, v25
    v_cvt_pk_bf16_f32 v117, v26, v27
    v_cvt_pk_bf16_f32 v118, v28, v29
    v_cvt_pk_bf16_f32 v119, v30, v31
    s_nop 1
    v_permlane32_swap_b32 v112, v114
    v_permlane32_swap_b32 v113, v115
    v_permlane32_swap_b32 v116, v118
    v_permlane32_swap_b32 v117, v119
    s_nop 1
    s_waitcnt vmcnt(1)
    v_lshlrev_b32 v16, 16, v112
    v_and_b32 v17, 0xffff0000, v112
    v_lshlrev_b32 v18, 16, v140
    v_and_b32 v19, 0xffff0000, v140
    v_add_f32 v16, v16, v18
    v_add_f32 v17, v17, v19
    v_cvt_pk_bf16_f32 v112, v16, v17
    v_lshlrev_b32 v16, 16, v113
    v_and_b32 v17, 0xffff0000, v113
    v_lshlrev_b32 v18, 16, v141
    v_and_b32 v19, 0xffff0000, v141
    v_add_f32 v16, v16, v18
    v_add_f32 v17, v17, v19
    v_cvt_pk_bf16_f32 v113, v16, v17
    v_lshlrev_b32 v16, 16, v114
    v_and_b32 v17, 0xffff0000, v114
    v_lshlrev_b32 v18, 16, v142
    v_and_b32 v19, 0xffff0000, v142
    v_add_f32 v16, v16, v18
    v_add_f32 v17, v17, v19
    v_cvt_pk_bf16_f32 v114, v16, v17
    v_lshlrev_b32 v16, 16, v115
    v_and_b32 v17, 0xffff0000, v115
    v_lshlrev_b32 v18, 16, v143
    v_and_b32 v19, 0xffff0000, v143
    v_add_f32 v16, v16, v18
    v_add_f32 v17, v17, v19
    v_cvt_pk_bf16_f32 v115, v16, v17
    buffer_store_dwordx4 v[112:115], v120, s[20:23], 0 offen offset:2048
    s_waitcnt vmcnt(1)
    v_lshlrev_b32 v16, 16, v116
    v_and_b32 v17, 0xffff0000, v116
    v_lshlrev_b32 v18, 16, v144
    v_and_b32 v19, 0xffff0000, v144
    v_add_f32 v16, v16, v18
    v_add_f32 v17, v17, v19
    v_cvt_pk_bf16_f32 v116, v16, v17
    v_lshlrev_b32 v16, 16, v117
    v_and_b32 v17, 0xffff0000, v117
    v_lshlrev_b32 v18, 16, v145
    v_and_b32 v19, 0xffff0000, v145
    v_add_f32 v16, v16, v18
    v_add_f32 v17, v17, v19
    v_cvt_pk_bf16_f32 v117, v16, v17
    v_lshlrev_b32 v16, 16, v118
    v_and_b32 v17, 0xffff0000, v118
    v_lshlrev_b32 v18, 16, v146
    v_and_b32 v19, 0xffff0000, v146
    v_add_f32 v16, v16, v18
    v_add_f32 v17, v17, v19
    v_cvt_pk_bf16_f32 v118, v16, v17
    v_lshlrev_b32 v16, 16, v119
    v_and_b32 v17, 0xffff0000, v119
    v_lshlrev_b32 v18, 16, v147
    v_and_b32 v19, 0xffff0000, v147
    v_add_f32 v16, v16, v18
    v_add_f32 v17, v17, v19
    v_cvt_pk_bf16_f32 v119, v16, v17
    buffer_store_dwordx4 v[116:119], v120, s[20:23], 0 offen offset:3072
    s_nop 1
    s_waitcnt vmcnt(0)
k_down1_kernel_end:
    s_endpgm

.globl k_qkv2_kernel
.p2align 8
.type k_qkv2_kernel,@function
k_qkv2_kernel:
    s_cmp_ge_u32 s2, 256
    s_cbranch_scc1 k_qkv2_kernel_end
    s_load_dwordx2 s[28:29], s[0:1], 72
    s_load_dwordx2 s[30:31], s[0:1], 8
    s_load_dwordx2 s[34:35], s[0:1], 72
    v_and_b32 v200, 63, v0
    v_lshrrev_b32 v184, 6, v0
    s_and_b32 s37, s2, 7
    s_lshl_b32 s37, s37, 1
    v_readfirstlane_b32 s36, v184
    s_lshr_b32 s38, s2, 3
    s_and_b32 s42, s38, 1
    s_add_u32 s37, s37, s42
    s_lshr_b32 s38, s38, 1
    s_waitcnt lgkmcnt(0)
    s_add_u32 s8, s28, 0x1200000
    s_addc_u32 s9, s29, 0
    s_mov_b32 s10, 0x1c0000
    s_mov_b32 s11, 0x20000
    s_mov_b32 s12, s30
    s_mov_b32 s13, s31
    s_mov_b32 s14, 0x126000
    s_mov_b32 s15, 0x20000
    s_mov_b32 s20, s34
    s_mov_b32 s21, s35
    s_mov_b32 s22, 0x600000
    s_mov_b32 s23, 0x20000
    s_lshl_b32 s48, s37, 2
    s_add_u32 s48, s48, s36
    s_lshl_b32 s42, s48, 5
    v_and_b32 v208, 31, v200
    v_add_u32 v208, s42, v208
    s_mul_i32 s42, s48, 28672
    v_lshlrev_b32 v206, 4, v200
    v_add_u32 v206, s42, v206
    buffer_load_dwordx4 v[0:3], v206, s[8:11], 0 offen offset:0
    buffer_load_dwordx4 v[4:7], v206, s[8:11], 0 offen offset:1024
    buffer_load_dwordx4 v[8:11], v206, s[8:11], 0 offen offset:2048
    buffer_load_dwordx4 v[12:15], v206, s[8:11], 0 offen offset:3072
    v_add_u32 v206, 4096, v206
    buffer_load_dwordx4 v[16:19], v206, s[8:11], 0 offen offset:0
    buffer_load_dwordx4 v[20:23], v206, s[8:11], 0 offen offset:1024
    buffer_load_dwordx4 v[24:27], v206, s[8:11], 0 offen offset:2048
    buffer_load_dwordx4 v[28:31], v206, s[8:11], 0 offen offset:3072
    v_add_u32 v206, 4096, v206
    buffer_load_dwordx4 v[32:35], v206, s[8:11], 0 offen offset:0
    buffer_load_dwordx4 v[36:39], v206, s[8:11], 0 offen offset:1024
    buffer_load_dwordx4 v[40:43], v206, s[8:11], 0 offen offset:2048
    buffer_load_dwordx4 v[44:47], v206, s[8:11], 0 offen offset:3072
    v_add_u32 v206, 4096, v206
    buffer_load_dwordx4 v[48:51], v206, s[8:11], 0 offen offset:0
    buffer_load_dwordx4 v[52:55], v206, s[8:11], 0 offen offset:1024
    buffer_load_dwordx4 v[56:59], v206, s[8:11], 0 offen offset:2048
    buffer_load_dwordx4 v[60:63], v206, s[8:11], 0 offen offset:3072
    v_add_u32 v206, 4096, v206
    buffer_load_dwordx4 v[64:67], v206, s[8:11], 0 offen offset:0
    buffer_load_dwordx4 v[68:71], v206, s[8:11], 0 offen offset:1024
    buffer_load_dwordx4 v[72:75], v206, s[8:11], 0 offen offset:2048
    buffer_load_dwordx4 v[76:79], v206, s[8:11], 0 offen offset:3072
    v_add_u32 v206, 4096, v206
    buffer_load_dwordx4 v[80:83], v206, s[8:11], 0 offen offset:0
    buffer_load_dwordx4 v[84:87], v206, s[8:11], 0 offen offset:1024
    buffer_load_dwordx4 v[88:91], v206, s[8:11], 0 offen offset:2048
    buffer_load_dwordx4 v[92:95], v206, s[8:11], 0 offen offset:3072
    v_add_u32 v206, 4096, v206
    buffer_load_dwordx4 v[96:99], v206, s[8:11], 0 offen offset:0
    buffer_load_dwordx4 v[100:103], v206, s[8:11], 0 offen offset:1024
    buffer_load_dwordx4 v[104:107], v206, s[8:11], 0 offen offset:2048
    buffer_load_dwordx4 v[108:111], v206, s[8:11], 0 offen offset:3072
    s_lshl_b32 s42, s36, 6
    v_add_u32 v203, s42, v200
    v_mul_u32_u24 v184, 683, v203
    v_lshrrev_b32 v184, 13, v184
    v_mul_u32_u24 v185, 12, v184
    v_sub_u32 v185, v203, v185
    v_mul_u32_u24 v203, 2688, v184
    v_lshrrev_b32 v186, 2, v185
    v_mul_u32_u24 v186, 56, v186
    v_and_b32 v185, 3, v185
    v_lshl_add_u32 v186, v185, 4, v186
    v_add_u32 v203, v203, v186
    v_add_u32 v204, s42, v200
    v_add_u32 v204, 256, v204
    v_mul_u32_u24 v184, 683, v204
    v_lshrrev_b32 v184, 13, v184
    v_mul_u32_u24 v185, 12, v184
    v_sub_u32 v185, v204, v185
    v_mul_u32_u24 v204, 2688, v184
    v_lshrrev_b32 v186, 2, v185
    v_mul_u32_u24 v186, 56, v186
    v_and_b32 v185, 3, v185
    v_lshl_add_u32 v186, v185, 4, v186
    v_add_u32 v204, v204, v186
    v_add_u32 v205, s42, v200
    v_add_u32 v205, 512, v205
    v_mul_u32_u24 v184, 683, v205
    v_lshrrev_b32 v184, 13, v184
    v_mul_u32_u24 v185, 12, v184
    v_sub_u32 v185, v205, v185
    v_mul_u32_u24 v205, 2688, v184
    v_lshrrev_b32 v186, 2, v185
    v_mul_u32_u24 v186, 56, v186
    v_and_b32 v185, 3, v185
    v_lshl_add_u32 v186, v185, 4, v186
    v_add_u32 v205, v205, v186
    s_mul_i32 s43, s38, 96
    s_mul_i32 s40, s38, 168
    s_lshl_b32 s39, s36, 10
    v_lshrrev_b32 v184, 5, v200
    v_lshlrev_b32 v184, 3, v184
    v_bfe_u32 v185, v200, 2, 2
    v_add_u32 v184, v184, v185
    v_mul_u32_u24 v201, 192, v184
    v_bfe_u32 v186, v200, 4, 1
    v_lshlrev_b32 v186, 5, v186
    v_and_b32 v187, 3, v200
    v_lshl_add_u32 v186, v187, 3, v186
    v_add_u32 v201, v201, v186
    s_add_u32 s42, s40, 0x0
    s_add_u32 m0, s39, 0
    buffer_load_dwordx4 v203, s[12:15], s42 offen lds
    s_add_u32 s42, s40, 0x0
    s_add_u32 m0, s39, 4096
    buffer_load_dwordx4 v204, s[12:15], s42 offen lds
    s_add_u32 s42, s40, 0x0
    s_add_u32 m0, s39, 8192
    buffer_load_dwordx4 v205, s[12:15], s42 offen lds
    s_add_u32 s42, s40, 0x2a000
    s_add_u32 m0, s39, 12288
    buffer_load_dwordx4 v203, s[12:15], s42 offen lds
    s_add_u32 s42, s40, 0x2a000
    s_add_u32 m0, s39, 16384
    buffer_load_dwordx4 v204, s[12:15], s42 offen lds
    s_add_u32 s42, s40, 0x2a000
    s_add_u32 m0, s39, 20480
    buffer_load_dwordx4 v205, s[12:15], s42 offen lds
    s_waitcnt vmcnt(6)
    v_mov_b32 v184, 0x3f803f80
    v_mov_b32 v185, 0
    v_mov_b32 v186, 0
    v_dot2_f32_bf16 v185, v0, v184, v185
    v_dot2_f32_bf16 v186, v1, v184, v186
    v_dot2_f32_bf16 v185, v2, v184, v185
    v_dot2_f32_bf16 v186, v3, v184, v186
    v_dot2_f32_bf16 v185, v4, v184, v185
    v_dot2_f32_bf16 v186, v5, v184, v186
    v_dot2_f32_bf16 v185, v6, v184, v185
    v_dot2_f32_bf16 v186, v7, v184, v186
    v_dot2_f32_bf16 v185, v8, v184, v185
    v_dot2_f32_bf16 v186, v9, v184, v186
    v_dot2_f32_bf16 v185, v10, v184, v185
    v_dot2_f32_bf16 v186, v11, v184, v186
    v_dot2_f32_bf16 v185, v12, v184, v185
    v_dot2_f32_bf16 v186, v13, v184, v186
    v_dot2_f32_bf16 v185, v14, v184, v185
    v_dot2_f32_bf16 v186, v15, v184, v186
    v_dot2_f32_bf16 v185, v16, v184, v185
    v_dot2_f32_bf16 v186, v17, v184, v186
    v_dot2_f32_bf16 v185, v18, v184, v185
    v_dot2_f32_bf16 v186, v19, v184, v186
    v_dot2_f32_bf16 v185, v20, v184, v185
    v_dot2_f32_bf16 v186, v21, v184, v186
    v_dot2_f32_bf16 v185, v22, v184, v185
    v_dot2_f32_bf16 v186, v23, v184, v186
    v_dot2_f32_bf16 v185, v24, v184, v185
    v_dot2_f32_bf16 v186, v25, v184, v186
    v_dot2_f32_bf16 v185, v26, v184, v185
    v_dot2_f32_bf16 v186, v27, v184, v186
    v_dot2_f32_bf16 v185, v28, v184, v185
    v_dot2_f32_bf16 v186, v29, v184, v186
    v_dot2_f32_bf16 v185, v30, v184, v185
    v_dot2_f32_bf16 v186, v31, v184, v186
    v_dot2_f32_bf16 v185, v32, v184, v185
    v_dot2_f32_bf16 v186, v33, v184, v186
    v_dot2_f32_bf16 v185, v34, v184, v185
    v_dot2_f32_bf16 v186, v35, v184, v186
    v_dot2_f32_bf16 v185, v36, v184, v185
    v_dot2_f32_bf16 v186, v37, v184, v186
    v_dot2_f32_bf16 v185, v38, v184, v185
    v_dot2_f32_bf16 v186, v39, v184, v186
    v_dot2_f32_bf16 v185, v40, v184, v185
    v_dot2_f32_bf16 v186, v41, v184, v186
    v_dot2_f32_bf16 v185, v42, v184, v185
    v_dot2_f32_bf16 v186, v43, v184, v186
    v_dot2_f32_bf16 v185, v44, v184, v185
    v_dot2_f32_bf16 v186, v45, v184, v186
    v_dot2_f32_bf16 v185, v46, v184, v185
    v_dot2_f32_bf16 v186, v47, v184, v186
    v_dot2_f32_bf16 v185, v48, v184, v185
    v_dot2_f32_bf16 v186, v49, v184, v186
    v_dot2_f32_bf16 v185, v50, v184, v185
    v_dot2_f32_bf16 v186, v51, v184, v186
    v_dot2_f32_bf16 v185, v52, v184, v185
    v_dot2_f32_bf16 v186, v53, v184, v186
    v_dot2_f32_bf16 v185, v54, v184, v185
    v_dot2_f32_bf16 v186, v55, v184, v186
    v_dot2_f32_bf16 v185, v56, v184, v185
    v_dot2_f32_bf16 v186, v57, v184, v186
    v_dot2_f32_bf16 v185, v58, v184, v185
    v_dot2_f32_bf16 v186, v59, v184, v186
    v_dot2_f32_bf16 v185, v60, v184, v185
    v_dot2_f32_bf16 v186, v61, v184, v186
    v_dot2_f32_bf16 v185, v62, v184, v185
    v_dot2_f32_bf16 v186, v63, v184, v186
    v_dot2_f32_bf16 v185, v64, v184, v185
    v_dot2_f32_bf16 v186, v65, v184, v186
    v_dot2_f32_bf16 v185, v66, v184, v185
    v_dot2_f32_bf16 v186, v67, v184, v186
    v_dot2_f32_bf16 v185, v68, v184, v185
    v_dot2_f32_bf16 v186, v69, v184, v186
    v_dot2_f32_bf16 v185, v70, v184, v185
    v_dot2_f32_bf16 v186, v71, v184, v186
    v_dot2_f32_bf16 v185, v72, v184, v185
    v_dot2_f32_bf16 v186, v73, v184, v186
    v_dot2_f32_bf16 v185, v74, v184, v185
    v_dot2_f32_bf16 v186, v75, v184, v186
    v_dot2_f32_bf16 v185, v76, v184, v185
    v_dot2_f32_bf16 v186, v77, v184, v186
    v_dot2_f32_bf16 v185, v78, v184, v185
    v_dot2_f32_bf16 v186, v79, v184, v186
    v_dot2_f32_bf16 v185, v80, v184, v185
    v_dot2_f32_bf16 v186, v81, v184, v186
    v_dot2_f32_bf16 v185, v82, v184, v185
    v_dot2_f32_bf16 v186, v83, v184, v186
    v_dot2_f32_bf16 v185, v84, v184, v185
    v_dot2_f32_bf16 v186, v85, v184, v186
    v_dot2_f32_bf16 v185, v86, v184, v185
    v_dot2_f32_bf16 v186, v87, v184, v186
    v_dot2_f32_bf16 v185, v88, v184, v185
    v_dot2_f32_bf16 v186, v89, v184, v186
    v_dot2_f32_bf16 v185, v90, v184, v185
    v_dot2_f32_bf16 v186, v91, v184, v186
    v_dot2_f32_bf16 v185, v92, v184, v185
    v_dot2_f32_bf16 v186, v93, v184, v186
    v_dot2_f32_bf16 v185, v94, v184, v185
    v_dot2_f32_bf16 v186, v95, v184, v186
    v_dot2_f32_bf16 v185, v96, v184, v185
    v_dot2_f32_bf16 v186, v97, v184, v186
    v_dot2_f32_bf16 v185, v98, v184, v185
    v_dot2_f32_bf16 v186, v99, v184, v186
    v_dot2_f32_bf16 v185, v100, v184, v185
    v_dot2_f32_bf16 v186, v101, v184, v186
    v_dot2_f32_bf16 v185, v102, v184, v185
    v_dot2_f32_bf16 v186, v103, v184, v186
    v_dot2_f32_bf16 v185, v104, v184, v185
    v_dot2_f32_bf16 v186, v105, v184, v186
    v_dot2_f32_bf16 v185, v106, v184, v185
    v_dot2_f32_bf16 v186, v107, v184, v186
    v_dot2_f32_bf16 v185, v108, v184, v185
    v_dot2_f32_bf16 v186, v109, v184, v186
    v_dot2_f32_bf16 v185, v110, v184, v185
    v_dot2_f32_bf16 v186, v111, v184, v186
    s_nop 3
    v_add_f32 v185, v185, v186
    v_mov_b32 v187, v185
    s_nop 1
    v_permlane32_swap_b32 v187, v185
    s_nop 1
    v_add_f32 v185, v185, v187
    v_mul_f32 v188, 0x3b124925, v185
    v_cvt_pk_bf16_f32 v189, v188, v188
    v_lshlrev_b32 v189, 16, v189
    v_sub_f32 v190, 0, v189
    v_mov_b32 v191, v190
    v_mov_b32 v192, 0
    v_mov_b32 v193, 0
    v_lshlrev_b32 v194, 16, v0
    v_and_b32 v195, 0xffff0000, v0
    v_pk_add_f32 v[194:195], v[194:195], v[190:191]
    v_pk_fma_f32 v[192:193], v[194:195], v[194:195], v[192:193]
    v_cvt_pk_bf16_f32 v0, v194, v195
    v_lshlrev_b32 v194, 16, v1
    v_and_b32 v195, 0xffff0000, v1
    v_pk_add_f32 v[194:195], v[194:195], v[190:191]
    v_pk_fma_f32 v[192:193], v[194:195], v[194:195], v[192:193]
    v_cvt_pk_bf16_f32 v1, v194, v195
    v_lshlrev_b32 v194, 16, v2
    v_and_b32 v195, 0xffff0000, v2
    v_pk_add_f32 v[194:195], v[194:195], v[190:191]
    v_pk_fma_f32 v[192:193], v[194:195], v[194:195], v[192:193]
    v_cvt_pk_bf16_f32 v2, v194, v195
    v_lshlrev_b32 v194, 16, v3
    v_and_b32 v195, 0xffff0000, v3
    v_pk_add_f32 v[194:195], v[194:195], v[190:191]
    v_pk_fma_f32 v[192:193], v[194:195], v[194:195], v[192:193]
    v_cvt_pk_bf16_f32 v3, v194, v195
    v_lshlrev_b32 v194, 16, v4
    v_and_b32 v195, 0xffff0000, v4
    v_pk_add_f32 v[194:195], v[194:195], v[190:191]
    v_pk_fma_f32 v[192:193], v[194:195], v[194:195], v[192:193]
    v_cvt_pk_bf16_f32 v4, v194, v195
    v_lshlrev_b32 v194, 16, v5
    v_and_b32 v195, 0xffff0000, v5
    v_pk_add_f32 v[194:195], v[194:195], v[190:191]
    v_pk_fma_f32 v[192:193], v[194:195], v[194:195], v[192:193]
    v_cvt_pk_bf16_f32 v5, v194, v195
    v_lshlrev_b32 v194, 16, v6
    v_and_b32 v195, 0xffff0000, v6
    v_pk_add_f32 v[194:195], v[194:195], v[190:191]
    v_pk_fma_f32 v[192:193], v[194:195], v[194:195], v[192:193]
    v_cvt_pk_bf16_f32 v6, v194, v195
    v_lshlrev_b32 v194, 16, v7
    v_and_b32 v195, 0xffff0000, v7
    v_pk_add_f32 v[194:195], v[194:195], v[190:191]
    v_pk_fma_f32 v[192:193], v[194:195], v[194:195], v[192:193]
    v_cvt_pk_bf16_f32 v7, v194, v195
    v_lshlrev_b32 v194, 16, v8
    v_and_b32 v195, 0xffff0000, v8
    v_pk_add_f32 v[194:195], v[194:195], v[190:191]
    v_pk_fma_f32 v[192:193], v[194:195], v[194:195], v[192:193]
    v_cvt_pk_bf16_f32 v8, v194, v195
    v_lshlrev_b32 v194, 16, v9
    v_and_b32 v195, 0xffff0000, v9
    v_pk_add_f32 v[194:195], v[194:195], v[190:191]
    v_pk_fma_f32 v[192:193], v[194:195], v[194:195], v[192:193]
    v_cvt_pk_bf16_f32 v9, v194, v195
    v_lshlrev_b32 v194, 16, v10
    v_and_b32 v195, 0xffff0000, v10
    v_pk_add_f32 v[194:195], v[194:195], v[190:191]
    v_pk_fma_f32 v[192:193], v[194:195], v[194:195], v[192:193]
    v_cvt_pk_bf16_f32 v10, v194, v195
    v_lshlrev_b32 v194, 16, v11
    v_and_b32 v195, 0xffff0000, v11
    v_pk_add_f32 v[194:195], v[194:195], v[190:191]
    v_pk_fma_f32 v[192:193], v[194:195], v[194:195], v[192:193]
    v_cvt_pk_bf16_f32 v11, v194, v195
    v_lshlrev_b32 v194, 16, v12
    v_and_b32 v195, 0xffff0000, v12
    v_pk_add_f32 v[194:195], v[194:195], v[190:191]
    v_pk_fma_f32 v[192:193], v[194:195], v[194:195], v[192:193]
    v_cvt_pk_bf16_f32 v12, v194, v195
    v_lshlrev_b32 v194, 16, v13
    v_and_b32 v195, 0xffff0000, v13
    v_pk_add_f32 v[194:195], v[194:195], v[190:191]
    v_pk_fma_f32 v[192:193], v[194:195], v[194:195], v[192:193]
    v_cvt_pk_bf16_f32 v13, v194, v195
    v_lshlrev_b32 v194, 16, v14
    v_and_b32 v195, 0xffff0000, v14
    v_pk_add_f32 v[194:195], v[194:195], v[190:191]
    v_pk_fma_f32 v[192:193], v[194:195], v[194:195], v[192:193]
    v_cvt_pk_bf16_f32 v14, v194, v195
    v_lshlrev_b32 v194, 16, v15
    v_and_b32 v195, 0xffff0000, v15
    v_pk_add_f32 v[194:195], v[194:195], v[190:191]
    v_pk_fma_f32 v[192:193], v[194:195], v[194:195], v[192:193]
    v_cvt_pk_bf16_f32 v15, v194, v195
    v_lshlrev_b32 v194, 16, v16
    v_and_b32 v195, 0xffff0000, v16
    v_pk_add_f32 v[194:195], v[194:195], v[190:191]
    v_pk_fma_f32 v[192:193], v[194:195], v[194:195], v[192:193]
    v_cvt_pk_bf16_f32 v16, v194, v195
    v_lshlrev_b32 v194, 16, v17
    v_and_b32 v195, 0xffff0000, v17
    v_pk_add_f32 v[194:195], v[194:195], v[190:191]
    v_pk_fma_f32 v[192:193], v[194:195], v[194:195], v[192:193]
    v_cvt_pk_bf16_f32 v17, v194, v195
    v_lshlrev_b32 v194, 16, v18
    v_and_b32 v195, 0xffff0000, v18
    v_pk_add_f32 v[194:195], v[194:195], v[190:191]
    v_pk_fma_f32 v[192:193], v[194:195], v[194:195], v[192:193]
    v_cvt_pk_bf16_f32 v18, v194, v195
    v_lshlrev_b32 v194, 16, v19
    v_and_b32 v195, 0xffff0000, v19
    v_pk_add_f32 v[194:195], v[194:195], v[190:191]
    v_pk_fma_f32 v[192:193], v[194:195], v[194:195], v[192:193]
    v_cvt_pk_bf16_f32 v19, v194, v195
    v_lshlrev_b32 v194, 16, v20
    v_and_b32 v195, 0xffff0000, v20
    v_pk_add_f32 v[194:195], v[194:195], v[190:191]
    v_pk_fma_f32 v[192:193], v[194:195], v[194:195], v[192:193]
    v_cvt_pk_bf16_f32 v20, v194, v195
    v_lshlrev_b32 v194, 16, v21
    v_and_b32 v195, 0xffff0000, v21
    v_pk_add_f32 v[194:195], v[194:195], v[190:191]
    v_pk_fma_f32 v[192:193], v[194:195], v[194:195], v[192:193]
    v_cvt_pk_bf16_f32 v21, v194, v195
    v_lshlrev_b32 v194, 16, v22
    v_and_b32 v195, 0xffff0000, v22
    v_pk_add_f32 v[194:195], v[194:195], v[190:191]
    v_pk_fma_f32 v[192:193], v[194:195], v[194:195], v[192:193]
    v_cvt_pk_bf16_f32 v22, v194, v195
    v_lshlrev_b32 v194, 16, v23
    v_and_b32 v195, 0xffff0000, v23
    v_pk_add_f32 v[194:195], v[194:195], v[190:191]
    v_pk_fma_f32 v[192:193], v[194:195], v[194:195], v[192:193]
    v_cvt_pk_bf16_f32 v23, v194, v195
    v_lshlrev_b32 v194, 16, v24
    v_and_b32 v195, 0xffff0000, v24
    v_pk_add_f32 v[194:195], v[194:195], v[190:191]
    v_pk_fma_f32 v[192:193], v[194:195], v[194:195], v[192:193]
    v_cvt_pk_bf16_f32 v24, v194, v195
    v_lshlrev_b32 v194, 16, v25
    v_and_b32 v195, 0xffff0000, v25
    v_pk_add_f32 v[194:195], v[194:195], v[190:191]
    v_pk_fma_f32 v[192:193], v[194:195], v[194:195], v[192:193]
    v_cvt_pk_bf16_f32 v25, v194, v195
    v_lshlrev_b32 v194, 16, v26
    v_and_b32 v195, 0xffff0000, v26
    v_pk_add_f32 v[194:195], v[194:195], v[190:191]
    v_pk_fma_f32 v[192:193], v[194:195], v[194:195], v[192:193]
    v_cvt_pk_bf16_f32 v26, v194, v195
    v_lshlrev_b32 v194, 16, v27
    v_and_b32 v195, 0xffff0000, v27
    v_pk_add_f32 v[194:195], v[194:195], v[190:191]
    v_pk_fma_f32 v[192:193], v[194:195], v[194:195], v[192:193]
    v_cvt_pk_bf16_f32 v27, v194, v195
    v_lshlrev_b32 v194, 16, v28
    v_and_b32 v195, 0xffff0000, v28
    v_pk_add_f32 v[194:195], v[194:195], v[190:191]
    v_pk_fma_f32 v[192:193], v[194:195], v[194:195], v[192:193]
    v_cvt_pk_bf16_f32 v28, v194, v195
    v_lshlrev_b32 v194, 16, v29
    v_and_b32 v195, 0xffff0000, v29
    v_pk_add_f32 v[194:195], v[194:195], v[190:191]
    v_pk_fma_f32 v[192:193], v[194:195], v[194:195], v[192:193]
    v_cvt_pk_bf16_f32 v29, v194, v195
    v_lshlrev_b32 v194, 16, v30
    v_and_b32 v195, 0xffff0000, v30
    v_pk_add_f32 v[194:195], v[194:195], v[190:191]
    v_pk_fma_f32 v[192:193], v[194:195], v[194:195], v[192:193]
    v_cvt_pk_bf16_f32 v30, v194, v195
    v_lshlrev_b32 v194, 16, v31
    v_and_b32 v195, 0xffff0000, v31
    v_pk_add_f32 v[194:195], v[194:195], v[190:191]
    v_pk_fma_f32 v[192:193], v[194:195], v[194:195], v[192:193]
    v_cvt_pk_bf16_f32 v31, v194, v195
    v_lshlrev_b32 v194, 16, v32
    v_and_b32 v195, 0xffff0000, v32
    v_pk_add_f32 v[194:195], v[194:195], v[190:191]
    v_pk_fma_f32 v[192:193], v[194:195], v[194:195], v[192:193]
    v_cvt_pk_bf16_f32 v32, v194, v195
    v_lshlrev_b32 v194, 16, v33
    v_and_b32 v195, 0xffff0000, v33
    v_pk_add_f32 v[194:195], v[194:195], v[190:191]
    v_pk_fma_f32 v[192:193], v[194:195], v[194:195], v[192:193]
    v_cvt_pk_bf16_f32 v33, v194, v195
    v_lshlrev_b32 v194, 16, v34
    v_and_b32 v195, 0xffff0000, v34
    v_pk_add_f32 v[194:195], v[194:195], v[190:191]
    v_pk_fma_f32 v[192:193], v[194:195], v[194:195], v[192:193]
    v_cvt_pk_bf16_f32 v34, v194, v195
    v_lshlrev_b32 v194, 16, v35
    v_and_b32 v195, 0xffff0000, v35
    v_pk_add_f32 v[194:195], v[194:195], v[190:191]
    v_pk_fma_f32 v[192:193], v[194:195], v[194:195], v[192:193]
    v_cvt_pk_bf16_f32 v35, v194, v195
    v_lshlrev_b32 v194, 16, v36
    v_and_b32 v195, 0xffff0000, v36
    v_pk_add_f32 v[194:195], v[194:195], v[190:191]
    v_pk_fma_f32 v[192:193], v[194:195], v[194:195], v[192:193]
    v_cvt_pk_bf16_f32 v36, v194, v195
    v_lshlrev_b32 v194, 16, v37
    v_and_b32 v195, 0xffff0000, v37
    v_pk_add_f32 v[194:195], v[194:195], v[190:191]
    v_pk_fma_f32 v[192:193], v[194:195], v[194:195], v[192:193]
    v_cvt_pk_bf16_f32 v37, v194, v195
    v_lshlrev_b32 v194, 16, v38
    v_and_b32 v195, 0xffff0000, v38
    v_pk_add_f32 v[194:195], v[194:195], v[190:191]
    v_pk_fma_f32 v[192:193], v[194:195], v[194:195], v[192:193]
    v_cvt_pk_bf16_f32 v38, v194, v195
    v_lshlrev_b32 v194, 16, v39
    v_and_b32 v195, 0xffff0000, v39
    v_pk_add_f32 v[194:195], v[194:195], v[190:191]
    v_pk_fma_f32 v[192:193], v[194:195], v[194:195], v[192:193]
    v_cvt_pk_bf16_f32 v39, v194, v195
    v_lshlrev_b32 v194, 16, v40
    v_and_b32 v195, 0xffff0000, v40
    v_pk_add_f32 v[194:195], v[194:195], v[190:191]
    v_pk_fma_f32 v[192:193], v[194:195], v[194:195], v[192:193]
    v_cvt_pk_bf16_f32 v40, v194, v195
    v_lshlrev_b32 v194, 16, v41
    v_and_b32 v195, 0xffff0000, v41
    v_pk_add_f32 v[194:195], v[194:195], v[190:191]
    v_pk_fma_f32 v[192:193], v[194:195], v[194:195], v[192:193]
    v_cvt_pk_bf16_f32 v41, v194, v195
    v_lshlrev_b32 v194, 16, v42
    v_and_b32 v195, 0xffff0000, v42
    v_pk_add_f32 v[194:195], v[194:195], v[190:191]
    v_pk_fma_f32 v[192:193], v[194:195], v[194:195], v[192:193]
    v_cvt_pk_bf16_f32 v42, v194, v195
    v_lshlrev_b32 v194, 16, v43
    v_and_b32 v195, 0xffff0000, v43
    v_pk_add_f32 v[194:195], v[194:195], v[190:191]
    v_pk_fma_f32 v[192:193], v[194:195], v[194:195], v[192:193]
    v_cvt_pk_bf16_f32 v43, v194, v195
    v_lshlrev_b32 v194, 16, v44
    v_and_b32 v195, 0xffff0000, v44
    v_pk_add_f32 v[194:195], v[194:195], v[190:191]
    v_pk_fma_f32 v[192:193], v[194:195], v[194:195], v[192:193]
    v_cvt_pk_bf16_f32 v44, v194, v195
    v_lshlrev_b32 v194, 16, v45
    v_and_b32 v195, 0xffff0000, v45
    v_pk_add_f32 v[194:195], v[194:195], v[190:191]
    v_pk_fma_f32 v[192:193], v[194:195], v[194:195], v[192:193]
    v_cvt_pk_bf16_f32 v45, v194, v195
    v_lshlrev_b32 v194, 16, v46
    v_and_b32 v195, 0xffff0000, v46
    v_pk_add_f32 v[194:195], v[194:195], v[190:191]
    v_pk_fma_f32 v[192:193], v[194:195], v[194:195], v[192:193]
    v_cvt_pk_bf16_f32 v46, v194, v195
    v_lshlrev_b32 v194, 16, v47
    v_and_b32 v195, 0xffff0000, v47
    v_pk_add_f32 v[194:195], v[194:195], v[190:191]
    v_pk_fma_f32 v[192:193], v[194:195], v[194:195], v[192:193]
    v_cvt_pk_bf16_f32 v47, v194, v195
    v_lshlrev_b32 v194, 16, v48
    v_and_b32 v195, 0xffff0000, v48
    v_pk_add_f32 v[194:195], v[194:195], v[190:191]
    v_pk_fma_f32 v[192:193], v[194:195], v[194:195], v[192:193]
    v_cvt_pk_bf16_f32 v48, v194, v195
    v_lshlrev_b32 v194, 16, v49
    v_and_b32 v195, 0xffff0000, v49
    v_pk_add_f32 v[194:195], v[194:195], v[190:191]
    v_pk_fma_f32 v[192:193], v[194:195], v[194:195], v[192:193]
    v_cvt_pk_bf16_f32 v49, v194, v195
    v_lshlrev_b32 v194, 16, v50
    v_and_b32 v195, 0xffff0000, v50
    v_pk_add_f32 v[194:195], v[194:195], v[190:191]
    v_pk_fma_f32 v[192:193], v[194:195], v[194:195], v[192:193]
    v_cvt_pk_bf16_f32 v50, v194, v195
    v_lshlrev_b32 v194, 16, v51
    v_and_b32 v195, 0xffff0000, v51
    v_pk_add_f32 v[194:195], v[194:195], v[190:191]
    v_pk_fma_f32 v[192:193], v[194:195], v[194:195], v[192:193]
    v_cvt_pk_bf16_f32 v51, v194, v195
    v_lshlrev_b32 v194, 16, v52
    v_and_b32 v195, 0xffff0000, v52
    v_pk_add_f32 v[194:195], v[194:195], v[190:191]
    v_pk_fma_f32 v[192:193], v[194:195], v[194:195], v[192:193]
    v_cvt_pk_bf16_f32 v52, v194, v195
    v_lshlrev_b32 v194, 16, v53
    v_and_b32 v195, 0xffff0000, v53
    v_pk_add_f32 v[194:195], v[194:195], v[190:191]
    v_pk_fma_f32 v[192:193], v[194:195], v[194:195], v[192:193]
    v_cvt_pk_bf16_f32 v53, v194, v195
    v_lshlrev_b32 v194, 16, v54
    v_and_b32 v195, 0xffff0000, v54
    v_pk_add_f32 v[194:195], v[194:195], v[190:191]
    v_pk_fma_f32 v[192:193], v[194:195], v[194:195], v[192:193]
    v_cvt_pk_bf16_f32 v54, v194, v195
    v_lshlrev_b32 v194, 16, v55
    v_and_b32 v195, 0xffff0000, v55
    v_pk_add_f32 v[194:195], v[194:195], v[190:191]
    v_pk_fma_f32 v[192:193], v[194:195], v[194:195], v[192:193]
    v_cvt_pk_bf16_f32 v55, v194, v195
    v_lshlrev_b32 v194, 16, v56
    v_and_b32 v195, 0xffff0000, v56
    v_pk_add_f32 v[194:195], v[194:195], v[190:191]
    v_pk_fma_f32 v[192:193], v[194:195], v[194:195], v[192:193]
    v_cvt_pk_bf16_f32 v56, v194, v195
    v_lshlrev_b32 v194, 16, v57
    v_and_b32 v195, 0xffff0000, v57
    v_pk_add_f32 v[194:195], v[194:195], v[190:191]
    v_pk_fma_f32 v[192:193], v[194:195], v[194:195], v[192:193]
    v_cvt_pk_bf16_f32 v57, v194, v195
    v_lshlrev_b32 v194, 16, v58
    v_and_b32 v195, 0xffff0000, v58
    v_pk_add_f32 v[194:195], v[194:195], v[190:191]
    v_pk_fma_f32 v[192:193], v[194:195], v[194:195], v[192:193]
    v_cvt_pk_bf16_f32 v58, v194, v195
    v_lshlrev_b32 v194, 16, v59
    v_and_b32 v195, 0xffff0000, v59
    v_pk_add_f32 v[194:195], v[194:195], v[190:191]
    v_pk_fma_f32 v[192:193], v[194:195], v[194:195], v[192:193]
    v_cvt_pk_bf16_f32 v59, v194, v195
    v_lshlrev_b32 v194, 16, v60
    v_and_b32 v195, 0xffff0000, v60
    v_pk_add_f32 v[194:195], v[194:195], v[190:191]
    v_pk_fma_f32 v[192:193], v[194:195], v[194:195], v[192:193]
    v_cvt_pk_bf16_f32 v60, v194, v195
    v_lshlrev_b32 v194, 16, v61
    v_and_b32 v195, 0xffff0000, v61
    v_pk_add_f32 v[194:195], v[194:195], v[190:191]
    v_pk_fma_f32 v[192:193], v[194:195], v[194:195], v[192:193]
    v_cvt_pk_bf16_f32 v61, v194, v195
    v_lshlrev_b32 v194, 16, v62
    v_and_b32 v195, 0xffff0000, v62
    v_pk_add_f32 v[194:195], v[194:195], v[190:191]
    v_pk_fma_f32 v[192:193], v[194:195], v[194:195], v[192:193]
    v_cvt_pk_bf16_f32 v62, v194, v195
    v_lshlrev_b32 v194, 16, v63
    v_and_b32 v195, 0xffff0000, v63
    v_pk_add_f32 v[194:195], v[194:195], v[190:191]
    v_pk_fma_f32 v[192:193], v[194:195], v[194:195], v[192:193]
    v_cvt_pk_bf16_f32 v63, v194, v195
    v_lshlrev_b32 v194, 16, v64
    v_and_b32 v195, 0xffff0000, v64
    v_pk_add_f32 v[194:195], v[194:195], v[190:191]
    v_pk_fma_f32 v[192:193], v[194:195], v[194:195], v[192:193]
    v_cvt_pk_bf16_f32 v64, v194, v195
    v_lshlrev_b32 v194, 16, v65
    v_and_b32 v195, 0xffff0000, v65
    v_pk_add_f32 v[194:195], v[194:195], v[190:191]
    v_pk_fma_f32 v[192:193], v[194:195], v[194:195], v[192:193]
    v_cvt_pk_bf16_f32 v65, v194, v195
    v_lshlrev_b32 v194, 16, v66
    v_and_b32 v195, 0xffff0000, v66
    v_pk_add_f32 v[194:195], v[194:195], v[190:191]
    v_pk_fma_f32 v[192:193], v[194:195], v[194:195], v[192:193]
    v_cvt_pk_bf16_f32 v66, v194, v195
    v_lshlrev_b32 v194, 16, v67
    v_and_b32 v195, 0xffff0000, v67
    v_pk_add_f32 v[194:195], v[194:195], v[190:191]
    v_pk_fma_f32 v[192:193], v[194:195], v[194:195], v[192:193]
    v_cvt_pk_bf16_f32 v67, v194, v195
    v_lshlrev_b32 v194, 16, v68
    v_and_b32 v195, 0xffff0000, v68
    v_pk_add_f32 v[194:195], v[194:195], v[190:191]
    v_pk_fma_f32 v[192:193], v[194:195], v[194:195], v[192:193]
    v_cvt_pk_bf16_f32 v68, v194, v195
    v_lshlrev_b32 v194, 16, v69
    v_and_b32 v195, 0xffff0000, v69
    v_pk_add_f32 v[194:195], v[194:195], v[190:191]
    v_pk_fma_f32 v[192:193], v[194:195], v[194:195], v[192:193]
    v_cvt_pk_bf16_f32 v69, v194, v195
    v_lshlrev_b32 v194, 16, v70
    v_and_b32 v195, 0xffff0000, v70
    v_pk_add_f32 v[194:195], v[194:195], v[190:191]
    v_pk_fma_f32 v[192:193], v[194:195], v[194:195], v[192:193]
    v_cvt_pk_bf16_f32 v70, v194, v195
    v_lshlrev_b32 v194, 16, v71
    v_and_b32 v195, 0xffff0000, v71
    v_pk_add_f32 v[194:195], v[194:195], v[190:191]
    v_pk_fma_f32 v[192:193], v[194:195], v[194:195], v[192:193]
    v_cvt_pk_bf16_f32 v71, v194, v195
    v_lshlrev_b32 v194, 16, v72
    v_and_b32 v195, 0xffff0000, v72
    v_pk_add_f32 v[194:195], v[194:195], v[190:191]
    v_pk_fma_f32 v[192:193], v[194:195], v[194:195], v[192:193]
    v_cvt_pk_bf16_f32 v72, v194, v195
    v_lshlrev_b32 v194, 16, v73
    v_and_b32 v195, 0xffff0000, v73
    v_pk_add_f32 v[194:195], v[194:195], v[190:191]
    v_pk_fma_f32 v[192:193], v[194:195], v[194:195], v[192:193]
    v_cvt_pk_bf16_f32 v73, v194, v195
    v_lshlrev_b32 v194, 16, v74
    v_and_b32 v195, 0xffff0000, v74
    v_pk_add_f32 v[194:195], v[194:195], v[190:191]
    v_pk_fma_f32 v[192:193], v[194:195], v[194:195], v[192:193]
    v_cvt_pk_bf16_f32 v74, v194, v195
    v_lshlrev_b32 v194, 16, v75
    v_and_b32 v195, 0xffff0000, v75
    v_pk_add_f32 v[194:195], v[194:195], v[190:191]
    v_pk_fma_f32 v[192:193], v[194:195], v[194:195], v[192:193]
    v_cvt_pk_bf16_f32 v75, v194, v195
    v_lshlrev_b32 v194, 16, v76
    v_and_b32 v195, 0xffff0000, v76
    v_pk_add_f32 v[194:195], v[194:195], v[190:191]
    v_pk_fma_f32 v[192:193], v[194:195], v[194:195], v[192:193]
    v_cvt_pk_bf16_f32 v76, v194, v195
    v_lshlrev_b32 v194, 16, v77
    v_and_b32 v195, 0xffff0000, v77
    v_pk_add_f32 v[194:195], v[194:195], v[190:191]
    v_pk_fma_f32 v[192:193], v[194:195], v[194:195], v[192:193]
    v_cvt_pk_bf16_f32 v77, v194, v195
    v_lshlrev_b32 v194, 16, v78
    v_and_b32 v195, 0xffff0000, v78
    v_pk_add_f32 v[194:195], v[194:195], v[190:191]
    v_pk_fma_f32 v[192:193], v[194:195], v[194:195], v[192:193]
    v_cvt_pk_bf16_f32 v78, v194, v195
    v_lshlrev_b32 v194, 16, v79
    v_and_b32 v195, 0xffff0000, v79
    v_pk_add_f32 v[194:195], v[194:195], v[190:191]
    v_pk_fma_f32 v[192:193], v[194:195], v[194:195], v[192:193]
    v_cvt_pk_bf16_f32 v79, v194, v195
    v_lshlrev_b32 v194, 16, v80
    v_and_b32 v195, 0xffff0000, v80
    v_pk_add_f32 v[194:195], v[194:195], v[190:191]
    v_pk_fma_f32 v[192:193], v[194:195], v[194:195], v[192:193]
    v_cvt_pk_bf16_f32 v80, v194, v195
    v_lshlrev_b32 v194, 16, v81
    v_and_b32 v195, 0xffff0000, v81
    v_pk_add_f32 v[194:195], v[194:195], v[190:191]
    v_pk_fma_f32 v[192:193], v[194:195], v[194:195], v[192:193]
    v_cvt_pk_bf16_f32 v81, v194, v195
    v_lshlrev_b32 v194, 16, v82
    v_and_b32 v195, 0xffff0000, v82
    v_pk_add_f32 v[194:195], v[194:195], v[190:191]
    v_pk_fma_f32 v[192:193], v[194:195], v[194:195], v[192:193]
    v_cvt_pk_bf16_f32 v82, v194, v195
    v_lshlrev_b32 v194, 16, v83
    v_and_b32 v195, 0xffff0000, v83
    v_pk_add_f32 v[194:195], v[194:195], v[190:191]
    v_pk_fma_f32 v[192:193], v[194:195], v[194:195], v[192:193]
    v_cvt_pk_bf16_f32 v83, v194, v195
    v_lshlrev_b32 v194, 16, v84
    v_and_b32 v195, 0xffff0000, v84
    v_pk_add_f32 v[194:195], v[194:195], v[190:191]
    v_pk_fma_f32 v[192:193], v[194:195], v[194:195], v[192:193]
    v_cvt_pk_bf16_f32 v84, v194, v195
    v_lshlrev_b32 v194, 16, v85
    v_and_b32 v195, 0xffff0000, v85
    v_pk_add_f32 v[194:195], v[194:195], v[190:191]
    v_pk_fma_f32 v[192:193], v[194:195], v[194:195], v[192:193]
    v_cvt_pk_bf16_f32 v85, v194, v195
    v_lshlrev_b32 v194, 16, v86
    v_and_b32 v195, 0xffff0000, v86
    v_pk_add_f32 v[194:195], v[194:195], v[190:191]
    v_pk_fma_f32 v[192:193], v[194:195], v[194:195], v[192:193]
    v_cvt_pk_bf16_f32 v86, v194, v195
    v_lshlrev_b32 v194, 16, v87
    v_and_b32 v195, 0xffff0000, v87
    v_pk_add_f32 v[194:195], v[194:195], v[190:191]
    v_pk_fma_f32 v[192:193], v[194:195], v[194:195], v[192:193]
    v_cvt_pk_bf16_f32 v87, v194, v195
    v_lshlrev_b32 v194, 16, v88
    v_and_b32 v195, 0xffff0000, v88
    v_pk_add_f32 v[194:195], v[194:195], v[190:191]
    v_pk_fma_f32 v[192:193], v[194:195], v[194:195], v[192:193]
    v_cvt_pk_bf16_f32 v88, v194, v195
    v_lshlrev_b32 v194, 16, v89
    v_and_b32 v195, 0xffff0000, v89
    v_pk_add_f32 v[194:195], v[194:195], v[190:191]
    v_pk_fma_f32 v[192:193], v[194:195], v[194:195], v[192:193]
    v_cvt_pk_bf16_f32 v89, v194, v195
    v_lshlrev_b32 v194, 16, v90
    v_and_b32 v195, 0xffff0000, v90
    v_pk_add_f32 v[194:195], v[194:195], v[190:191]
    v_pk_fma_f32 v[192:193], v[194:195], v[194:195], v[192:193]
    v_cvt_pk_bf16_f32 v90, v194, v195
    v_lshlrev_b32 v194, 16, v91
    v_and_b32 v195, 0xffff0000, v91
    v_pk_add_f32 v[194:195], v[194:195], v[190:191]
    v_pk_fma_f32 v[192:193], v[194:195], v[194:195], v[192:193]
    v_cvt_pk_bf16_f32 v91, v194, v195
    v_lshlrev_b32 v194, 16, v92
    v_and_b32 v195, 0xffff0000, v92
    v_pk_add_f32 v[194:195], v[194:195], v[190:191]
    v_pk_fma_f32 v[192:193], v[194:195], v[194:195], v[192:193]
    v_cvt_pk_bf16_f32 v92, v194, v195
    v_lshlrev_b32 v194, 16, v93
    v_and_b32 v195, 0xffff0000, v93
    v_pk_add_f32 v[194:195], v[194:195], v[190:191]
    v_pk_fma_f32 v[192:193], v[194:195], v[194:195], v[192:193]
    v_cvt_pk_bf16_f32 v93, v194, v195
    v_lshlrev_b32 v194, 16, v94
    v_and_b32 v195, 0xffff0000, v94
    v_pk_add_f32 v[194:195], v[194:195], v[190:191]
    v_pk_fma_f32 v[192:193], v[194:195], v[194:195], v[192:193]
    v_cvt_pk_bf16_f32 v94, v194, v195
    v_lshlrev_b32 v194, 16, v95
    v_and_b32 v195, 0xffff0000, v95
    v_pk_add_f32 v[194:195], v[194:195], v[190:191]
    v_pk_fma_f32 v[192:193], v[194:195], v[194:195], v[192:193]
    v_cvt_pk_bf16_f32 v95, v194, v195
    v_lshlrev_b32 v194, 16, v96
    v_and_b32 v195, 0xffff0000, v96
    v_pk_add_f32 v[194:195], v[194:195], v[190:191]
    v_pk_fma_f32 v[192:193], v[194:195], v[194:195], v[192:193]
    v_cvt_pk_bf16_f32 v96, v194, v195
    v_lshlrev_b32 v194, 16, v97
    v_and_b32 v195, 0xffff0000, v97
    v_pk_add_f32 v[194:195], v[194:195], v[190:191]
    v_pk_fma_f32 v[192:193], v[194:195], v[194:195], v[192:193]
    v_cvt_pk_bf16_f32 v97, v194, v195
    v_lshlrev_b32 v194, 16, v98
    v_and_b32 v195, 0xffff0000, v98
    v_pk_add_f32 v[194:195], v[194:195], v[190:191]
    v_pk_fma_f32 v[192:193], v[194:195], v[194:195], v[192:193]
    v_cvt_pk_bf16_f32 v98, v194, v195
    v_lshlrev_b32 v194, 16, v99
    v_and_b32 v195, 0xffff0000, v99
    v_pk_add_f32 v[194:195], v[194:195], v[190:191]
    v_pk_fma_f32 v[192:193], v[194:195], v[194:195], v[192:193]
    v_cvt_pk_bf16_f32 v99, v194, v195
    v_lshlrev_b32 v194, 16, v100
    v_and_b32 v195, 0xffff0000, v100
    v_pk_add_f32 v[194:195], v[194:195], v[190:191]
    v_pk_fma_f32 v[192:193], v[194:195], v[194:195], v[192:193]
    v_cvt_pk_bf16_f32 v100, v194, v195
    v_lshlrev_b32 v194, 16, v101
    v_and_b32 v195, 0xffff0000, v101
    v_pk_add_f32 v[194:195], v[194:195], v[190:191]
    v_pk_fma_f32 v[192:193], v[194:195], v[194:195], v[192:193]
    v_cvt_pk_bf16_f32 v101, v194, v195
    v_lshlrev_b32 v194, 16, v102
    v_and_b32 v195, 0xffff0000, v102
    v_pk_add_f32 v[194:195], v[194:195], v[190:191]
    v_pk_fma_f32 v[192:193], v[194:195], v[194:195], v[192:193]
    v_cvt_pk_bf16_f32 v102, v194, v195
    v_lshlrev_b32 v194, 16, v103
    v_and_b32 v195, 0xffff0000, v103
    v_pk_add_f32 v[194:195], v[194:195], v[190:191]
    v_pk_fma_f32 v[192:193], v[194:195], v[194:195], v[192:193]
    v_cvt_pk_bf16_f32 v103, v194, v195
    v_lshlrev_b32 v194, 16, v104
    v_and_b32 v195, 0xffff0000, v104
    v_pk_add_f32 v[194:195], v[194:195], v[190:191]
    v_pk_fma_f32 v[192:193], v[194:195], v[194:195], v[192:193]
    v_cvt_pk_bf16_f32 v104, v194, v195
    v_lshlrev_b32 v194, 16, v105
    v_and_b32 v195, 0xffff0000, v105
    v_pk_add_f32 v[194:195], v[194:195], v[190:191]
    v_pk_fma_f32 v[192:193], v[194:195], v[194:195], v[192:193]
    v_cvt_pk_bf16_f32 v105, v194, v195
    v_lshlrev_b32 v194, 16, v106
    v_and_b32 v195, 0xffff0000, v106
    v_pk_add_f32 v[194:195], v[194:195], v[190:191]
    v_pk_fma_f32 v[192:193], v[194:195], v[194:195], v[192:193]
    v_cvt_pk_bf16_f32 v106, v194, v195
    v_lshlrev_b32 v194, 16, v107
    v_and_b32 v195, 0xffff0000, v107
    v_pk_add_f32 v[194:195], v[194:195], v[190:191]
    v_pk_fma_f32 v[192:193], v[194:195], v[194:195], v[192:193]
    v_cvt_pk_bf16_f32 v107, v194, v195
    v_lshlrev_b32 v194, 16, v108
    v_and_b32 v195, 0xffff0000, v108
    v_pk_add_f32 v[194:195], v[194:195], v[190:191]
    v_pk_fma_f32 v[192:193], v[194:195], v[194:195], v[192:193]
    v_cvt_pk_bf16_f32 v108, v194, v195
    v_lshlrev_b32 v194, 16, v109
    v_and_b32 v195, 0xffff0000, v109
    v_pk_add_f32 v[194:195], v[194:195], v[190:191]
    v_pk_fma_f32 v[192:193], v[194:195], v[194:195], v[192:193]
    v_cvt_pk_bf16_f32 v109, v194, v195
    v_lshlrev_b32 v194, 16, v110
    v_and_b32 v195, 0xffff0000, v110
    v_pk_add_f32 v[194:195], v[194:195], v[190:191]
    v_pk_fma_f32 v[192:193], v[194:195], v[194:195], v[192:193]
    v_cvt_pk_bf16_f32 v110, v194, v195
    v_lshlrev_b32 v194, 16, v111
    v_and_b32 v195, 0xffff0000, v111
    v_pk_add_f32 v[194:195], v[194:195], v[190:191]
    v_pk_fma_f32 v[192:193], v[194:195], v[194:195], v[192:193]
    v_cvt_pk_bf16_f32 v111, v194, v195
    v_add_f32 v192, v192, v193
    v_mov_b32 v187, v192
    s_nop 1
    v_permlane32_swap_b32 v187, v192
    s_nop 1
    v_add_f32 v192, v192, v187
    v_sub_f32 v187, v188, v189
    v_mul_f32 v187, v187, v187
    v_mul_f32 v192, 0x3b124925, v192
    v_sub_f32 v192, v192, v187
    v_cvt_pk_bf16_f32 v192, v192, v192
    v_lshlrev_b32 v192, 16, v192
    v_add_f32 v192, 0x3727c5ac, v192
    v_cvt_pk_bf16_f32 v192, v192, v192
    v_lshlrev_b32 v192, 16, v192
    v_sqrt_f32 v192, v192
    s_nop 0
    v_cvt_pk_bf16_f32 v192, v192, v192
    v_lshlrev_b32 v192, 16, v192
    v_rcp_f32 v207, v192
    s_nop 0
    s_waitcnt vmcnt(3)
    s_barrier
    s_add_u32 s42, s40, 0x54000
    s_add_u32 m0, s39, 24576
    buffer_load_dwordx4 v203, s[12:15], s42 offen lds
    s_add_u32 s42, s40, 0x54000
    s_add_u32 m0, s39, 28672
    buffer_load_dwordx4 v204, s[12:15], s42 offen lds
    s_add_u32 s42, s40, 0x54000
    s_add_u32 m0, s39, 32768
    buffer_load_dwordx4 v205, s[12:15], s42 offen lds
    ds_read_b64_tr_b16 v[160:161], v201 offset:0
    ds_read_b64_tr_b16 v[162:163], v201 offset:768
    ds_read_b64_tr_b16 v[164:165], v201 offset:64
    ds_read_b64_tr_b16 v[166:167], v201 offset:832
    ds_read_b64_tr_b16 v[168:169], v201 offset:128
    ds_read_b64_tr_b16 v[170:171], v201 offset:896
    ds_read_b64_tr_b16 v[172:173], v201 offset:3072
    ds_read_b64_tr_b16 v[174:175], v201 offset:3840
    ds_read_b64_tr_b16 v[176:177], v201 offset:3136
    ds_read_b64_tr_b16 v[178:179], v201 offset:3904
    ds_read_b64_tr_b16 v[180:181], v201 offset:3200
    ds_read_b64_tr_b16 v[182:183], v201 offset:3968
    s_waitcnt lgkmcnt(6)
    v_mfma_f32_32x32x16_bf16 v[112:127], v[160:163], v[0:3], 0
    v_mfma_f32_32x32x16_bf16 v[128:143], v[164:167], v[0:3], 0
    v_mfma_f32_32x32x16_bf16 v[144:159], v[168:171], v[0:3], 0
    ds_read_b64_tr_b16 v[160:161], v201 offset:6144
    ds_read_b64_tr_b16 v[162:163], v201 offset:6912
    ds_read_b64_tr_b16 v[164:165], v201 offset:6208
    ds_read_b64_tr_b16 v[166:167], v201 offset:6976
    ds_read_b64_tr_b16 v[168:169], v201 offset:6272
    ds_read_b64_tr_b16 v[170:171], v201 offset:7040
    s_waitcnt lgkmcnt(6)
    v_mfma_f32_32x32x16_bf16 v[112:127], v[172:175], v[4:7], v[112:127]
    v_mfma_f32_32x32x16_bf16 v[128:143], v[176:179], v[4:7], v[128:143]
    v_mfma_f32_32x32x16_bf16 v[144:159], v[180:183], v[4:7], v[144:159]
    ds_read_b64_tr_b16 v[172:173], v201 offset:9216
    ds_read_b64_tr_b16 v[174:175], v201 offset:9984
    ds_read_b64_tr_b16 v[176:177], v201 offset:9280
    ds_read_b64_tr_b16 v[178:179], v201 offset:10048
    ds_read_b64_tr_b16 v[180:181], v201 offset:9344
    ds_read_b64_tr_b16 v[182:183], v201 offset:10112
    s_waitcnt lgkmcnt(6)
    v_mfma_f32_32x32x16_bf16 v[112:127], v[160:163], v[8:11], v[112:127]
    v_mfma_f32_32x32x16_bf16 v[128:143], v[164:167], v[8:11], v[128:143]
    v_mfma_f32_32x32x16_bf16 v[144:159], v[168:171], v[8:11], v[144:159]
    s_waitcnt vmcnt(3)
    s_barrier
    s_add_u32 s42, s40, 0x7e000
    s_add_u32 m0, s39, 36864
    buffer_load_dwordx4 v203, s[12:15], s42 offen lds
    s_add_u32 s42, s40, 0x7e000
    s_add_u32 m0, s39, 40960
    buffer_load_dwordx4 v204, s[12:15], s42 offen lds
    s_add_u32 s42, s40, 0x7e000
    s_add_u32 m0, s39, 45056
    buffer_load_dwordx4 v205, s[12:15], s42 offen lds
    ds_read_b64_tr_b16 v[160:161], v201 offset:12288
    ds_read_b64_tr_b16 v[162:163], v201 offset:13056
    ds_read_b64_tr_b16 v[164:165], v201 offset:12352
    ds_read_b64_tr_b16 v[166:167], v201 offset:13120
    ds_read_b64_tr_b16 v[168:169], v201 offset:12416
    ds_read_b64_tr_b16 v[170:171], v201 offset:13184
    s_waitcnt lgkmcnt(6)
    v_mfma_f32_32x32x16_bf16 v[112:127], v[172:175], v[12:15], v[112:127]
    v_mfma_f32_32x32x16_bf16 v[128:143], v[176:179], v[12:15], v[128:143]
    v_mfma_f32_32x32x16_bf16 v[144:159], v[180:183], v[12:15], v[144:159]
    ds_read_b64_tr_b16 v[172:173], v201 offset:15360
    ds_read_b64_tr_b16 v[174:175], v201 offset:16128
    ds_read_b64_tr_b16 v[176:177], v201 offset:15424
    ds_read_b64_tr_b16 v[178:179], v201 offset:16192
    ds_read_b64_tr_b16 v[180:181], v201 offset:15488
    ds_read_b64_tr_b16 v[182:183], v201 offset:16256
    s_waitcnt lgkmcnt(6)
    v_mfma_f32_32x32x16_bf16 v[112:127], v[160:163], v[16:19], v[112:127]
    v_mfma_f32_32x32x16_bf16 v[128:143], v[164:167], v[16:19], v[128:143]
    v_mfma_f32_32x32x16_bf16 v[144:159], v[168:171], v[16:19], v[144:159]
    ds_read_b64_tr_b16 v[160:161], v201 offset:18432
    ds_read_b64_tr_b16 v[162:163], v201 offset:19200
    ds_read_b64_tr_b16 v[164:165], v201 offset:18496
    ds_read_b64_tr_b16 v[166:167], v201 offset:19264
    ds_read_b64_tr_b16 v[168:169], v201 offset:18560
    ds_read_b64_tr_b16 v[170:171], v201 offset:19328
    s_waitcnt lgkmcnt(6)
    v_mfma_f32_32x32x16_bf16 v[112:127], v[172:175], v[20:23], v[112:127]
    v_mfma_f32_32x32x16_bf16 v[128:143], v[176:179], v[20:23], v[128:143]
    v_mfma_f32_32x32x16_bf16 v[144:159], v[180:183], v[20:23], v[144:159]
    ds_read_b64_tr_b16 v[172:173], v201 offset:21504
    ds_read_b64_tr_b16 v[174:175], v201 offset:22272
    ds_read_b64_tr_b16 v[176:177], v201 offset:21568
    ds_read_b64_tr_b16 v[178:179], v201 offset:22336
    ds_read_b64_tr_b16 v[180:181], v201 offset:21632
    ds_read_b64_tr_b16 v[182:183], v201 offset:22400
    s_waitcnt lgkmcnt(6)
    v_mfma_f32_32x32x16_bf16 v[112:127], v[160:163], v[24:27], v[112:127]
    v_mfma_f32_32x32x16_bf16 v[128:143], v[164:167], v[24:27], v[128:143]
    v_mfma_f32_32x32x16_bf16 v[144:159], v[168:171], v[24:27], v[144:159]
    s_waitcnt vmcnt(3)
    s_barrier
    s_add_u32 s42, s40, 0xa8000
    s_add_u32 m0, s39, 0
    buffer_load_dwordx4 v203, s[12:15], s42 offen lds
    s_add_u32 s42, s40, 0xa8000
    s_add_u32 m0, s39, 4096
    buffer_load_dwordx4 v204, s[12:15], s42 offen lds
    s_add_u32 s42, s40, 0xa8000
    s_add_u32 m0, s39, 8192
    buffer_load_dwordx4 v205, s[12:15], s42 offen lds
    ds_read_b64_tr_b16 v[160:161], v201 offset:24576
    ds_read_b64_tr_b16 v[162:163], v201 offset:25344
    ds_read_b64_tr_b16 v[164:165], v201 offset:24640
    ds_read_b64_tr_b16 v[166:167], v201 offset:25408
    ds_read_b64_tr_b16 v[168:169], v201 offset:24704
    ds_read_b64_tr_b16 v[170:171], v201 offset:25472
    s_waitcnt lgkmcnt(6)
    v_mfma_f32_32x32x16_bf16 v[112:127], v[172:175], v[28:31], v[112:127]
    v_mfma_f32_32x32x16_bf16 v[128:143], v[176:179], v[28:31], v[128:143]
    v_mfma_f32_32x32x16_bf16 v[144:159], v[180:183], v[28:31], v[144:159]
    ds_read_b64_tr_b16 v[172:173], v201 offset:27648
    ds_read_b64_tr_b16 v[174:175], v201 offset:28416
    ds_read_b64_tr_b16 v[176:177], v201 offset:27712
    ds_read_b64_tr_b16 v[178:179], v201 offset:28480
    ds_read_b64_tr_b16 v[180:181], v201 offset:27776
    ds_read_b64_tr_b16 v[182:183], v201 offset:28544
    s_waitcnt lgkmcnt(6)
    v_mfma_f32_32x32x16_bf16 v[112:127], v[160:163], v[32:35], v[112:127]
    v_mfma_f32_32x32x16_bf16 v[128:143], v[164:167], v[32:35], v[128:143]
    v_mfma_f32_32x32x16_bf16 v[144:159], v[168:171], v[32:35], v[144:159]
    ds_read_b64_tr_b16 v[160:161], v201 offset:30720
    ds_read_b64_tr_b16 v[162:163], v201 offset:31488
    ds_read_b64_tr_b16 v[164:165], v201 offset:30784
    ds_read_b64_tr_b16 v[166:167], v201 offset:31552
    ds_read_b64_tr_b16 v[168:169], v201 offset:30848
    ds_read_b64_tr_b16 v[170:171], v201 offset:31616
    s_waitcnt lgkmcnt(6)
    v_mfma_f32_32x32x16_bf16 v[112:127], v[172:175], v[36:39], v[112:127]
    v_mfma_f32_32x32x16_bf16 v[128:143], v[176:179], v[36:39], v[128:143]
    v_mfma_f32_32x32x16_bf16 v[144:159], v[180:183], v[36:39], v[144:159]
    ds_read_b64_tr_b16 v[172:173], v201 offset:33792
    ds_read_b64_tr_b16 v[174:175], v201 offset:34560
    ds_read_b64_tr_b16 v[176:177], v201 offset:33856
    ds_read_b64_tr_b16 v[178:179], v201 offset:34624
    ds_read_b64_tr_b16 v[180:181], v201 offset:33920
    ds_read_b64_tr_b16 v[182:183], v201 offset:34688
    s_waitcnt lgkmcnt(6)
    v_mfma_f32_32x32x16_bf16 v[112:127], v[160:163], v[40:43], v[112:127]
    v_mfma_f32_32x32x16_bf16 v[128:143], v[164:167], v[40:43], v[128:143]
    v_mfma_f32_32x32x16_bf16 v[144:159], v[168:171], v[40:43], v[144:159]
    s_waitcnt vmcnt(3)
    s_barrier
    s_add_u32 s42, s40, 0xd2000
    s_add_u32 m0, s39, 12288
    buffer_load_dwordx4 v203, s[12:15], s42 offen lds
    s_add_u32 s42, s40, 0xd2000
    s_add_u32 m0, s39, 16384
    buffer_load_dwordx4 v204, s[12:15], s42 offen lds
    s_add_u32 s42, s40, 0xd2000
    s_add_u32 m0, s39, 20480
    buffer_load_dwordx4 v205, s[12:15], s42 offen lds
    ds_read_b64_tr_b16 v[160:161], v201 offset:36864
    ds_read_b64_tr_b16 v[162:163], v201 offset:37632
    ds_read_b64_tr_b16 v[164:165], v201 offset:36928
    ds_read_b64_tr_b16 v[166:167], v201 offset:37696
    ds_read_b64_tr_b16 v[168:169], v201 offset:36992
    ds_read_b64_tr_b16 v[170:171], v201 offset:37760
    s_waitcnt lgkmcnt(6)
    v_mfma_f32_32x32x16_bf16 v[112:127], v[172:175], v[44:47], v[112:127]
    v_mfma_f32_32x32x16_bf16 v[128:143], v[176:179], v[44:47], v[128:143]
    v_mfma_f32_32x32x16_bf16 v[144:159], v[180:183], v[44:47], v[144:159]
    ds_read_b64_tr_b16 v[172:173], v201 offset:39936
    ds_read_b64_tr_b16 v[174:175], v201 offset:40704
    ds_read_b64_tr_b16 v[176:177], v201 offset:40000
    ds_read_b64_tr_b16 v[178:179], v201 offset:40768
    ds_read_b64_tr_b16 v[180:181], v201 offset:40064
    ds_read_b64_tr_b16 v[182:183], v201 offset:40832
    s_waitcnt lgkmcnt(6)
    v_mfma_f32_32x32x16_bf16 v[112:127], v[160:163], v[48:51], v[112:127]
    v_mfma_f32_32x32x16_bf16 v[128:143], v[164:167], v[48:51], v[128:143]
    v_mfma_f32_32x32x16_bf16 v[144:159], v[168:171], v[48:51], v[144:159]
    ds_read_b64_tr_b16 v[160:161], v201 offset:43008
    ds_read_b64_tr_b16 v[162:163], v201 offset:43776
    ds_read_b64_tr_b16 v[164:165], v201 offset:43072
    ds_read_b64_tr_b16 v[166:167], v201 offset:43840
    ds_read_b64_tr_b16 v[168:169], v201 offset:43136
    ds_read_b64_tr_b16 v[170:171], v201 offset:43904
    s_waitcnt lgkmcnt(6)
    v_mfma_f32_32x32x16_bf16 v[112:127], v[172:175], v[52:55], v[112:127]
    v_mfma_f32_32x32x16_bf16 v[128:143], v[176:179], v[52:55], v[128:143]
    v_mfma_f32_32x32x16_bf16 v[144:159], v[180:183], v[52:55], v[144:159]
    ds_read_b64_tr_b16 v[172:173], v201 offset:46080
    ds_read_b64_tr_b16 v[174:175], v201 offset:46848
    ds_read_b64_tr_b16 v[176:177], v201 offset:46144
    ds_read_b64_tr_b16 v[178:179], v201 offset:46912
    ds_read_b64_tr_b16 v[180:181], v201 offset:46208
    ds_read_b64_tr_b16 v[182:183], v201 offset:46976
    s_waitcnt lgkmcnt(6)
    v_mfma_f32_32x32x16_bf16 v[112:127], v[160:163], v[56:59], v[112:127]
    v_mfma_f32_32x32x16_bf16 v[128:143], v[164:167], v[56:59], v[128:143]
    v_mfma_f32_32x32x16_bf16 v[144:159], v[168:171], v[56:59], v[144:159]
    s_waitcnt vmcnt(3)
    s_barrier
    s_add_u32 s42, s40, 0xfc000
    s_add_u32 m0, s39, 24576
    buffer_load_dwordx4 v203, s[12:15], s42 offen lds
    s_add_u32 s42, s40, 0xfc000
    s_add_u32 m0, s39, 28672
    buffer_load_dwordx4 v204, s[12:15], s42 offen lds
    s_add_u32 s42, s40, 0xfc000
    s_add_u32 m0, s39, 32768
    buffer_load_dwordx4 v205, s[12:15], s42 offen lds
    ds_read_b64_tr_b16 v[160:161], v201 offset:0
    ds_read_b64_tr_b16 v[162:163], v201 offset:768
    ds_read_b64_tr_b16 v[164:165], v201 offset:64
    ds_read_b64_tr_b16 v[166:167], v201 offset:832
    ds_read_b64_tr_b16 v[168:169], v201 offset:128
    ds_read_b64_tr_b16 v[170:171], v201 offset:896
    s_waitcnt lgkmcnt(6)
    v_mfma_f32_32x32x16_bf16 v[112:127], v[172:175], v[60:63], v[112:127]
    v_mfma_f32_32x32x16_bf16 v[128:143], v[176:179], v[60:63], v[128:143]
    v_mfma_f32_32x32x16_bf16 v[144:159], v[180:183], v[60:63], v[144:159]
    ds_read_b64_tr_b16 v[172:173], v201 offset:3072
    ds_read_b64_tr_b16 v[174:175], v201 offset:3840
    ds_read_b64_tr_b16 v[176:177], v201 offset:3136
    ds_read_b64_tr_b16 v[178:179], v201 offset:3904
    ds_read_b64_tr_b16 v[180:181], v201 offset:3200
    ds_read_b64_tr_b16 v[182:183], v201 offset:3968
    s_waitcnt lgkmcnt(6)
    v_mfma_f32_32x32x16_bf16 v[112:127], v[160:163], v[64:67], v[112:127]
    v_mfma_f32_32x32x16_bf16 v[128:143], v[164:167], v[64:67], v[128:143]
    v_mfma_f32_32x32x16_bf16 v[144:159], v[168:171], v[64:67], v[144:159]
    ds_read_b64_tr_b16 v[160:161], v201 offset:6144
    ds_read_b64_tr_b16 v[162:163], v201 offset:6912
    ds_read_b64_tr_b16 v[164:165], v201 offset:6208
    ds_read_b64_tr_b16 v[166:167], v201 offset:6976
    ds_read_b64_tr_b16 v[168:169], v201 offset:6272
    ds_read_b64_tr_b16 v[170:171], v201 offset:7040
    s_waitcnt lgkmcnt(6)
    v_mfma_f32_32x32x16_bf16 v[112:127], v[172:175], v[68:71], v[112:127]
    v_mfma_f32_32x32x16_bf16 v[128:143], v[176:179], v[68:71], v[128:143]
    v_mfma_f32_32x32x16_bf16 v[144:159], v[180:183], v[68:71], v[144:159]
    ds_read_b64_tr_b16 v[172:173], v201 offset:9216
    ds_read_b64_tr_b16 v[174:175], v201 offset:9984
    ds_read_b64_tr_b16 v[176:177], v201 offset:9280
    ds_read_b64_tr_b16 v[178:179], v201 offset:10048
    ds_read_b64_tr_b16 v[180:181], v201 offset:9344
    ds_read_b64_tr_b16 v[182:183], v201 offset:10112
    s_waitcnt lgkmcnt(6)
    v_mfma_f32_32x32x16_bf16 v[112:127], v[160:163], v[72:75], v[112:127]
    v_mfma_f32_32x32x16_bf16 v[128:143], v[164:167], v[72:75], v[128:143]
    v_mfma_f32_32x32x16_bf16 v[144:159], v[168:171], v[72:75], v[144:159]
    s_waitcnt vmcnt(3)
    s_barrier
    ds_read_b64_tr_b16 v[160:161], v201 offset:12288
    ds_read_b64_tr_b16 v[162:163], v201 offset:13056
    ds_read_b64_tr_b16 v[164:165], v201 offset:12352
    ds_read_b64_tr_b16 v[166:167], v201 offset:13120
    ds_read_b64_tr_b16 v[168:169], v201 offset:12416
    ds_read_b64_tr_b16 v[170:171], v201 offset:13184
    s_waitcnt lgkmcnt(6)
    v_mfma_f32_32x32x16_bf16 v[112:127], v[172:175], v[76:79], v[112:127]
    v_mfma_f32_32x32x16_bf16 v[128:143], v[176:179], v[76:79], v[128:143]
    v_mfma_f32_32x32x16_bf16 v[144:159], v[180:183], v[76:79], v[144:159]
    ds_read_b64_tr_b16 v[172:173], v201 offset:15360
    ds_read_b64_tr_b16 v[174:175], v201 offset:16128
    ds_read_b64_tr_b16 v[176:177], v201 offset:15424
    ds_read_b64_tr_b16 v[178:179], v201 offset:16192
    ds_read_b64_tr_b16 v[180:181], v201 offset:15488
    ds_read_b64_tr_b16 v[182:183], v201 offset:16256
    s_waitcnt lgkmcnt(6)
    v_mfma_f32_32x32x16_bf16 v[112:127], v[160:163], v[80:83], v[112:127]
    v_mfma_f32_32x32x16_bf16 v[128:143], v[164:167], v[80:83], v[128:143]
    v_mfma_f32_32x32x16_bf16 v[144:159], v[168:171], v[80:83], v[144:159]
    ds_read_b64_tr_b16 v[160:161], v201 offset:18432
    ds_read_b64_tr_b16 v[162:163], v201 offset:19200
    ds_read_b64_tr_b16 v[164:165], v201 offset:18496
    ds_read_b64_tr_b16 v[166:167], v201 offset:19264
    ds_read_b64_tr_b16 v[168:169], v201 offset:18560
    ds_read_b64_tr_b16 v[170:171], v201 offset:19328
    s_waitcnt lgkmcnt(6)
    v_mfma_f32_32x32x16_bf16 v[112:127], v[172:175], v[84:87], v[112:127]
    v_mfma_f32_32x32x16_bf16 v[128:143], v[176:179], v[84:87], v[128:143]
    v_mfma_f32_32x32x16_bf16 v[144:159], v[180:183], v[84:87], v[144:159]
    ds_read_b64_tr_b16 v[172:173], v201 offset:21504
    ds_read_b64_tr_b16 v[174:175], v201 offset:22272
    ds_read_b64_tr_b16 v[176:177], v201 offset:21568
    ds_read_b64_tr_b16 v[178:179], v201 offset:22336
    ds_read_b64_tr_b16 v[180:181], v201 offset:21632
    ds_read_b64_tr_b16 v[182:183], v201 offset:22400
    s_waitcnt lgkmcnt(6)
    v_mfma_f32_32x32x16_bf16 v[112:127], v[160:163], v[88:91], v[112:127]
    v_mfma_f32_32x32x16_bf16 v[128:143], v[164:167], v[88:91], v[128:143]
    v_mfma_f32_32x32x16_bf16 v[144:159], v[168:171], v[88:91], v[144:159]
    s_waitcnt vmcnt(0)
    s_barrier
    ds_read_b64_tr_b16 v[160:161], v201 offset:24576
    ds_read_b64_tr_b16 v[162:163], v201 offset:25344
    ds_read_b64_tr_b16 v[164:165], v201 offset:24640
    ds_read_b64_tr_b16 v[166:167], v201 offset:25408
    ds_read_b64_tr_b16 v[168:169], v201 offset:24704
    ds_read_b64_tr_b16 v[170:171], v201 offset:25472
    s_waitcnt lgkmcnt(6)
    v_mfma_f32_32x32x16_bf16 v[112:127], v[172:175], v[92:95], v[112:127]
    v_mfma_f32_32x32x16_bf16 v[128:143], v[176:179], v[92:95], v[128:143]
    v_mfma_f32_32x32x16_bf16 v[144:159], v[180:183], v[92:95], v[144:159]
    ds_read_b64_tr_b16 v[172:173], v201 offset:27648
    ds_read_b64_tr_b16 v[174:175], v201 offset:28416
    ds_read_b64_tr_b16 v[176:177], v201 offset:27712
    ds_read_b64_tr_b16 v[178:179], v201 offset:28480
    ds_read_b64_tr_b16 v[180:181], v201 offset:27776
    ds_read_b64_tr_b16 v[182:183], v201 offset:28544
    s_waitcnt lgkmcnt(6)
    v_mfma_f32_32x32x16_bf16 v[112:127], v[160:163], v[96:99], v[112:127]
    v_mfma_f32_32x32x16_bf16 v[128:143], v[164:167], v[96:99], v[128:143]
    v_mfma_f32_32x32x16_bf16 v[144:159], v[168:171], v[96:99], v[144:159]
    ds_read_b64_tr_b16 v[160:161], v201 offset:30720
    ds_read_b64_tr_b16 v[162:163], v201 offset:31488
    ds_read_b64_tr_b16 v[164:165], v201 offset:30784
    ds_read_b64_tr_b16 v[166:167], v201 offset:31552
    ds_read_b64_tr_b16 v[168:169], v201 offset:30848
    ds_read_b64_tr_b16 v[170:171], v201 offset:31616
    s_waitcnt lgkmcnt(6)
    v_mfma_f32_32x32x16_bf16 v[112:127], v[172:175], v[100:103], v[112:127]
    v_mfma_f32_32x32x16_bf16 v[128:143], v[176:179], v[100:103], v[128:143]
    v_mfma_f32_32x32x16_bf16 v[144:159], v[180:183], v[100:103], v[144:159]
    ds_read_b64_tr_b16 v[172:173], v201 offset:33792
    ds_read_b64_tr_b16 v[174:175], v201 offset:34560
    ds_read_b64_tr_b16 v[176:177], v201 offset:33856
    ds_read_b64_tr_b16 v[178:179], v201 offset:34624
    ds_read_b64_tr_b16 v[180:181], v201 offset:33920
    ds_read_b64_tr_b16 v[182:183], v201 offset:34688
    s_waitcnt lgkmcnt(6)
    v_mfma_f32_32x32x16_bf16 v[112:127], v[160:163], v[104:107], v[112:127]
    v_mfma_f32_32x32x16_bf16 v[128:143], v[164:167], v[104:107], v[128:143]
    v_mfma_f32_32x32x16_bf16 v[144:159], v[168:171], v[104:107], v[144:159]
    s_waitcnt lgkmcnt(0)
    v_mfma_f32_32x32x16_bf16 v[112:127], v[172:175], v[108:111], v[112:127]
    v_mfma_f32_32x32x16_bf16 v[128:143], v[176:179], v[108:111], v[128:143]
    v_mfma_f32_32x32x16_bf16 v[144:159], v[180:183], v[108:111], v[144:159]
    s_nop 15
    s_nop 3
    v_lshlrev_b32 v192, 6, v208
    v_lshrrev_b32 v212, 5, v200
    v_lshl_add_u32 v192, v212, 4, v192
    v_cmp_le_u32 vcc, 32, v200
    v_mul_f32 v112, v112, v207
    v_mul_f32 v113, v113, v207
    v_mul_f32 v114, v114, v207
    v_mul_f32 v115, v115, v207
    v_mul_f32 v116, v116, v207
    v_mul_f32 v117, v117, v207
    v_mul_f32 v118, v118, v207
    v_mul_f32 v119, v119, v207
    v_mul_f32 v120, v120, v207
    v_mul_f32 v121, v121, v207
    v_mul_f32 v122, v122, v207
    v_mul_f32 v123, v123, v207
    v_mul_f32 v124, v124, v207
    v_mul_f32 v125, v125, v207
    v_mul_f32 v126, v126, v207
    v_mul_f32 v127, v127, v207
    v_cvt_pk_bf16_f32 v184, v112, v113
    v_cvt_pk_bf16_f32 v185, v114, v115
    v_cvt_pk_bf16_f32 v186, v116, v117
    v_cvt_pk_bf16_f32 v187, v118, v119
    v_cvt_pk_bf16_f32 v188, v120, v121
    v_cvt_pk_bf16_f32 v189, v122, v123
    v_cvt_pk_bf16_f32 v190, v124, v125
    v_cvt_pk_bf16_f32 v191, v126, v127
    s_nop 1
    v_permlane32_swap_b32 v184, v186
    v_permlane32_swap_b32 v185, v187
    v_permlane32_swap_b32 v188, v190
    v_permlane32_swap_b32 v189, v191
    s_nop 1
    s_mul_i32 s41, s38, 3
    s_add_u32 s41, s41, 0
    s_cmp_ge_u32 s41, 32
    s_cselect_b32 s49, 0x3f80, 0
    s_lshl_b32 s41, s41, 17
    v_mov_b32 v212, s49
    v_mov_b32 v213, 0
    v_cndmask_b32 v190, v190, v212, vcc
    v_cndmask_b32 v191, v191, v213, vcc
    buffer_store_dwordx4 v[184:187], v192, s[20:23], s41 offen
    buffer_store_dwordx4 v[188:191], v192, s[20:23], s41 offen offset:32
    s_nop 1
    v_mul_f32 v128, v128, v207
    v_mul_f32 v129, v129, v207
    v_mul_f32 v130, v130, v207
    v_mul_f32 v131, v131, v207
    v_mul_f32 v132, v132, v207
    v_mul_f32 v133, v133, v207
    v_mul_f32 v134, v134, v207
    v_mul_f32 v135, v135, v207
    v_mul_f32 v136, v136, v207
    v_mul_f32 v137, v137, v207
    v_mul_f32 v138, v138, v207
    v_mul_f32 v139, v139, v207
    v_mul_f32 v140, v140, v207
    v_mul_f32 v141, v141, v207
    v_mul_f32 v142, v142, v207
    v_mul_f32 v143, v143, v207
    v_cvt_pk_bf16_f32 v184, v128, v129
    v_cvt_pk_bf16_f32 v185, v130, v131
    v_cvt_pk_bf16_f32 v186, v132, v133
    v_cvt_pk_bf16_f32 v187, v134, v135
    v_cvt_pk_bf16_f32 v188, v136, v137
    v_cvt_pk_bf16_f32 v189, v138, v139
    v_cvt_pk_bf16_f32 v190, v140, v141
    v_cvt_pk_bf16_f32 v191, v142, v143
    s_nop 1
    v_permlane32_swap_b32 v184, v186
    v_permlane32_swap_b32 v185, v187
    v_permlane32_swap_b32 v188, v190
    v_permlane32_swap_b32 v189, v191
    s_nop 1
    s_mul_i32 s41, s38, 3
    s_add_u32 s41, s41, 1
    s_cmp_ge_u32 s41, 32
    s_cselect_b32 s49, 0x3f80, 0
    s_lshl_b32 s41, s41, 17
    v_mov_b32 v212, s49
    v_mov_b32 v213, 0
    v_cndmask_b32 v190, v190, v212, vcc
    v_cndmask_b32 v191, v191, v213, vcc
    buffer_store_dwordx4 v[184:187], v192, s[20:23], s41 offen
    buffer_store_dwordx4 v[188:191], v192, s[20:23], s41 offen offset:32
    s_nop 1
    v_mul_f32 v144, v144, v207
    v_mul_f32 v145, v145, v207
    v_mul_f32 v146, v146, v207
    v_mul_f32 v147, v147, v207
    v_mul_f32 v148, v148, v207
    v_mul_f32 v149, v149, v207
    v_mul_f32 v150, v150, v207
    v_mul_f32 v151, v151, v207
    v_mul_f32 v152, v152, v207
    v_mul_f32 v153, v153, v207
    v_mul_f32 v154, v154, v207
    v_mul_f32 v155, v155, v207
    v_mul_f32 v156, v156, v207
    v_mul_f32 v157, v157, v207
    v_mul_f32 v158, v158, v207
    v_mul_f32 v159, v159, v207
    v_cvt_pk_bf16_f32 v184, v144, v145
    v_cvt_pk_bf16_f32 v185, v146, v147
    v_cvt_pk_bf16_f32 v186, v148, v149
    v_cvt_pk_bf16_f32 v187, v150, v151
    v_cvt_pk_bf16_f32 v188, v152, v153
    v_cvt_pk_bf16_f32 v189, v154, v155
    v_cvt_pk_bf16_f32 v190, v156, v157
    v_cvt_pk_bf16_f32 v191, v158, v159
    s_nop 1
    v_permlane32_swap_b32 v184, v186
    v_permlane32_swap_b32 v185, v187
    v_permlane32_swap_b32 v188, v190
    v_permlane32_swap_b32 v189, v191
    s_nop 1
    s_mul_i32 s41, s38, 3
    s_add_u32 s41, s41, 2
    s_cmp_ge_u32 s41, 32
    s_cselect_b32 s49, 0x3f80, 0
    s_lshl_b32 s41, s41, 17
    v_mov_b32 v212, s49
    v_mov_b32 v213, 0
    v_cndmask_b32 v190, v190, v212, vcc
    v_cndmask_b32 v191, v191, v213, vcc
    buffer_store_dwordx4 v[184:187], v192, s[20:23], s41 offen
    buffer_store_dwordx4 v[188:191], v192, s[20:23], s41 offen offset:32
    s_nop 1
    s_waitcnt vmcnt(0)
k_qkv2_kernel_end:
    s_endpgm

.globl k_oproj2_kernel
.p2align 8
.type k_oproj2_kernel,@function
k_oproj2_kernel:
    s_cmp_ge_u32 s2, 224
    s_cbranch_scc1 k_oproj2_kernel_end
    s_load_dwordx2 s[28:29], s[0:1], 72
    s_load_dwordx2 s[30:31], s[0:1], 16
    s_load_dwordx2 s[34:35], s[0:1], 72
    s_load_dwordx2 s[44:45], s[0:1], 72
    v_and_b32 v152, 63, v0
    v_lshrrev_b32 v136, 6, v0
    s_and_b32 s37, s2, 7
    s_lshl_b32 s37, s37, 1
    v_readfirstlane_b32 s36, v136
    s_lshr_b32 s38, s2, 3
    s_and_b32 s42, s38, 1
    s_add_u32 s37, s37, s42
    s_lshr_b32 s38, s38, 1
    s_waitcnt lgkmcnt(0)
    s_add_u32 s8, s28, 0x600000
    s_addc_u32 s9, s29, 0
    s_mov_b32 s10, 0x1c0000
    s_mov_b32 s11, 0x20000
    s_mov_b32 s12, s30
    s_mov_b32 s13, s31
    s_mov_b32 s14, 0x62000
    s_mov_b32 s15, 0x20000
    s_add_u32 s20, s34, 0x800000
    s_addc_u32 s21, s35, 0
    s_mov_b32 s22, 0x1c0000
    s_mov_b32 s23, 0x20000
    s_add_u32 s24, s44, 0x1200000
    s_addc_u32 s25, s45, 0
    s_mov_b32 s26, 0x1c0000
    s_mov_b32 s27, 0x20000
    s_lshl_b32 s48, s37, 2
    s_add_u32 s48, s48, s36
    s_lshl_b32 s42, s48, 5
    v_and_b32 v158, 31, v152
    v_add_u32 v158, s42, v158
    s_mul_i32 s42, s48, 28672
    v_lshlrev_b32 v156, 4, v152
    v_add_u32 v156, s42, v156
    buffer_load_dwordx4 v[0:3], v156, s[8:11], 0 offen offset:0
    buffer_load_dwordx4 v[4:7], v156, s[8:11], 0 offen offset:1024
    buffer_load_dwordx4 v[8:11], v156, s[8:11], 0 offen offset:2048
    buffer_load_dwordx4 v[12:15], v156, s[8:11], 0 offen offset:3072
    v_add_u32 v156, 4096, v156
    buffer_load_dwordx4 v[16:19], v156, s[8:11], 0 offen offset:0
    buffer_load_dwordx4 v[20:23], v156, s[8:11], 0 offen offset:1024
    buffer_load_dwordx4 v[24:27], v156, s[8:11], 0 offen offset:2048
    buffer_load_dwordx4 v[28:31], v156, s[8:11], 0 offen offset:3072
    v_add_u32 v156, 4096, v156
    buffer_load_dwordx4 v[32:35], v156, s[8:11], 0 offen offset:0
    buffer_load_dwordx4 v[36:39], v156, s[8:11], 0 offen offset:1024
    buffer_load_dwordx4 v[40:43], v156, s[8:11], 0 offen offset:2048
    buffer_load_dwordx4 v[44:47], v156, s[8:11], 0 offen offset:3072
    v_add_u32 v156, 4096, v156
    buffer_load_dwordx4 v[48:51], v156, s[8:11], 0 offen offset:0
    buffer_load_dwordx4 v[52:55], v156, s[8:11], 0 offen offset:1024
    buffer_load_dwordx4 v[56:59], v156, s[8:11], 0 offen offset:2048
    buffer_load_dwordx4 v[60:63], v156, s[8:11], 0 offen offset:3072
    v_add_u32 v156, 4096, v156
    buffer_load_dwordx4 v[64:67], v156, s[8:11], 0 offen offset:0
    buffer_load_dwordx4 v[68:71], v156, s[8:11], 0 offen offset:1024
    buffer_load_dwordx4 v[72:75], v156, s[8:11], 0 offen offset:2048
    buffer_load_dwordx4 v[76:79], v156, s[8:11], 0 offen offset:3072
    v_add_u32 v156, 4096, v156
    buffer_load_dwordx4 v[80:83], v156, s[8:11], 0 offen offset:0
    buffer_load_dwordx4 v[84:87], v156, s[8:11], 0 offen offset:1024
    buffer_load_dwordx4 v[88:91], v156, s[8:11], 0 offen offset:2048
    buffer_load_dwordx4 v[92:95], v156, s[8:11], 0 offen offset:3072
    v_add_u32 v156, 4096, v156
    buffer_load_dwordx4 v[96:99], v156, s[8:11], 0 offen offset:0
    buffer_load_dwordx4 v[100:103], v156, s[8:11], 0 offen offset:1024
    buffer_load_dwordx4 v[104:107], v156, s[8:11], 0 offen offset:2048
    buffer_load_dwordx4 v[108:111], v156, s[8:11], 0 offen offset:3072
    s_lshl_b32 s42, s36, 6
    v_add_u32 v155, s42, v152
    v_mul_u32_u24 v136, 64, v155
    v_lshrrev_b32 v136, 8, v136
    v_mul_u32_u24 v137, 4, v136
    v_sub_u32 v137, v155, v137
    v_mul_u32_u24 v155, 896, v136
    v_lshl_add_u32 v155, v137, 4, v155
    s_mul_i32 s43, s38, 32
    s_lshl_b32 s40, s43, 1
    s_lshl_b32 s39, s36, 10
    v_lshrrev_b32 v136, 5, v152
    v_lshlrev_b32 v136, 3, v136
    v_bfe_u32 v137, v152, 2, 2
    v_add_u32 v136, v136, v137
    v_mul_u32_u24 v153, 64, v136
    v_bfe_u32 v138, v152, 4, 1
    v_lshlrev_b32 v138, 5, v138
    v_and_b32 v139, 3, v152
    v_lshl_add_u32 v138, v139, 3, v138
    v_add_u32 v153, v153, v138
    s_add_u32 s42, s40, 0x0
    s_add_u32 m0, s39, 0
    buffer_load_dwordx4 v155, s[12:15], s42 offen lds
    s_add_u32 s42, s40, 0xe000
    s_add_u32 m0, s39, 4096
    buffer_load_dwordx4 v155, s[12:15], s42 offen lds
    s_waitcnt vmcnt(2)
    s_waitcnt vmcnt(1)
    s_barrier
    s_add_u32 s42, s40, 0x1c000
    s_add_u32 m0, s39, 8192
    buffer_load_dwordx4 v155, s[12:15], s42 offen lds
    ds_read_b64_tr_b16 v[128:129], v153 offset:0
    ds_read_b64_tr_b16 v[130:131], v153 offset:256
    ds_read_b64_tr_b16 v[132:133], v153 offset:1024
    ds_read_b64_tr_b16 v[134:135], v153 offset:1280
    s_waitcnt lgkmcnt(2)
    v_mfma_f32_32x32x16_bf16 v[112:127], v[128:131], v[0:3], 0
    ds_read_b64_tr_b16 v[128:129], v153 offset:2048
    ds_read_b64_tr_b16 v[130:131], v153 offset:2304
    s_waitcnt lgkmcnt(2)
    v_mfma_f32_32x32x16_bf16 v[112:127], v[132:135], v[4:7], v[112:127]
    ds_read_b64_tr_b16 v[132:133], v153 offset:3072
    ds_read_b64_tr_b16 v[134:135], v153 offset:3328
    s_waitcnt lgkmcnt(2)
    v_mfma_f32_32x32x16_bf16 v[112:127], v[128:131], v[8:11], v[112:127]
    s_waitcnt vmcnt(1)
    s_barrier
    s_add_u32 s42, s40, 0x2a000
    s_add_u32 m0, s39, 12288
    buffer_load_dwordx4 v155, s[12:15], s42 offen lds
    ds_read_b64_tr_b16 v[128:129], v153 offset:4096
    ds_read_b64_tr_b16 v[130:131], v153 offset:4352
    s_waitcnt lgkmcnt(2)
    v_mfma_f32_32x32x16_bf16 v[112:127], v[132:135], v[12:15], v[112:127]
    ds_read_b64_tr_b16 v[132:133], v153 offset:5120
    ds_read_b64_tr_b16 v[134:135], v153 offset:5376
    s_waitcnt lgkmcnt(2)
    v_mfma_f32_32x32x16_bf16 v[112:127], v[128:131], v[16:19], v[112:127]
    ds_read_b64_tr_b16 v[128:129], v153 offset:6144
    ds_read_b64_tr_b16 v[130:131], v153 offset:6400
    s_waitcnt lgkmcnt(2)
    v_mfma_f32_32x32x16_bf16 v[112:127], v[132:135], v[20:23], v[112:127]
    ds_read_b64_tr_b16 v[132:133], v153 offset:7168
    ds_read_b64_tr_b16 v[134:135], v153 offset:7424
    s_waitcnt lgkmcnt(2)
    v_mfma_f32_32x32x16_bf16 v[112:127], v[128:131], v[24:27], v[112:127]
    s_waitcnt vmcnt(1)
    s_barrier
    s_add_u32 s42, s40, 0x38000
    s_add_u32 m0, s39, 0
    buffer_load_dwordx4 v155, s[12:15], s42 offen lds
    ds_read_b64_tr_b16 v[128:129], v153 offset:8192
    ds_read_b64_tr_b16 v[130:131], v153 offset:8448
    s_waitcnt lgkmcnt(2)
    v_mfma_f32_32x32x16_bf16 v[112:127], v[132:135], v[28:31], v[112:127]
    ds_read_b64_tr_b16 v[132:133], v153 offset:9216
    ds_read_b64_tr_b16 v[134:135], v153 offset:9472
    s_waitcnt lgkmcnt(2)
    v_mfma_f32_32x32x16_bf16 v[112:127], v[128:131], v[32:35], v[112:127]
    ds_read_b64_tr_b16 v[128:129], v153 offset:10240
    ds_read_b64_tr_b16 v[130:131], v153 offset:10496
    s_waitcnt lgkmcnt(2)
    v_mfma_f32_32x32x16_bf16 v[112:127], v[132:135], v[36:39], v[112:127]
    ds_read_b64_tr_b16 v[132:133], v153 offset:11264
    ds_read_b64_tr_b16 v[134:135], v153 offset:11520
    s_waitcnt lgkmcnt(2)
    v_mfma_f32_32x32x16_bf16 v[112:127], v[128:131], v[40:43], v[112:127]
    s_waitcnt vmcnt(1)
    s_barrier
    s_add_u32 s42, s40, 0x46000
    s_add_u32 m0, s39, 4096
    buffer_load_dwordx4 v155, s[12:15], s42 offen lds
    ds_read_b64_tr_b16 v[128:129], v153 offset:12288
    ds_read_b64_tr_b16 v[130:131], v153 offset:12544
    s_waitcnt lgkmcnt(2)
    v_mfma_f32_32x32x16_bf16 v[112:127], v[132:135], v[44:47], v[112:127]
    ds_read_b64_tr_b16 v[132:133], v153 offset:13312
    ds_read_b64_tr_b16 v[134:135], v153 offset:13568
    s_waitcnt lgkmcnt(2)
    v_mfma_f32_32x32x16_bf16 v[112:127], v[128:131], v[48:51], v[112:127]
    ds_read_b64_tr_b16 v[128:129], v153 offset:14336
    ds_read_b64_tr_b16 v[130:131], v153 offset:14592
    s_waitcnt lgkmcnt(2)
    v_mfma_f32_32x32x16_bf16 v[112:127], v[132:135], v[52:55], v[112:127]
    ds_read_b64_tr_b16 v[132:133], v153 offset:15360
    ds_read_b64_tr_b16 v[134:135], v153 offset:15616
    s_waitcnt lgkmcnt(2)
    v_mfma_f32_32x32x16_bf16 v[112:127], v[128:131], v[56:59], v[112:127]
    s_waitcnt vmcnt(1)
    s_barrier
    s_add_u32 s42, s40, 0x54000
    s_add_u32 m0, s39, 8192
    buffer_load_dwordx4 v155, s[12:15], s42 offen lds
    ds_read_b64_tr_b16 v[128:129], v153 offset:0
    ds_read_b64_tr_b16 v[130:131], v153 offset:256
    s_waitcnt lgkmcnt(2)
    v_mfma_f32_32x32x16_bf16 v[112:127], v[132:135], v[60:63], v[112:127]
    ds_read_b64_tr_b16 v[132:133], v153 offset:1024
    ds_read_b64_tr_b16 v[134:135], v153 offset:1280
    s_waitcnt lgkmcnt(2)
    v_mfma_f32_32x32x16_bf16 v[112:127], v[128:131], v[64:67], v[112:127]
    ds_read_b64_tr_b16 v[128:129], v153 offset:2048
    ds_read_b64_tr_b16 v[130:131], v153 offset:2304
    s_waitcnt lgkmcnt(2)
    v_mfma_f32_32x32x16_bf16 v[112:127], v[132:135], v[68:71], v[112:127]
    ds_read_b64_tr_b16 v[132:133], v153 offset:3072
    ds_read_b64_tr_b16 v[134:135], v153 offset:3328
    s_waitcnt lgkmcnt(2)
    v_mfma_f32_32x32x16_bf16 v[112:127], v[128:131], v[72:75], v[112:127]
    s_waitcnt vmcnt(1)
    s_barrier
    ds_read_b64_tr_b16 v[128:129], v153 offset:4096
    ds_read_b64_tr_b16 v[130:131], v153 offset:4352
    s_waitcnt lgkmcnt(2)
    v_mfma_f32_32x32x16_bf16 v[112:127], v[132:135], v[76:79], v[112:127]
    ds_read_b64_tr_b16 v[132:133], v153 offset:5120
    ds_read_b64_tr_b16 v[134:135], v153 offset:5376
    s_waitcnt lgkmcnt(2)
    v_mfma_f32_32x32x16_bf16 v[112:127], v[128:131], v[80:83], v[112:127]
    ds_read_b64_tr_b16 v[128:129], v153 offset:6144
    ds_read_b64_tr_b16 v[130:131], v153 offset:6400
    s_waitcnt lgkmcnt(2)
    v_mfma_f32_32x32x16_bf16 v[112:127], v[132:135], v[84:87], v[112:127]
    ds_read_b64_tr_b16 v[132:133], v153 offset:7168
    ds_read_b64_tr_b16 v[134:135], v153 offset:7424
    s_waitcnt lgkmcnt(2)
    v_mfma_f32_32x32x16_bf16 v[112:127], v[128:131], v[88:91], v[112:127]
    s_waitcnt vmcnt(0)
    s_barrier
    ds_read_b64_tr_b16 v[128:129], v153 offset:8192
    ds_read_b64_tr_b16 v[130:131], v153 offset:8448
    s_waitcnt lgkmcnt(2)
    v_mfma_f32_32x32x16_bf16 v[112:127], v[132:135], v[92:95], v[112:127]
    ds_read_b64_tr_b16 v[132:133], v153 offset:9216
    ds_read_b64_tr_b16 v[134:135], v153 offset:9472
    s_waitcnt lgkmcnt(2)
    v_mfma_f32_32x32x16_bf16 v[112:127], v[128:131], v[96:99], v[112:127]
    ds_read_b64_tr_b16 v[128:129], v153 offset:10240
    ds_read_b64_tr_b16 v[130:131], v153 offset:10496
    s_waitcnt lgkmcnt(2)
    v_mfma_f32_32x32x16_bf16 v[112:127], v[132:135], v[100:103], v[112:127]
    ds_read_b64_tr_b16 v[132:133], v153 offset:11264
    ds_read_b64_tr_b16 v[134:135], v153 offset:11520
    s_waitcnt lgkmcnt(2)
    v_mfma_f32_32x32x16_bf16 v[112:127], v[128:131], v[104:107], v[112:127]
    s_waitcnt lgkmcnt(0)
    v_mfma_f32_32x32x16_bf16 v[112:127], v[132:135], v[108:111], v[112:127]
    s_nop 15
    s_nop 3
    s_mul_i32 s41, s48, 28
    s_lshr_b32 s49, s43, 4
    s_add_u32 s41, s41, s49
    s_lshl_b32 s41, s41, 10
    v_lshlrev_b32 v144, 4, v152
    v_add_u32 v144, s41, v144
    buffer_load_dwordx4 v[160:163], v144, s[24:27], 0 offen offset:0
    buffer_load_dwordx4 v[164:167], v144, s[24:27], 0 offen offset:1024
    v_cvt_pk_bf16_f32 v136, v112, v113
    v_cvt_pk_bf16_f32 v137, v114, v115
    v_cvt_pk_bf16_f32 v138, v116, v117
    v_cvt_pk_bf16_f32 v139, v118, v119
    v_cvt_pk_bf16_f32 v140, v120, v121
    v_cvt_pk_bf16_f32 v141, v122, v123
    v_cvt_pk_bf16_f32 v142, v124, v125
    v_cvt_pk_bf16_f32 v143, v126, v127
    s_nop 1
    v_permlane32_swap_b32 v136, v138
    v_permlane32_swap_b32 v137, v139
    v_permlane32_swap_b32 v140, v142
    v_permlane32_swap_b32 v141, v143
    s_nop 1
    s_waitcnt vmcnt(1)
    v_lshlrev_b32 v112, 16, v136
    v_and_b32 v113, 0xffff0000, v136
    v_lshlrev_b32 v114, 16, v160
    v_and_b32 v115, 0xffff0000, v160
    v_add_f32 v112, v112, v114
    v_add_f32 v113, v113, v115
    v_cvt_pk_bf16_f32 v136, v112, v113
    v_lshlrev_b32 v112, 16, v137
    v_and_b32 v113, 0xffff0000, v137
    v_lshlrev_b32 v114, 16, v161
    v_and_b32 v115, 0xffff0000, v161
    v_add_f32 v112, v112, v114
    v_add_f32 v113, v113, v115
    v_cvt_pk_bf16_f32 v137, v112, v113
    v_lshlrev_b32 v112, 16, v138
    v_and_b32 v113, 0xffff0000, v138
    v_lshlrev_b32 v114, 16, v162
    v_and_b32 v115, 0xffff0000, v162
    v_add_f32 v112, v112, v114
    v_add_f32 v113, v113, v115
    v_cvt_pk_bf16_f32 v138, v112, v113
    v_lshlrev_b32 v112, 16, v139
    v_and_b32 v113, 0xffff0000, v139
    v_lshlrev_b32 v114, 16, v163
    v_and_b32 v115, 0xffff0000, v163
    v_add_f32 v112, v112, v114
    v_add_f32 v113, v113, v115
    v_cvt_pk_bf16_f32 v139, v112, v113
    buffer_store_dwordx4 v[136:139], v144, s[20:23], 0 offen offset:0
    s_waitcnt vmcnt(1)
    v_lshlrev_b32 v112, 16, v140
    v_and_b32 v113, 0xffff0000, v140
    v_lshlrev_b32 v114, 16, v164
    v_and_b32 v115, 0xffff0000, v164
    v_add_f32 v112, v112, v114
    v_add_f32 v113, v113, v115
    v_cvt_pk_bf16_f32 v140, v112, v113
    v_lshlrev_b32 v112, 16, v141
    v_and_b32 v113, 0xffff0000, v141
    v_lshlrev_b32 v114, 16, v165
    v_and_b32 v115, 0xffff0000, v165
    v_add_f32 v112, v112, v114
    v_add_f32 v113, v113, v115
    v_cvt_pk_bf16_f32 v141, v112, v113
    v_lshlrev_b32 v112, 16, v142
    v_and_b32 v113, 0xffff0000, v142
    v_lshlrev_b32 v114, 16, v166
    v_and_b32 v115, 0xffff0000, v166
    v_add_f32 v112, v112, v114
    v_add_f32 v113, v113, v115
    v_cvt_pk_bf16_f32 v142, v112, v113
    v_lshlrev_b32 v112, 16, v143
    v_and_b32 v113, 0xffff0000, v143
    v_lshlrev_b32 v114, 16, v167
    v_and_b32 v115, 0xffff0000, v167
    v_add_f32 v112, v112, v114
    v_add_f32 v113, v113, v115
    v_cvt_pk_bf16_f32 v143, v112, v113
    buffer_store_dwordx4 v[140:143], v144, s[20:23], 0 offen offset:1024
    s_nop 1
    s_waitcnt vmcnt(0)
k_oproj2_kernel_end:
    s_endpgm

.globl k_down2_kernel
.p2align 8
.type k_down2_kernel,@function
k_down2_kernel:
    s_cmp_ge_u32 s2, 224
    s_cbranch_scc1 k_down2_kernel_end
    s_load_dwordx2 s[28:29], s[0:1], 48
    s_load_dwordx2 s[30:31], s[0:1], 72
    s_load_dwordx2 s[32:33], s[0:1], 56
    v_and_b32 v128, 63, v0
    v_lshrrev_b32 v112, 6, v0
    s_and_b32 s37, s2, 7
    s_lshl_b32 s37, s37, 2
    v_readfirstlane_b32 s36, v112
    s_lshr_b32 s38, s2, 3
    s_and_b32 s42, s38, 3
    s_add_u32 s37, s37, s42
    s_lshr_b32 s38, s38, 2
    s_waitcnt lgkmcnt(0)
    s_add_u32 s8, s30, 0xa00000
    s_addc_u32 s9, s31, 0
    s_mov_b32 s10, 0x700000
    s_mov_b32 s11, 0x20000
    s_mov_b32 s12, s28
    s_mov_b32 s13, s29
    s_mov_b32 s14, 0x188000
    s_mov_b32 s15, 0x20000
    s_mov_b32 s20, s32
    s_mov_b32 s21, s33
    s_mov_b32 s22, 0x1c0000
    s_mov_b32 s23, 0x20000
    s_add_u32 s24, s30, 0x800000
    s_addc_u32 s25, s31, 0
    s_mov_b32 s26, 0x1c0000
    s_mov_b32 s27, 0x20000
    s_lshl_b32 s48, s37, 1
    s_and_b32 s42, s36, 1
    s_add_u32 s48, s48, s42
    s_lshl_b32 s42, s48, 5
    v_and_b32 v136, 31, v128
    v_add_u32 v136, s42, v136
    s_mul_i32 s42, s48, 112
    s_lshr_b32 s49, s36, 1
    s_mul_i32 s41, s49, 56
    s_add_u32 s42, s42, s41
    s_lshl_b32 s42, s42, 10
    v_lshlrev_b32 v135, 4, v128
    v_add_u32 v135, s42, v135
    s_lshl_b32 s42, s36, 6
    v_add_u32 v131, s42, v128
    v_lshrrev_b32 v112, 3, v131
    v_and_b32 v113, 7, v131
    v_bfe_u32 v114, v112, 1, 1
    v_lshlrev_b32 v114, 2, v114
    v_xor_b32 v113, v113, v114
    v_mul_u32_u24 v131, 896, v112
    v_lshl_add_u32 v131, v113, 4, v131
    v_add_u32 v132, s42, v128
    v_add_u32 v132, 256, v132
    v_lshrrev_b32 v112, 3, v132
    v_and_b32 v113, 7, v132
    v_bfe_u32 v114, v112, 1, 1
    v_lshlrev_b32 v114, 2, v114
    v_xor_b32 v113, v113, v114
    v_mul_u32_u24 v132, 896, v112
    v_lshl_add_u32 v132, v113, 4, v132
    v_add_u32 v133, s42, v128
    v_lshrrev_b32 v112, 3, v133
    v_and_b32 v113, 7, v133
    v_bfe_u32 v114, v112, 1, 1
    v_lshlrev_b32 v114, 2, v114
    v_xor_b32 v113, v113, v114
    v_mul_u32_u24 v133, 896, v112
    v_lshl_add_u32 v133, v113, 4, v133
    v_add_u32 v133, 0xc4000, v133
    v_add_u32 v134, s42, v128
    v_add_u32 v134, 256, v134
    v_lshrrev_b32 v112, 3, v134
    v_and_b32 v113, 7, v134
    v_bfe_u32 v114, v112, 1, 1
    v_lshlrev_b32 v114, 2, v114
    v_xor_b32 v113, v113, v114
    v_mul_u32_u24 v134, 896, v112
    v_lshl_add_u32 v134, v113, 4, v134
    v_add_u32 v134, 0xc4000, v134
    s_lshl_b32 s43, s38, 6
    s_lshl_b32 s40, s43, 1
    s_lshl_b32 s39, s36, 10
    v_lshrrev_b32 v112, 5, v128
    v_lshlrev_b32 v112, 3, v112
    v_bfe_u32 v113, v128, 2, 2
    v_add_u32 v112, v112, v113
    v_mul_u32_u24 v129, 128, v112
    s_lshl_b32 s49, s49, 13
    v_add_u32 v129, s49, v129
    v_bfe_u32 v114, v128, 4, 1
    v_lshlrev_b32 v114, 5, v114
    v_and_b32 v115, 3, v128
    v_lshl_add_u32 v114, v115, 3, v114
    v_bfe_u32 v115, v128, 3, 1
    v_lshlrev_b32 v115, 6, v115
    v_add3_u32 v130, v129, v114, v115
    v_sub_u32 v115, v114, v115
    v_add_u32 v129, v129, v115
    s_add_u32 s42, s40, 0x0
    s_add_u32 m0, s39, 0
    buffer_load_dwordx4 v131, s[12:15], s42 offen lds
    s_add_u32 s42, s40, 0x0
    s_add_u32 m0, s39, 4096
    buffer_load_dwordx4 v132, s[12:15], s42 offen lds
    s_add_u32 s42, s40, 0x0
    s_add_u32 m0, s39, 8192
    buffer_load_dwordx4 v133, s[12:15], s42 offen lds
    s_add_u32 s42, s40, 0x0
    s_add_u32 m0, s39, 12288
    buffer_load_dwordx4 v134, s[12:15], s42 offen lds
    s_mov_b32 s41, 0x0
    buffer_load_dwordx4 v[32:35], v135, s[8:11], s41 offen offset:0
    s_mov_b32 s41, 0x0
    buffer_load_dwordx4 v[36:39], v135, s[8:11], s41 offen offset:1024
    s_mov_b32 s41, 0x0
    buffer_load_dwordx4 v[40:43], v135, s[8:11], s41 offen offset:2048
    s_mov_b32 s41, 0x0
    buffer_load_dwordx4 v[44:47], v135, s[8:11], s41 offen offset:3072
    s_add_u32 s42, s40, 0xe000
    s_add_u32 m0, s39, 16384
    buffer_load_dwordx4 v131, s[12:15], s42 offen lds
    s_add_u32 s42, s40, 0xe000
    s_add_u32 m0, s39, 20480
    buffer_load_dwordx4 v132, s[12:15], s42 offen lds
    s_add_u32 s42, s40, 0xe000
    s_add_u32 m0, s39, 24576
    buffer_load_dwordx4 v133, s[12:15], s42 offen lds
    s_add_u32 s42, s40, 0xe000
    s_add_u32 m0, s39, 28672
    buffer_load_dwordx4 v134, s[12:15], s42 offen lds
    s_mov_b32 s41, 0x1000
    buffer_load_dwordx4 v[48:51], v135, s[8:11], s41 offen offset:0
    s_mov_b32 s41, 0x1000
    buffer_load_dwordx4 v[52:55], v135, s[8:11], s41 offen offset:1024
    s_mov_b32 s41, 0x1000
    buffer_load_dwordx4 v[56:59], v135, s[8:11], s41 offen offset:2048
    s_mov_b32 s41, 0x1000
    buffer_load_dwordx4 v[60:63], v135, s[8:11], s41 offen offset:3072
    s_waitcnt vmcnt(12)
    s_barrier
    s_add_u32 s42, s40, 0x1c000
    s_add_u32 m0, s39, 32768
    buffer_load_dwordx4 v131, s[12:15], s42 offen lds
    s_add_u32 s42, s40, 0x1c000
    s_add_u32 m0, s39, 36864
    buffer_load_dwordx4 v132, s[12:15], s42 offen lds
    s_add_u32 s42, s40, 0x1c000
    s_add_u32 m0, s39, 40960
    buffer_load_dwordx4 v133, s[12:15], s42 offen lds
    s_add_u32 s42, s40, 0x1c000
    s_add_u32 m0, s39, 45056
    buffer_load_dwordx4 v134, s[12:15], s42 offen lds
    s_mov_b32 s41, 0x2000
    buffer_load_dwordx4 v[64:67], v135, s[8:11], s41 offen offset:0
    s_mov_b32 s41, 0x2000
    buffer_load_dwordx4 v[68:71], v135, s[8:11], s41 offen offset:1024
    s_mov_b32 s41, 0x2000
    buffer_load_dwordx4 v[72:75], v135, s[8:11], s41 offen offset:2048
    s_mov_b32 s41, 0x2000
    buffer_load_dwordx4 v[76:79], v135, s[8:11], s41 offen offset:3072
    ds_read_b64_tr_b16 v[96:97], v130 offset:0
    ds_read_b64_tr_b16 v[98:99], v130 offset:512
    ds_read_b64_tr_b16 v[100:101], v129 offset:64
    ds_read_b64_tr_b16 v[102:103], v129 offset:576
    ds_read_b64_tr_b16 v[104:105], v130 offset:2048
    ds_read_b64_tr_b16 v[106:107], v130 offset:2560
    ds_read_b64_tr_b16 v[108:109], v129 offset:2112
    ds_read_b64_tr_b16 v[110:111], v129 offset:2624
    s_waitcnt vmcnt(16)
    s_waitcnt lgkmcnt(4)
    v_mfma_f32_32x32x16_bf16 v[0:15], v[96:99], v[32:35], 0
    v_mfma_f32_32x32x16_bf16 v[16:31], v[100:103], v[32:35], 0
    ds_read_b64_tr_b16 v[96:97], v130 offset:4096
    ds_read_b64_tr_b16 v[98:99], v130 offset:4608
    ds_read_b64_tr_b16 v[100:101], v129 offset:4160
    ds_read_b64_tr_b16 v[102:103], v129 offset:4672
    s_waitcnt lgkmcnt(4)
    v_mfma_f32_32x32x16_bf16 v[0:15], v[104:107], v[36:39], v[0:15]
    v_mfma_f32_32x32x16_bf16 v[16:31], v[108:111], v[36:39], v[16:31]
    ds_read_b64_tr_b16 v[104:105], v130 offset:6144
    ds_read_b64_tr_b16 v[106:107], v130 offset:6656
    ds_read_b64_tr_b16 v[108:109], v129 offset:6208
    ds_read_b64_tr_b16 v[110:111], v129 offset:6720
    s_waitcnt lgkmcnt(4)
    v_mfma_f32_32x32x16_bf16 v[0:15], v[96:99], v[40:43], v[0:15]
    v_mfma_f32_32x32x16_bf16 v[16:31], v[100:103], v[40:43], v[16:31]
    s_waitcnt vmcnt(12)
    s_barrier
    s_add_u32 s42, s40, 0x2a000
    s_add_u32 m0, s39, 49152
    buffer_load_dwordx4 v131, s[12:15], s42 offen lds
    s_add_u32 s42, s40, 0x2a000
    s_add_u32 m0, s39, 53248
    buffer_load_dwordx4 v132, s[12:15], s42 offen lds
    s_add_u32 s42, s40, 0x2a000
    s_add_u32 m0, s39, 57344
    buffer_load_dwordx4 v133, s[12:15], s42 offen lds
    s_add_u32 s42, s40, 0x2a000
    s_add_u32 m0, s39, 61440
    buffer_load_dwordx4 v134, s[12:15], s42 offen lds
    s_mov_b32 s41, 0x3000
    buffer_load_dwordx4 v[80:83], v135, s[8:11], s41 offen offset:0
    s_mov_b32 s41, 0x3000
    buffer_load_dwordx4 v[84:87], v135, s[8:11], s41 offen offset:1024
    s_mov_b32 s41, 0x3000
    buffer_load_dwordx4 v[88:91], v135, s[8:11], s41 offen offset:2048
    s_mov_b32 s41, 0x3000
    buffer_load_dwordx4 v[92:95], v135, s[8:11], s41 offen offset:3072
    ds_read_b64_tr_b16 v[96:97], v130 offset:16384
    ds_read_b64_tr_b16 v[98:99], v130 offset:16896
    ds_read_b64_tr_b16 v[100:101], v129 offset:16448
    ds_read_b64_tr_b16 v[102:103], v129 offset:16960
    s_waitcnt lgkmcnt(4)
    v_mfma_f32_32x32x16_bf16 v[0:15], v[104:107], v[44:47], v[0:15]
    v_mfma_f32_32x32x16_bf16 v[16:31], v[108:111], v[44:47], v[16:31]
    ds_read_b64_tr_b16 v[104:105], v130 offset:18432
    ds_read_b64_tr_b16 v[106:107], v130 offset:18944
    ds_read_b64_tr_b16 v[108:109], v129 offset:18496
    ds_read_b64_tr_b16 v[110:111], v129 offset:19008
    s_waitcnt vmcnt(16)
    s_waitcnt lgkmcnt(4)
    v_mfma_f32_32x32x16_bf16 v[0:15], v[96:99], v[48:51], v[0:15]
    v_mfma_f32_32x32x16_bf16 v[16:31], v[100:103], v[48:51], v[16:31]
    ds_read_b64_tr_b16 v[96:97], v130 offset:20480
    ds_read_b64_tr_b16 v[98:99], v130 offset:20992
    ds_read_b64_tr_b16 v[100:101], v129 offset:20544
    ds_read_b64_tr_b16 v[102:103], v129 offset:21056
    s_waitcnt lgkmcnt(4)
    v_mfma_f32_32x32x16_bf16 v[0:15], v[104:107], v[52:55], v[0:15]
    v_mfma_f32_32x32x16_bf16 v[16:31], v[108:111], v[52:55], v[16:31]
    ds_read_b64_tr_b16 v[104:105], v130 offset:22528
    ds_read_b64_tr_b16 v[106:107], v130 offset:23040
    ds_read_b64_tr_b16 v[108:109], v129 offset:22592
    ds_read_b64_tr_b16 v[110:111], v129 offset:23104
    s_waitcnt lgkmcnt(4)
    v_mfma_f32_32x32x16_bf16 v[0:15], v[96:99], v[56:59], v[0:15]
    v_mfma_f32_32x32x16_bf16 v[16:31], v[100:103], v[56:59], v[16:31]
    s_waitcnt vmcnt(12)
    s_barrier
    s_add_u32 s42, s40, 0x38000
    s_add_u32 m0, s39, 0
    buffer_load_dwordx4 v131, s[12:15], s42 offen lds
    s_add_u32 s42, s40, 0x38000
    s_add_u32 m0, s39, 4096
    buffer_load_dwordx4 v132, s[12:15], s42 offen lds
    s_add_u32 s42, s40, 0x38000
    s_add_u32 m0, s39, 8192
    buffer_load_dwordx4 v133, s[12:15], s42 offen lds
    s_add_u32 s42, s40, 0x38000
    s_add_u32 m0, s39, 12288
    buffer_load_dwordx4 v134, s[12:15], s42 offen lds
    s_mov_b32 s41, 0x4000
    buffer_load_dwordx4 v[32:35], v135, s[8:11], s41 offen offset:0
    s_mov_b32 s41, 0x4000
    buffer_load_dwordx4 v[36:39], v135, s[8:11], s41 offen offset:1024
    s_mov_b32 s41, 0x4000
    buffer_load_dwordx4 v[40:43], v135, s[8:11], s41 offen offset:2048
    s_mov_b32 s41, 0x4000
    buffer_load_dwordx4 v[44:47], v135, s[8:11], s41 offen offset:3072
    ds_read_b64_tr_b16 v[96:97], v130 offset:32768
    ds_read_b64_tr_b16 v[98:99], v130 offset:33280
    ds_read_b64_tr_b16 v[100:101], v129 offset:32832
    ds_read_b64_tr_b16 v[102:103], v129 offset:33344
    s_waitcnt lgkmcnt(4)
    v_mfma_f32_32x32x16_bf16 v[0:15], v[104:107], v[60:63], v[0:15]
    v_mfma_f32_32x32x16_bf16 v[16:31], v[108:111], v[60:63], v[16:31]
    ds_read_b64_tr_b16 v[104:105], v130 offset:34816
    ds_read_b64_tr_b16 v[106:107], v130 offset:35328
    ds_read_b64_tr_b16 v[108:109], v129 offset:34880
    ds_read_b64_tr_b16 v[110:111], v129 offset:35392
    s_waitcnt vmcnt(16)
    s_waitcnt lgkmcnt(4)
    v_mfma_f32_32x32x16_bf16 v[0:15], v[96:99], v[64:67], v[0:15]
    v_mfma_f32_32x32x16_bf16 v[16:31], v[100:103], v[64:67], v[16:31]
    ds_read_b64_tr_b16 v[96:97], v130 offset:36864
    ds_read_b64_tr_b16 v[98:99], v130 offset:37376
    ds_read_b64_tr_b16 v[100:101], v129 offset:36928
    ds_read_b64_tr_b16 v[102:103], v129 offset:37440
    s_waitcnt lgkmcnt(4)
    v_mfma_f32_32x32x16_bf16 v[0:15], v[104:107], v[68:71], v[0:15]
    v_mfma_f32_32x32x16_bf16 v[16:31], v[108:111], v[68:71], v[16:31]
    ds_read_b64_tr_b16 v[104:105], v130 offset:38912
    ds_read_b64_tr_b16 v[106:107], v130 offset:39424
    ds_read_b64_tr_b16 v[108:109], v129 offset:38976
    ds_read_b64_tr_b16 v[110:111], v129 offset:39488
    s_waitcnt lgkmcnt(4)
    v_mfma_f32_32x32x16_bf16 v[0:15], v[96:99], v[72:75], v[0:15]
    v_mfma_f32_32x32x16_bf16 v[16:31], v[100:103], v[72:75], v[16:31]
    s_waitcnt vmcnt(12)
    s_barrier
    s_add_u32 s42, s40, 0x46000
    s_add_u32 m0, s39, 16384
    buffer_load_dwordx4 v131, s[12:15], s42 offen lds
    s_add_u32 s42, s40, 0x46000
    s_add_u32 m0, s39, 20480
    buffer_load_dwordx4 v132, s[12:15], s42 offen lds
    s_add_u32 s42, s40, 0x46000
    s_add_u32 m0, s39, 24576
    buffer_load_dwordx4 v133, s[12:15], s42 offen lds
    s_add_u32 s42, s40, 0x46000
    s_add_u32 m0, s39, 28672
    buffer_load_dwordx4 v134, s[12:15], s42 offen lds
    s_mov_b32 s41, 0x5000
    buffer_load_dwordx4 v[48:51], v135, s[8:11], s41 offen offset:0
    s_mov_b32 s41, 0x5000
    buffer_load_dwordx4 v[52:55], v135, s[8:11], s41 offen offset:1024
    s_mov_b32 s41, 0x5000
    buffer_load_dwordx4 v[56:59], v135, s[8:11], s41 offen offset:2048
    s_mov_b32 s41, 0x5000
    buffer_load_dwordx4 v[60:63], v135, s[8:11], s41 offen offset:3072
    ds_read_b64_tr_b16 v[96:97], v130 offset:49152
    ds_read_b64_tr_b16 v[98:99], v130 offset:49664
    ds_read_b64_tr_b16 v[100:101], v129 offset:49216
    ds_read_b64_tr_b16 v[102:103], v129 offset:49728
    s_waitcnt lgkmcnt(4)
    v_mfma_f32_32x32x16_bf16 v[0:15], v[104:107], v[76:79], v[0:15]
    v_mfma_f32_32x32x16_bf16 v[16:31], v[108:111], v[76:79], v[16:31]
    ds_read_b64_tr_b16 v[104:105], v130 offset:51200
    ds_read_b64_tr_b16 v[106:107], v130 offset:51712
    ds_read_b64_tr_b16 v[108:109], v129 offset:51264
    ds_read_b64_tr_b16 v[110:111], v129 offset:51776
    s_waitcnt vmcnt(16)
    s_waitcnt lgkmcnt(4)
    v_mfma_f32_32x32x16_bf16 v[0:15], v[96:99], v[80:83], v[0:15]
    v_mfma_f32_32x32x16_bf16 v[16:31], v[100:103], v[80:83], v[16:31]
    ds_read_b64_tr_b16 v[96:97], v130 offset:53248
    ds_read_b64_tr_b16 v[98:99], v130 offset:53760
    ds_read_b64_tr_b16 v[100:101], v129 offset:53312
    ds_read_b64_tr_b16 v[102:103], v129 offset:53824
    s_waitcnt lgkmcnt(4)
    v_mfma_f32_32x32x16_bf16 v[0:15], v[104:107], v[84:87], v[0:15]
    v_mfma_f32_32x32x16_bf16 v[16:31], v[108:111], v[84:87], v[16:31]
    ds_read_b64_tr_b16 v[104:105], v130 offset:55296
    ds_read_b64_tr_b16 v[106:107], v130 offset:55808
    ds_read_b64_tr_b16 v[108:109], v129 offset:55360
    ds_read_b64_tr_b16 v[110:111], v129 offset:55872
    s_waitcnt lgkmcnt(4)
    v_mfma_f32_32x32x16_bf16 v[0:15], v[96:99], v[88:91], v[0:15]
    v_mfma_f32_32x32x16_bf16 v[16:31], v[100:103], v[88:91], v[16:31]
    s_waitcnt vmcnt(12)
    s_barrier
    s_add_u32 s42, s40, 0x54000
    s_add_u32 m0, s39, 32768
    buffer_load_dwordx4 v131, s[12:15], s42 offen lds
    s_add_u32 s42, s40, 0x54000
    s_add_u32 m0, s39, 36864
    buffer_load_dwordx4 v132, s[12:15], s42 offen lds
    s_add_u32 s42, s40, 0x54000
    s_add_u32 m0, s39, 40960
    buffer_load_dwordx4 v133, s[12:15], s42 offen lds
    s_add_u32 s42, s40, 0x54000
    s_add_u32 m0, s39, 45056
    buffer_load_dwordx4 v134, s[12:15], s42 offen lds
    s_mov_b32 s41, 0x6000
    buffer_load_dwordx4 v[64:67], v135, s[8:11], s41 offen offset:0
    s_mov_b32 s41, 0x6000
    buffer_load_dwordx4 v[68:71], v135, s[8:11], s41 offen offset:1024
    s_mov_b32 s41, 0x6000
    buffer_load_dwordx4 v[72:75], v135, s[8:11], s41 offen offset:2048
    s_mov_b32 s41, 0x6000
    buffer_load_dwordx4 v[76:79], v135, s[8:11], s41 offen offset:3072
    ds_read_b64_tr_b16 v[96:97], v130 offset:0
    ds_read_b64_tr_b16 v[98:99], v130 offset:512
    ds_read_b64_tr_b16 v[100:101], v129 offset:64
    ds_read_b64_tr_b16 v[102:103], v129 offset:576
    s_waitcnt lgkmcnt(4)
    v_mfma_f32_32x32x16_bf16 v[0:15], v[104:107], v[92:95], v[0:15]
    v_mfma_f32_32x32x16_bf16 v[16:31], v[108:111], v[92:95], v[16:31]
    ds_read_b64_tr_b16 v[104:105], v130 offset:2048
    ds_read_b64_tr_b16 v[106:107], v130 offset:2560
    ds_read_b64_tr_b16 v[108:109], v129 offset:2112
    ds_read_b64_tr_b16 v[110:111], v129 offset:2624
    s_waitcnt vmcnt(16)
    s_waitcnt lgkmcnt(4)
    v_mfma_f32_32x32x16_bf16 v[0:15], v[96:99], v[32:35], v[0:15]
    v_mfma_f32_32x32x16_bf16 v[16:31], v[100:103], v[32:35], v[16:31]
    ds_read_b64_tr_b16 v[96:97], v130 offset:4096
    ds_read_b64_tr_b16 v[98:99], v130 offset:4608
    ds_read_b64_tr_b16 v[100:101], v129 offset:4160
    ds_read_b64_tr_b16 v[102:103], v129 offset:4672
    s_waitcnt lgkmcnt(4)
    v_mfma_f32_32x32x16_bf16 v[0:15], v[104:107], v[36:39], v[0:15]
    v_mfma_f32_32x32x16_bf16 v[16:31], v[108:111], v[36:39], v[16:31]
    ds_read_b64_tr_b16 v[104:105], v130 offset:6144
    ds_read_b64_tr_b16 v[106:107], v130 offset:6656
    ds_read_b64_tr_b16 v[108:109], v129 offset:6208
    ds_read_b64_tr_b16 v[110:111], v129 offset:6720
    s_waitcnt lgkmcnt(4)
    v_mfma_f32_32x32x16_bf16 v[0:15], v[96:99], v[40:43], v[0:15]
    v_mfma_f32_32x32x16_bf16 v[16:31], v[100:103], v[40:43], v[16:31]
    s_waitcnt vmcnt(12)
    s_barrier
    s_add_u32 s42, s40, 0x62000
    s_add_u32 m0, s39, 49152
    buffer_load_dwordx4 v131, s[12:15], s42 offen lds
    s_add_u32 s42, s40, 0x62000
    s_add_u32 m0, s39, 53248
    buffer_load_dwordx4 v132, s[12:15], s42 offen lds
    s_add_u32 s42, s40, 0x62000
    s_add_u32 m0, s39, 57344
    buffer_load_dwordx4 v133, s[12:15], s42 offen lds
    s_add_u32 s42, s40, 0x62000
    s_add_u32 m0, s39, 61440
    buffer_load_dwordx4 v134, s[12:15], s42 offen lds
    s_mov_b32 s41, 0x7000
    buffer_load_dwordx4 v[80:83], v135, s[8:11], s41 offen offset:0
    s_mov_b32 s41, 0x7000
    buffer_load_dwordx4 v[84:87], v135, s[8:11], s41 offen offset:1024
    s_mov_b32 s41, 0x7000
    buffer_load_dwordx4 v[88:91], v135, s[8:11], s41 offen offset:2048
    s_mov_b32 s41, 0x7000
    buffer_load_dwordx4 v[92:95], v135, s[8:11], s41 offen offset:3072
    ds_read_b64_tr_b16 v[96:97], v130 offset:16384
    ds_read_b64_tr_b16 v[98:99], v130 offset:16896
    ds_read_b64_tr_b16 v[100:101], v129 offset:16448
    ds_read_b64_tr_b16 v[102:103], v129 offset:16960
    s_waitcnt lgkmcnt(4)
    v_mfma_f32_32x32x16_bf16 v[0:15], v[104:107], v[44:47], v[0:15]
    v_mfma_f32_32x32x16_bf16 v[16:31], v[108:111], v[44:47], v[16:31]
    ds_read_b64_tr_b16 v[104:105], v130 offset:18432
    ds_read_b64_tr_b16 v[106:107], v130 offset:18944
    ds_read_b64_tr_b16 v[108:109], v129 offset:18496
    ds_read_b64_tr_b16 v[110:111], v129 offset:19008
    s_waitcnt vmcnt(16)
    s_waitcnt lgkmcnt(4)
    v_mfma_f32_32x32x16_bf16 v[0:15], v[96:99], v[48:51], v[0:15]
    v_mfma_f32_32x32x16_bf16 v[16:31], v[100:103], v[48:51], v[16:31]
    ds_read_b64_tr_b16 v[96:97], v130 offset:20480
    ds_read_b64_tr_b16 v[98:99], v130 offset:20992
    ds_read_b64_tr_b16 v[100:101], v129 offset:20544
    ds_read_b64_tr_b16 v[102:103], v129 offset:21056
    s_waitcnt lgkmcnt(4)
    v_mfma_f32_32x32x16_bf16 v[0:15], v[104:107], v[52:55], v[0:15]
    v_mfma_f32_32x32x16_bf16 v[16:31], v[108:111], v[52:55], v[16:31]
    ds_read_b64_tr_b16 v[104:105], v130 offset:22528
    ds_read_b64_tr_b16 v[106:107], v130 offset:23040
    ds_read_b64_tr_b16 v[108:109], v129 offset:22592
    ds_read_b64_tr_b16 v[110:111], v129 offset:23104
    s_waitcnt lgkmcnt(4)
    v_mfma_f32_32x32x16_bf16 v[0:15], v[96:99], v[56:59], v[0:15]
    v_mfma_f32_32x32x16_bf16 v[16:31], v[100:103], v[56:59], v[16:31]
    s_waitcnt vmcnt(12)
    s_barrier
    s_add_u32 s42, s40, 0x70000
    s_add_u32 m0, s39, 0
    buffer_load_dwordx4 v131, s[12:15], s42 offen lds
    s_add_u32 s42, s40, 0x70000
    s_add_u32 m0, s39, 4096
    buffer_load_dwordx4 v132, s[12:15], s42 offen lds
    s_add_u32 s42, s40, 0x70000
    s_add_u32 m0, s39, 8192
    buffer_load_dwordx4 v133, s[12:15], s42 offen lds
    s_add_u32 s42, s40, 0x70000
    s_add_u32 m0, s39, 12288
    buffer_load_dwordx4 v134, s[12:15], s42 offen lds
    s_mov_b32 s41, 0x8000
    buffer_load_dwordx4 v[32:35], v135, s[8:11], s41 offen offset:0
    s_mov_b32 s41, 0x8000
    buffer_load_dwordx4 v[36:39], v135, s[8:11], s41 offen offset:1024
    s_mov_b32 s41, 0x8000
    buffer_load_dwordx4 v[40:43], v135, s[8:11], s41 offen offset:2048
    s_mov_b32 s41, 0x8000
    buffer_load_dwordx4 v[44:47], v135, s[8:11], s41 offen offset:3072
    ds_read_b64_tr_b16 v[96:97], v130 offset:32768
    ds_read_b64_tr_b16 v[98:99], v130 offset:33280
    ds_read_b64_tr_b16 v[100:101], v129 offset:32832
    ds_read_b64_tr_b16 v[102:103], v129 offset:33344
    s_waitcnt lgkmcnt(4)
    v_mfma_f32_32x32x16_bf16 v[0:15], v[104:107], v[60:63], v[0:15]
    v_mfma_f32_32x32x16_bf16 v[16:31], v[108:111], v[60:63], v[16:31]
    ds_read_b64_tr_b16 v[104:105], v130 offset:34816
    ds_read_b64_tr_b16 v[106:107], v130 offset:35328
    ds_read_b64_tr_b16 v[108:109], v129 offset:34880
    ds_read_b64_tr_b16 v[110:111], v129 offset:35392
    s_waitcnt vmcnt(16)
    s_waitcnt lgkmcnt(4)
    v_mfma_f32_32x32x16_bf16 v[0:15], v[96:99], v[64:67], v[0:15]
    v_mfma_f32_32x32x16_bf16 v[16:31], v[100:103], v[64:67], v[16:31]
    ds_read_b64_tr_b16 v[96:97], v130 offset:36864
    ds_read_b64_tr_b16 v[98:99], v130 offset:37376
    ds_read_b64_tr_b16 v[100:101], v129 offset:36928
    ds_read_b64_tr_b16 v[102:103], v129 offset:37440
    s_waitcnt lgkmcnt(4)
    v_mfma_f32_32x32x16_bf16 v[0:15], v[104:107], v[68:71], v[0:15]
    v_mfma_f32_32x32x16_bf16 v[16:31], v[108:111], v[68:71], v[16:31]
    ds_read_b64_tr_b16 v[104:105], v130 offset:38912
    ds_read_b64_tr_b16 v[106:107], v130 offset:39424
    ds_read_b64_tr_b16 v[108:109], v129 offset:38976
    ds_read_b64_tr_b16 v[110:111], v129 offset:39488
    s_waitcnt lgkmcnt(4)
    v_mfma_f32_32x32x16_bf16 v[0:15], v[96:99], v[72:75], v[0:15]
    v_mfma_f32_32x32x16_bf16 v[16:31], v[100:103], v[72:75], v[16:31]
    s_waitcnt vmcnt(12)
    s_barrier
    s_add_u32 s42, s40, 0x7e000
    s_add_u32 m0, s39, 16384
    buffer_load_dwordx4 v131, s[12:15], s42 offen lds
    s_add_u32 s42, s40, 0x7e000
    s_add_u32 m0, s39, 20480
    buffer_load_dwordx4 v132, s[12:15], s42 offen lds
    s_add_u32 s42, s40, 0x7e000
    s_add_u32 m0, s39, 24576
    buffer_load_dwordx4 v133, s[12:15], s42 offen lds
    s_add_u32 s42, s40, 0x7e000
    s_add_u32 m0, s39, 28672
    buffer_load_dwordx4 v134, s[12:15], s42 offen lds
    s_mov_b32 s41, 0x9000
    buffer_load_dwordx4 v[48:51], v135, s[8:11], s41 offen offset:0
    s_mov_b32 s41, 0x9000
    buffer_load_dwordx4 v[52:55], v135, s[8:11], s41 offen offset:1024
    s_mov_b32 s41, 0x9000
    buffer_load_dwordx4 v[56:59], v135, s[8:11], s41 offen offset:2048
    s_mov_b32 s41, 0x9000
    buffer_load_dwordx4 v[60:63], v135, s[8:11], s41 offen offset:3072
    ds_read_b64_tr_b16 v[96:97], v130 offset:49152
    ds_read_b64_tr_b16 v[98:99], v130 offset:49664
    ds_read_b64_tr_b16 v[100:101], v129 offset:49216
    ds_read_b64_tr_b16 v[102:103], v129 offset:49728
    s_waitcnt lgkmcnt(4)
    v_mfma_f32_32x32x16_bf16 v[0:15], v[104:107], v[76:79], v[0:15]
    v_mfma_f32_32x32x16_bf16 v[16:31], v[108:111], v[76:79], v[16:31]
    ds_read_b64_tr_b16 v[104:105], v130 offset:51200
    ds_read_b64_tr_b16 v[106:107], v130 offset:51712
    ds_read_b64_tr_b16 v[108:109], v129 offset:51264
    ds_read_b64_tr_b16 v[110:111], v129 offset:51776
    s_waitcnt vmcnt(16)
    s_waitcnt lgkmcnt(4)
    v_mfma_f32_32x32x16_bf16 v[0:15], v[96:99], v[80:83], v[0:15]
    v_mfma_f32_32x32x16_bf16 v[16:31], v[100:103], v[80:83], v[16:31]
    ds_read_b64_tr_b16 v[96:97], v130 offset:53248
    ds_read_b64_tr_b16 v[98:99], v130 offset:53760
    ds_read_b64_tr_b16 v[100:101], v129 offset:53312
    ds_read_b64_tr_b16 v[102:103], v129 offset:53824
    s_waitcnt lgkmcnt(4)
    v_mfma_f32_32x32x16_bf16 v[0:15], v[104:107], v[84:87], v[0:15]
    v_mfma_f32_32x32x16_bf16 v[16:31], v[108:111], v[84:87], v[16:31]
    ds_read_b64_tr_b16 v[104:105], v130 offset:55296
    ds_read_b64_tr_b16 v[106:107], v130 offset:55808
    ds_read_b64_tr_b16 v[108:109], v129 offset:55360
    ds_read_b64_tr_b16 v[110:111], v129 offset:55872
    s_waitcnt lgkmcnt(4)
    v_mfma_f32_32x32x16_bf16 v[0:15], v[96:99], v[88:91], v[0:15]
    v_mfma_f32_32x32x16_bf16 v[16:31], v[100:103], v[88:91], v[16:31]
    s_waitcnt vmcnt(12)
    s_barrier
    s_add_u32 s42, s40, 0x8c000
    s_add_u32 m0, s39, 32768
    buffer_load_dwordx4 v131, s[12:15], s42 offen lds
    s_add_u32 s42, s40, 0x8c000
    s_add_u32 m0, s39, 36864
    buffer_load_dwordx4 v132, s[12:15], s42 offen lds
    s_add_u32 s42, s40, 0x8c000
    s_add_u32 m0, s39, 40960
    buffer_load_dwordx4 v133, s[12:15], s42 offen lds
    s_add_u32 s42, s40, 0x8c000
    s_add_u32 m0, s39, 45056
    buffer_load_dwordx4 v134, s[12:15], s42 offen lds
    s_mov_b32 s41, 0xa000
    buffer_load_dwordx4 v[64:67], v135, s[8:11], s41 offen offset:0
    s_mov_b32 s41, 0xa000
    buffer_load_dwordx4 v[68:71], v135, s[8:11], s41 offen offset:1024
    s_mov_b32 s41, 0xa000
    buffer_load_dwordx4 v[72:75], v135, s[8:11], s41 offen offset:2048
    s_mov_b32 s41, 0xa000
    buffer_load_dwordx4 v[76:79], v135, s[8:11], s41 offen offset:3072
    ds_read_b64_tr_b16 v[96:97], v130 offset:0
    ds_read_b64_tr_b16 v[98:99], v130 offset:512
    ds_read_b64_tr_b16 v[100:101], v129 offset:64
    ds_read_b64_tr_b16 v[102:103], v129 offset:576
    s_waitcnt lgkmcnt(4)
    v_mfma_f32_32x32x16_bf16 v[0:15], v[104:107], v[92:95], v[0:15]
    v_mfma_f32_32x32x16_bf16 v[16:31], v[108:111], v[92:95], v[16:31]
    ds_read_b64_tr_b16 v[104:105], v130 offset:2048
    ds_read_b64_tr_b16 v[106:107], v130 offset:2560
    ds_read_b64_tr_b16 v[108:109], v129 offset:2112
    ds_read_b64_tr_b16 v[110:111], v129 offset:2624
    s_waitcnt vmcnt(16)
    s_waitcnt lgkmcnt(4)
    v_mfma_f32_32x32x16_bf16 v[0:15], v[96:99], v[32:35], v[0:15]
    v_mfma_f32_32x32x16_bf16 v[16:31], v[100:103], v[32:35], v[16:31]
    ds_read_b64_tr_b16 v[96:97], v130 offset:4096
    ds_read_b64_tr_b16 v[98:99], v130 offset:4608
    ds_read_b64_tr_b16 v[100:101], v129 offset:4160
    ds_read_b64_tr_b16 v[102:103], v129 offset:4672
    s_waitcnt lgkmcnt(4)
    v_mfma_f32_32x32x16_bf16 v[0:15], v[104:107], v[36:39], v[0:15]
    v_mfma_f32_32x32x16_bf16 v[16:31], v[108:111], v[36:39], v[16:31]
    ds_read_b64_tr_b16 v[104:105], v130 offset:6144
    ds_read_b64_tr_b16 v[106:107], v130 offset:6656
    ds_read_b64_tr_b16 v[108:109], v129 offset:6208
    ds_read_b64_tr_b16 v[110:111], v129 offset:6720
    s_waitcnt lgkmcnt(4)
    v_mfma_f32_32x32x16_bf16 v[0:15], v[96:99], v[40:43], v[0:15]
    v_mfma_f32_32x32x16_bf16 v[16:31], v[100:103], v[40:43], v[16:31]
    s_waitcnt vmcnt(12)
    s_barrier
    s_add_u32 s42, s40, 0x9a000
    s_add_u32 m0, s39, 49152
    buffer_load_dwordx4 v131, s[12:15], s42 offen lds
    s_add_u32 s42, s40, 0x9a000
    s_add_u32 m0, s39, 53248
    buffer_load_dwordx4 v132, s[12:15], s42 offen lds
    s_add_u32 s42, s40, 0x9a000
    s_add_u32 m0, s39, 57344
    buffer_load_dwordx4 v133, s[12:15], s42 offen lds
    s_add_u32 s42, s40, 0x9a000
    s_add_u32 m0, s39, 61440
    buffer_load_dwordx4 v134, s[12:15], s42 offen lds
    s_mov_b32 s41, 0xb000
    buffer_load_dwordx4 v[80:83], v135, s[8:11], s41 offen offset:0
    s_mov_b32 s41, 0xb000
    buffer_load_dwordx4 v[84:87], v135, s[8:11], s41 offen offset:1024
    s_mov_b32 s41, 0xb000
    buffer_load_dwordx4 v[88:91], v135, s[8:11], s41 offen offset:2048
    s_mov_b32 s41, 0xb000
    buffer_load_dwordx4 v[92:95], v135, s[8:11], s41 offen offset:3072
    ds_read_b64_tr_b16 v[96:97], v130 offset:16384
    ds_read_b64_tr_b16 v[98:99], v130 offset:16896
    ds_read_b64_tr_b16 v[100:101], v129 offset:16448
    ds_read_b64_tr_b16 v[102:103], v129 offset:16960
    s_waitcnt lgkmcnt(4)
    v_mfma_f32_32x32x16_bf16 v[0:15], v[104:107], v[44:47], v[0:15]
    v_mfma_f32_32x32x16_bf16 v[16:31], v[108:111], v[44:47], v[16:31]
    ds_read_b64_tr_b16 v[104:105], v130 offset:18432
    ds_read_b64_tr_b16 v[106:107], v130 offset:18944
    ds_read_b64_tr_b16 v[108:109], v129 offset:18496
    ds_read_b64_tr_b16 v[110:111], v129 offset:19008
    s_waitcnt vmcnt(16)
    s_waitcnt lgkmcnt(4)
    v_mfma_f32_32x32x16_bf16 v[0:15], v[96:99], v[48:51], v[0:15]
    v_mfma_f32_32x32x16_bf16 v[16:31], v[100:103], v[48:51], v[16:31]
    ds_read_b64_tr_b16 v[96:97], v130 offset:20480
    ds_read_b64_tr_b16 v[98:99], v130 offset:20992
    ds_read_b64_tr_b16 v[100:101], v129 offset:20544
    ds_read_b64_tr_b16 v[102:103], v129 offset:21056
    s_waitcnt lgkmcnt(4)
    v_mfma_f32_32x32x16_bf16 v[0:15], v[104:107], v[52:55], v[0:15]
    v_mfma_f32_32x32x16_bf16 v[16:31], v[108:111], v[52:55], v[16:31]
    ds_read_b64_tr_b16 v[104:105], v130 offset:22528
    ds_read_b64_tr_b16 v[106:107], v130 offset:23040
    ds_read_b64_tr_b16 v[108:109], v129 offset:22592
    ds_read_b64_tr_b16 v[110:111], v129 offset:23104
    s_waitcnt lgkmcnt(4)
    v_mfma_f32_32x32x16_bf16 v[0:15], v[96:99], v[56:59], v[0:15]
    v_mfma_f32_32x32x16_bf16 v[16:31], v[100:103], v[56:59], v[16:31]
    s_waitcnt vmcnt(12)
    s_barrier
    s_add_u32 s42, s40, 0xa8000
    s_add_u32 m0, s39, 0
    buffer_load_dwordx4 v131, s[12:15], s42 offen lds
    s_add_u32 s42, s40, 0xa8000
    s_add_u32 m0, s39, 4096
    buffer_load_dwordx4 v132, s[12:15], s42 offen lds
    s_add_u32 s42, s40, 0xa8000
    s_add_u32 m0, s39, 8192
    buffer_load_dwordx4 v133, s[12:15], s42 offen lds
    s_add_u32 s42, s40, 0xa8000
    s_add_u32 m0, s39, 12288
    buffer_load_dwordx4 v134, s[12:15], s42 offen lds
    s_mov_b32 s41, 0xc000
    buffer_load_dwordx4 v[32:35], v135, s[8:11], s41 offen offset:0
    s_mov_b32 s41, 0xc000
    buffer_load_dwordx4 v[36:39], v135, s[8:11], s41 offen offset:1024
    s_mov_b32 s41, 0xc000
    buffer_load_dwordx4 v[40:43], v135, s[8:11], s41 offen offset:2048
    s_mov_b32 s41, 0xc000
    buffer_load_dwordx4 v[44:47], v135, s[8:11], s41 offen offset:3072
    ds_read_b64_tr_b16 v[96:97], v130 offset:32768
    ds_read_b64_tr_b16 v[98:99], v130 offset:33280
    ds_read_b64_tr_b16 v[100:101], v129 offset:32832
    ds_read_b64_tr_b16 v[102:103], v129 offset:33344
    s_waitcnt lgkmcnt(4)
    v_mfma_f32_32x32x16_bf16 v[0:15], v[104:107], v[60:63], v[0:15]
    v_mfma_f32_32x32x16_bf16 v[16:31], v[108:111], v[60:63], v[16:31]
    ds_read_b64_tr_b16 v[104:105], v130 offset:34816
    ds_read_b64_tr_b16 v[106:107], v130 offset:35328
    ds_read_b64_tr_b16 v[108:109], v129 offset:34880
    ds_read_b64_tr_b16 v[110:111], v129 offset:35392
    s_waitcnt vmcnt(16)
    s_waitcnt lgkmcnt(4)
    v_mfma_f32_32x32x16_bf16 v[0:15], v[96:99], v[64:67], v[0:15]
    v_mfma_f32_32x32x16_bf16 v[16:31], v[100:103], v[64:67], v[16:31]
    ds_read_b64_tr_b16 v[96:97], v130 offset:36864
    ds_read_b64_tr_b16 v[98:99], v130 offset:37376
    ds_read_b64_tr_b16 v[100:101], v129 offset:36928
    ds_read_b64_tr_b16 v[102:103], v129 offset:37440
    s_waitcnt lgkmcnt(4)
    v_mfma_f32_32x32x16_bf16 v[0:15], v[104:107], v[68:71], v[0:15]
    v_mfma_f32_32x32x16_bf16 v[16:31], v[108:111], v[68:71], v[16:31]
    ds_read_b64_tr_b16 v[104:105], v130 offset:38912
    ds_read_b64_tr_b16 v[106:107], v130 offset:39424
    ds_read_b64_tr_b16 v[108:109], v129 offset:38976
    ds_read_b64_tr_b16 v[110:111], v129 offset:39488
    s_waitcnt lgkmcnt(4)
    v_mfma_f32_32x32x16_bf16 v[0:15], v[96:99], v[72:75], v[0:15]
    v_mfma_f32_32x32x16_bf16 v[16:31], v[100:103], v[72:75], v[16:31]
    s_waitcnt vmcnt(12)
    s_barrier
    s_add_u32 s42, s40, 0xb6000
    s_add_u32 m0, s39, 16384
    buffer_load_dwordx4 v131, s[12:15], s42 offen lds
    s_add_u32 s42, s40, 0xb6000
    s_add_u32 m0, s39, 20480
    buffer_load_dwordx4 v132, s[12:15], s42 offen lds
    s_add_u32 s42, s40, 0xb6000
    s_add_u32 m0, s39, 24576
    buffer_load_dwordx4 v133, s[12:15], s42 offen lds
    s_add_u32 s42, s40, 0xb6000
    s_add_u32 m0, s39, 28672
    buffer_load_dwordx4 v134, s[12:15], s42 offen lds
    s_mov_b32 s41, 0xd000
    buffer_load_dwordx4 v[48:51], v135, s[8:11], s41 offen offset:0
    s_mov_b32 s41, 0xd000
    buffer_load_dwordx4 v[52:55], v135, s[8:11], s41 offen offset:1024
    s_mov_b32 s41, 0xd000
    buffer_load_dwordx4 v[56:59], v135, s[8:11], s41 offen offset:2048
    s_mov_b32 s41, 0xd000
    buffer_load_dwordx4 v[60:63], v135, s[8:11], s41 offen offset:3072
    ds_read_b64_tr_b16 v[96:97], v130 offset:49152
    ds_read_b64_tr_b16 v[98:99], v130 offset:49664
    ds_read_b64_tr_b16 v[100:101], v129 offset:49216
    ds_read_b64_tr_b16 v[102:103], v129 offset:49728
    s_waitcnt lgkmcnt(4)
    v_mfma_f32_32x32x16_bf16 v[0:15], v[104:107], v[76:79], v[0:15]
    v_mfma_f32_32x32x16_bf16 v[16:31], v[108:111], v[76:79], v[16:31]
    ds_read_b64_tr_b16 v[104:105], v130 offset:51200
    ds_read_b64_tr_b16 v[106:107], v130 offset:51712
    ds_read_b64_tr_b16 v[108:109], v129 offset:51264
    ds_read_b64_tr_b16 v[110:111], v129 offset:51776
    s_waitcnt vmcnt(16)
    s_waitcnt lgkmcnt(4)
    v_mfma_f32_32x32x16_bf16 v[0:15], v[96:99], v[80:83], v[0:15]
    v_mfma_f32_32x32x16_bf16 v[16:31], v[100:103], v[80:83], v[16:31]
    ds_read_b64_tr_b16 v[96:97], v130 offset:53248
    ds_read_b64_tr_b16 v[98:99], v130 offset:53760
    ds_read_b64_tr_b16 v[100:101], v129 offset:53312
    ds_read_b64_tr_b16 v[102:103], v129 offset:53824
    s_waitcnt lgkmcnt(4)
    v_mfma_f32_32x32x16_bf16 v[0:15], v[104:107], v[84:87], v[0:15]
    v_mfma_f32_32x32x16_bf16 v[16:31], v[108:111], v[84:87], v[16:31]
    ds_read_b64_tr_b16 v[104:105], v130 offset:55296
    ds_read_b64_tr_b16 v[106:107], v130 offset:55808
    ds_read_b64_tr_b16 v[108:109], v129 offset:55360
    ds_read_b64_tr_b16 v[110:111], v129 offset:55872
    s_waitcnt lgkmcnt(4)
    v_mfma_f32_32x32x16_bf16 v[0:15], v[96:99], v[88:91], v[0:15]
    v_mfma_f32_32x32x16_bf16 v[16:31], v[100:103], v[88:91], v[16:31]
    s_waitcnt vmcnt(12)
    s_barrier
    ds_read_b64_tr_b16 v[96:97], v130 offset:0
    ds_read_b64_tr_b16 v[98:99], v130 offset:512
    ds_read_b64_tr_b16 v[100:101], v129 offset:64
    ds_read_b64_tr_b16 v[102:103], v129 offset:576
    s_waitcnt lgkmcnt(4)
    v_mfma_f32_32x32x16_bf16 v[0:15], v[104:107], v[92:95], v[0:15]
    v_mfma_f32_32x32x16_bf16 v[16:31], v[108:111], v[92:95], v[16:31]
    ds_read_b64_tr_b16 v[104:105], v130 offset:2048
    ds_read_b64_tr_b16 v[106:107], v130 offset:2560
    ds_read_b64_tr_b16 v[108:109], v129 offset:2112
    ds_read_b64_tr_b16 v[110:111], v129 offset:2624
    s_waitcnt vmcnt(8)
    s_waitcnt lgkmcnt(4)
    v_mfma_f32_32x32x16_bf16 v[0:15], v[96:99], v[32:35], v[0:15]
    v_mfma_f32_32x32x16_bf16 v[16:31], v[100:103], v[32:35], v[16:31]
    ds_read_b64_tr_b16 v[96:97], v130 offset:4096
    ds_read_b64_tr_b16 v[98:99], v130 offset:4608
    ds_read_b64_tr_b16 v[100:101], v129 offset:4160
    ds_read_b64_tr_b16 v[102:103], v129 offset:4672
    s_waitcnt lgkmcnt(4)
    v_mfma_f32_32x32x16_bf16 v[0:15], v[104:107], v[36:39], v[0:15]
    v_mfma_f32_32x32x16_bf16 v[16:31], v[108:111], v[36:39], v[16:31]
    ds_read_b64_tr_b16 v[104:105], v130 offset:6144
    ds_read_b64_tr_b16 v[106:107], v130 offset:6656
    ds_read_b64_tr_b16 v[108:109], v129 offset:6208
    ds_read_b64_tr_b16 v[110:111], v129 offset:6720
    s_waitcnt lgkmcnt(4)
    v_mfma_f32_32x32x16_bf16 v[0:15], v[96:99], v[40:43], v[0:15]
    v_mfma_f32_32x32x16_bf16 v[16:31], v[100:103], v[40:43], v[16:31]
    s_waitcnt vmcnt(4)
    s_barrier
    ds_read_b64_tr_b16 v[96:97], v130 offset:16384
    ds_read_b64_tr_b16 v[98:99], v130 offset:16896
    ds_read_b64_tr_b16 v[100:101], v129 offset:16448
    ds_read_b64_tr_b16 v[102:103], v129 offset:16960
    s_waitcnt lgkmcnt(4)
    v_mfma_f32_32x32x16_bf16 v[0:15], v[104:107], v[44:47], v[0:15]
    v_mfma_f32_32x32x16_bf16 v[16:31], v[108:111], v[44:47], v[16:31]
    ds_read_b64_tr_b16 v[104:105], v130 offset:18432
    ds_read_b64_tr_b16 v[106:107], v130 offset:18944
    ds_read_b64_tr_b16 v[108:109], v129 offset:18496
    ds_read_b64_tr_b16 v[110:111], v129 offset:19008
    s_waitcnt vmcnt(0)
    s_waitcnt lgkmcnt(4)
    v_mfma_f32_32x32x16_bf16 v[0:15], v[96:99], v[48:51], v[0:15]
    v_mfma_f32_32x32x16_bf16 v[16:31], v[100:103], v[48:51], v[16:31]
    ds_read_b64_tr_b16 v[96:97], v130 offset:20480
    ds_read_b64_tr_b16 v[98:99], v130 offset:20992
    ds_read_b64_tr_b16 v[100:101], v129 offset:20544
    ds_read_b64_tr_b16 v[102:103], v129 offset:21056
    s_waitcnt lgkmcnt(4)
    v_mfma_f32_32x32x16_bf16 v[0:15], v[104:107], v[52:55], v[0:15]
    v_mfma_f32_32x32x16_bf16 v[16:31], v[108:111], v[52:55], v[16:31]
    ds_read_b64_tr_b16 v[104:105], v130 offset:22528
    ds_read_b64_tr_b16 v[106:107], v130 offset:23040
    ds_read_b64_tr_b16 v[108:109], v129 offset:22592
    ds_read_b64_tr_b16 v[110:111], v129 offset:23104
    s_waitcnt lgkmcnt(4)
    v_mfma_f32_32x32x16_bf16 v[0:15], v[96:99], v[56:59], v[0:15]
    v_mfma_f32_32x32x16_bf16 v[16:31], v[100:103], v[56:59], v[16:31]
    s_waitcnt lgkmcnt(0)
    v_mfma_f32_32x32x16_bf16 v[0:15], v[104:107], v[60:63], v[0:15]
    v_mfma_f32_32x32x16_bf16 v[16:31], v[108:111], v[60:63], v[16:31]
    s_nop 15
    s_nop 3
    s_barrier
    s_and_b32 s42, s36, 1
    s_lshl_b32 s42, s42, 13
    v_lshlrev_b32 v112, 4, v128
    v_add_u32 v112, s42, v112
    s_cmp_lt_u32 s36, 2
    s_cbranch_scc1 k_down2_kernel_lo
    ds_write_b128 v112, v[0:3] offset:0
    ds_write_b128 v112, v[4:7] offset:1024
    ds_write_b128 v112, v[8:11] offset:2048
    ds_write_b128 v112, v[12:15] offset:3072
    ds_write_b128 v112, v[16:19] offset:4096
    ds_write_b128 v112, v[20:23] offset:5120
    ds_write_b128 v112, v[24:27] offset:6144
    ds_write_b128 v112, v[28:31] offset:7168
    s_waitcnt lgkmcnt(0)
    s_barrier
    s_branch k_down2_kernel_end
k_down2_kernel_lo:
    s_barrier
    ds_read_b128 v[32:35], v112 offset:0
    ds_read_b128 v[36:39], v112 offset:1024
    ds_read_b128 v[40:43], v112 offset:2048
    ds_read_b128 v[44:47], v112 offset:3072
    ds_read_b128 v[48:51], v112 offset:4096
    ds_read_b128 v[52:55], v112 offset:5120
    ds_read_b128 v[56:59], v112 offset:6144
    ds_read_b128 v[60:63], v112 offset:7168
    s_waitcnt lgkmcnt(0)
    v_add_f32 v0, v0, v32
    v_add_f32 v1, v1, v33
    v_add_f32 v2, v2, v34
    v_add_f32 v3, v3, v35
    v_add_f32 v4, v4, v36
    v_add_f32 v5, v5, v37
    v_add_f32 v6, v6, v38
    v_add_f32 v7, v7, v39
    v_add_f32 v8, v8, v40
    v_add_f32 v9, v9, v41
    v_add_f32 v10, v10, v42
    v_add_f32 v11, v11, v43
    v_add_f32 v12, v12, v44
    v_add_f32 v13, v13, v45
    v_add_f32 v14, v14, v46
    v_add_f32 v15, v15, v47
    v_add_f32 v16, v16, v48
    v_add_f32 v17, v17, v49
    v_add_f32 v18, v18, v50
    v_add_f32 v19, v19, v51
    v_add_f32 v20, v20, v52
    v_add_f32 v21, v21, v53
    v_add_f32 v22, v22, v54
    v_add_f32 v23, v23, v55
    v_add_f32 v24, v24, v56
    v_add_f32 v25, v25, v57
    v_add_f32 v26, v26, v58
    v_add_f32 v27, v27, v59
    v_add_f32 v28, v28, v60
    v_add_f32 v29, v29, v61
    v_add_f32 v30, v30, v62
    v_add_f32 v31, v31, v63
    s_nop 15
    s_nop 3
    s_mul_i32 s41, s48, 28
    s_lshr_b32 s49, s43, 4
    s_add_u32 s41, s41, s49
    s_lshl_b32 s41, s41, 10
    v_lshlrev_b32 v120, 4, v128
    v_add_u32 v120, s41, v120
    v_mul_u32_u24 v121, 896, v136
    v_lshrrev_b32 v140, 5, v128
    v_lshl_add_u32 v121, v140, 4, v121
    s_lshl_b32 s49, s43, 1
    v_add_u32 v121, s49, v121
    buffer_load_dwordx4 v[140:143], v120, s[24:27], 0 offen offset:0
    buffer_load_dwordx4 v[144:147], v120, s[24:27], 0 offen offset:1024
    v_cvt_pk_bf16_f32 v112, v0, v1
    v_cvt_pk_bf16_f32 v113, v2, v3
    v_cvt_pk_bf16_f32 v114, v4, v5
    v_cvt_pk_bf16_f32 v115, v6, v7
    v_cvt_pk_bf16_f32 v116, v8, v9
    v_cvt_pk_bf16_f32 v117, v10, v11
    v_cvt_pk_bf16_f32 v118, v12, v13
    v_cvt_pk_bf16_f32 v119, v14, v15
    s_nop 1
    v_permlane32_swap_b32 v112, v114
    v_permlane32_swap_b32 v113, v115
    v_permlane32_swap_b32 v116, v118
    v_permlane32_swap_b32 v117, v119
    s_nop 1
    s_waitcnt vmcnt(1)
    v_lshlrev_b32 v0, 16, v112
    v_and_b32 v1, 0xffff0000, v112
    v_lshlrev_b32 v2, 16, v140
    v_and_b32 v3, 0xffff0000, v140
    v_add_f32 v0, v0, v2
    v_add_f32 v1, v1, v3
    v_cvt_pk_bf16_f32 v112, v0, v1
    v_lshlrev_b32 v0, 16, v113
    v_and_b32 v1, 0xffff0000, v113
    v_lshlrev_b32 v2, 16, v141
    v_and_b32 v3, 0xffff0000, v141
    v_add_f32 v0, v0, v2
    v_add_f32 v1, v1, v3
    v_cvt_pk_bf16_f32 v113, v0, v1
    v_lshlrev_b32 v0, 16, v114
    v_and_b32 v1, 0xffff0000, v114
    v_lshlrev_b32 v2, 16, v142
    v_and_b32 v3, 0xffff0000, v142
    v_add_f32 v0, v0, v2
    v_add_f32 v1, v1, v3
    v_cvt_pk_bf16_f32 v114, v0, v1
    v_lshlrev_b32 v0, 16, v115
    v_and_b32 v1, 0xffff0000, v115
    v_lshlrev_b32 v2, 16, v143
    v_and_b32 v3, 0xffff0000, v143
    v_add_f32 v0, v0, v2
    v_add_f32 v1, v1, v3
    v_cvt_pk_bf16_f32 v115, v0, v1
    buffer_store_dwordx4 v[112:115], v121, s[20:23], 0 offen offset:0
    s_waitcnt vmcnt(1)
    v_lshlrev_b32 v0, 16, v116
    v_and_b32 v1, 0xffff0000, v116
    v_lshlrev_b32 v2, 16, v144
    v_and_b32 v3, 0xffff0000, v144
    v_add_f32 v0, v0, v2
    v_add_f32 v1, v1, v3
    v_cvt_pk_bf16_f32 v116, v0, v1
    v_lshlrev_b32 v0, 16, v117
    v_and_b32 v1, 0xffff0000, v117
    v_lshlrev_b32 v2, 16, v145
    v_and_b32 v3, 0xffff0000, v145
    v_add_f32 v0, v0, v2
    v_add_f32 v1, v1, v3
    v_cvt_pk_bf16_f32 v117, v0, v1
    v_lshlrev_b32 v0, 16, v118
    v_and_b32 v1, 0xffff0000, v118
    v_lshlrev_b32 v2, 16, v146
    v_and_b32 v3, 0xffff0000, v146
    v_add_f32 v0, v0, v2
    v_add_f32 v1, v1, v3
    v_cvt_pk_bf16_f32 v118, v0, v1
    v_lshlrev_b32 v0, 16, v119
    v_and_b32 v1, 0xffff0000, v119
    v_lshlrev_b32 v2, 16, v147
    v_and_b32 v3, 0xffff0000, v147
    v_add_f32 v0, v0, v2
    v_add_f32 v1, v1, v3
    v_cvt_pk_bf16_f32 v119, v0, v1
    buffer_store_dwordx4 v[116:119], v121, s[20:23], 0 offen offset:32
    s_nop 1
    buffer_load_dwordx4 v[140:143], v120, s[24:27], 0 offen offset:2048
    buffer_load_dwordx4 v[144:147], v120, s[24:27], 0 offen offset:3072
    v_cvt_pk_bf16_f32 v112, v16, v17
    v_cvt_pk_bf16_f32 v113, v18, v19
    v_cvt_pk_bf16_f32 v114, v20, v21
    v_cvt_pk_bf16_f32 v115, v22, v23
    v_cvt_pk_bf16_f32 v116, v24, v25
    v_cvt_pk_bf16_f32 v117, v26, v27
    v_cvt_pk_bf16_f32 v118, v28, v29
    v_cvt_pk_bf16_f32 v119, v30, v31
    s_nop 1
    v_permlane32_swap_b32 v112, v114
    v_permlane32_swap_b32 v113, v115
    v_permlane32_swap_b32 v116, v118
    v_permlane32_swap_b32 v117, v119
    s_nop 1
    s_waitcnt vmcnt(1)
    v_lshlrev_b32 v16, 16, v112
    v_and_b32 v17, 0xffff0000, v112
    v_lshlrev_b32 v18, 16, v140
    v_and_b32 v19, 0xffff0000, v140
    v_add_f32 v16, v16, v18
    v_add_f32 v17, v17, v19
    v_cvt_pk_bf16_f32 v112, v16, v17
    v_lshlrev_b32 v16, 16, v113
    v_and_b32 v17, 0xffff0000, v113
    v_lshlrev_b32 v18, 16, v141
    v_and_b32 v19, 0xffff0000, v141
    v_add_f32 v16, v16, v18
    v_add_f32 v17, v17, v19
    v_cvt_pk_bf16_f32 v113, v16, v17
    v_lshlrev_b32 v16, 16, v114
    v_and_b32 v17, 0xffff0000, v114
    v_lshlrev_b32 v18, 16, v142
    v_and_b32 v19, 0xffff0000, v142
    v_add_f32 v16, v16, v18
    v_add_f32 v17, v17, v19
    v_cvt_pk_bf16_f32 v114, v16, v17
    v_lshlrev_b32 v16, 16, v115
    v_and_b32 v17, 0xffff0000, v115
    v_lshlrev_b32 v18, 16, v143
    v_and_b32 v19, 0xffff0000, v143
    v_add_f32 v16, v16, v18
    v_add_f32 v17, v17, v19
    v_cvt_pk_bf16_f32 v115, v16, v17
    buffer_store_dwordx4 v[112:115], v121, s[20:23], 0 offen offset:64
    s_waitcnt vmcnt(1)
    v_lshlrev_b32 v16, 16, v116
    v_and_b32 v17, 0xffff0000, v116
    v_lshlrev_b32 v18, 16, v144
    v_and_b32 v19, 0xffff0000, v144
    v_add_f32 v16, v16, v18
    v_add_f32 v17, v17, v19
    v_cvt_pk_bf16_f32 v116, v16, v17
    v_lshlrev_b32 v16, 16, v117
    v_and_b32 v17, 0xffff0000, v117
    v_lshlrev_b32 v18, 16, v145
    v_and_b32 v19, 0xffff0000, v145
    v_add_f32 v16, v16, v18
    v_add_f32 v17, v17, v19
    v_cvt_pk_bf16_f32 v117, v16, v17
    v_lshlrev_b32 v16, 16, v118
    v_and_b32 v17, 0xffff0000, v118
    v_lshlrev_b32 v18, 16, v146
    v_and_b32 v19, 0xffff0000, v146
    v_add_f32 v16, v16, v18
    v_add_f32 v17, v17, v19
    v_cvt_pk_bf16_f32 v118, v16, v17
    v_lshlrev_b32 v16, 16, v119
    v_and_b32 v17, 0xffff0000, v119
    v_lshlrev_b32 v18, 16, v147
    v_and_b32 v19, 0xffff0000, v147
    v_add_f32 v16, v16, v18
    v_add_f32 v17, v17, v19
    v_cvt_pk_bf16_f32 v119, v16, v17
    buffer_store_dwordx4 v[116:119], v121, s[20:23], 0 offen offset:96
    s_nop 1
    s_waitcnt vmcnt(0)
k_down2_kernel_end:
    s_endpgm

.section .rodata,"a"
.p2align 6
.amdhsa_kernel k_qkv1_kernel
  .amdhsa_next_free_vgpr 224
  .amdhsa_next_free_sgpr 96
  .amdhsa_accum_offset 224
  .amdhsa_group_segment_fixed_size 0
  .amdhsa_kernarg_size 80
  .amdhsa_user_sgpr_count 2
  .amdhsa_user_sgpr_kernarg_segment_ptr 1
  .amdhsa_system_sgpr_workgroup_id_x 1
  .amdhsa_float_denorm_mode_32 3
  .amdhsa_float_denorm_mode_16_64 3
.end_amdhsa_kernel
.p2align 6
.amdhsa_kernel k_attn_kernel
  .amdhsa_next_free_vgpr 200
  .amdhsa_next_free_sgpr 96
  .amdhsa_accum_offset 200
  .amdhsa_group_segment_fixed_size 0
  .amdhsa_kernarg_size 80
  .amdhsa_user_sgpr_count 2
  .amdhsa_user_sgpr_kernarg_segment_ptr 1
  .amdhsa_system_sgpr_workgroup_id_x 1
  .amdhsa_float_denorm_mode_32 3
  .amdhsa_float_denorm_mode_16_64 3
.end_amdhsa_kernel
.p2align 6
.amdhsa_kernel k_oproj1_kernel
  .amdhsa_next_free_vgpr 172
  .amdhsa_next_free_sgpr 96
  .amdhsa_accum_offset 172
  .amdhsa_group_segment_fixed_size 0
  .amdhsa_kernarg_size 80
  .amdhsa_user_sgpr_count 2
  .amdhsa_user_sgpr_kernarg_segment_ptr 1
  .amdhsa_system_sgpr_workgroup_id_x 1
  .amdhsa_float_denorm_mode_32 3
  .amdhsa_float_denorm_mode_16_64 3
.end_amdhsa_kernel
.p2align 6
.amdhsa_kernel k_glu_kernel
  .amdhsa_next_free_vgpr 248
  .amdhsa_next_free_sgpr 96
  .amdhsa_accum_offset 248
  .amdhsa_group_segment_fixed_size 0
  .amdhsa_kernarg_size 80
  .amdhsa_user_sgpr_count 2
  .amdhsa_user_sgpr_kernarg_segment_ptr 1
  .amdhsa_system_sgpr_workgroup_id_x 1
  .amdhsa_float_denorm_mode_32 3
  .amdhsa_float_denorm_mode_16_64 3
.end_amdhsa_kernel
.p2align 6
.amdhsa_kernel k_down1_kernel
  .amdhsa_next_free_vgpr 152
  .amdhsa_next_free_sgpr 96
  .amdhsa_accum_offset 152
  .amdhsa_group_segment_fixed_size 0
  .amdhsa_kernarg_size 80
  .amdhsa_user_sgpr_count 2
  .amdhsa_user_sgpr_kernarg_segment_ptr 1
  .amdhsa_system_sgpr_workgroup_id_x 1
  .amdhsa_float_denorm_mode_32 3
  .amdhsa_float_denorm_mode_16_64 3
.end_amdhsa_kernel
.p2align 6
.amdhsa_kernel k_qkv2_kernel
  .amdhsa_next_free_vgpr 224
  .amdhsa_next_free_sgpr 96
  .amdhsa_accum_offset 224
  .amdhsa_group_segment_fixed_size 0
  .amdhsa_kernarg_size 80
  .amdhsa_user_sgpr_count 2
  .amdhsa_user_sgpr_kernarg_segment_ptr 1
  .amdhsa_system_sgpr_workgroup_id_x 1
  .amdhsa_float_denorm_mode_32 3
  .amdhsa_float_denorm_mode_16_64 3
.end_amdhsa_kernel
.p2align 6
.amdhsa_kernel k_oproj2_kernel
  .amdhsa_next_free_vgpr 172
  .amdhsa_next_free_sgpr 96
  .amdhsa_accum_offset 172
  .amdhsa_group_segment_fixed_size 0
  .amdhsa_kernarg_size 80
  .amdhsa_user_sgpr_count 2
  .amdhsa_user_sgpr_kernarg_segment_ptr 1
  .amdhsa_system_sgpr_workgroup_id_x 1
  .amdhsa_float_denorm_mode_32 3
  .amdhsa_float_denorm_mode_16_64 3
.end_amdhsa_kernel
.p2align 6
.amdhsa_kernel k_down2_kernel
  .amdhsa_next_free_vgpr 152
  .amdhsa_next_free_sgpr 96
  .amdhsa_accum_offset 152
  .amdhsa_group_segment_fixed_size 0
  .amdhsa_kernarg_size 80
  .amdhsa_user_sgpr_count 2
  .amdhsa_user_sgpr_kernarg_segment_ptr 1
  .amdhsa_system_sgpr_workgroup_id_x 1
  .amdhsa_float_denorm_mode_32 3
  .amdhsa_float_denorm_mode_16_64 3
.end_amdhsa_kernel
```
